```python
import torch

def _softmax(x, axis=-1):
    return torch.softmax(x, dim=axis)

def _gelu(x):
    return torch.nn.functional.gelu(x, approximate='tanh')

def _silu(x):
    return torch.nn.functional.silu(x)

def _sigmoid(x):
    return torch.sigmoid(x)

def _layernorm(x, axis=-1, eps=1e-05):
    m = x.mean(dim=axis, keepdim=True)
    v = x.var(dim=axis, keepdim=True, unbiased=False)
    return (x - m) / torch.sqrt(v + eps)

def _scatter_add(tgt, idx, src, axis=0):
    return tgt.clone().index_add_(axis, idx, src)

def _segment_sum(src, seg, n):
    out = torch.zeros((n,) + src.shape[1:], dtype=src.dtype)
    return out.index_add_(0, seg, src)

def _pad(x, pw):
    flat = tuple((v for pair in reversed(pw) for v in pair))
    return torch.nn.functional.pad(x, flat)
kernel_name = 'gated_mix__memory_aug_recurrent_mem_tr__glu_gated_swiglu__prompt'

def setup_inputs():

    _w = lambda a: (lambda t: t.to(torch.bfloat16) if t.is_floating_point() else t)(torch.as_tensor(a))

    def _A_setup():
        B, S, Dm = (1, 2048, 640)
        H, Dh = (32, 128)
        M, seg = (8, 32)
        seg = min(seg, S)
        S = S // seg * seg
        return {'x': _w((lambda *s: torch.randn(*s, dtype=torch.bfloat16) * 0.05)(B, S, Dm)), 'mem0': _w((lambda *s: torch.randn(*s, dtype=torch.bfloat16) * 0.8)(B, M, Dm)), 'Wq': _w((lambda *s: torch.randn(*s, dtype=torch.bfloat16) * 1.6)(Dm, H, Dh) * Dm ** (-0.5)), 'Wk': _w((lambda *s: torch.randn(*s, dtype=torch.bfloat16) * 1.6)(Dm, H, Dh) * Dm ** (-0.5)), 'Wv': _w((lambda *s: torch.randn(*s, dtype=torch.bfloat16) * 0.8)(Dm, H, Dh) * Dm ** (-0.5)), 'Wo': _w((lambda *s: torch.randn(*s, dtype=torch.bfloat16) * 0.8)(H, Dh, Dm) * (H * Dh) ** (-0.5)), 'seg_len': seg}
    _A_in = _A_setup()

    def _B_setup():
        B, S, D, F = (1, 2048, 640, 1728)
        return {'x': _w((lambda *s: torch.randn(*s, dtype=torch.bfloat16) * 0.05)(B, S, D)), 'w1': _w((lambda *s: torch.randn(*s, dtype=torch.bfloat16) * 3.2)(D, F) * (2.0 / D) ** 0.5), 'w3': _w((lambda *s: torch.randn(*s, dtype=torch.bfloat16) * 3.2)(D, F) * (2.0 / D) ** 0.5), 'w2': _w((lambda *s: torch.randn(*s, dtype=torch.bfloat16) * 3.2)(F, D) * (2.0 / F) ** 0.5)}
    _B_in = _B_setup()
    return {'A_x': _A_in['x'], 'A_mem0': _A_in['mem0'], 'A_Wq': _A_in['Wq'], 'A_Wk': _A_in['Wk'], 'A_Wv': _A_in['Wv'], 'A_Wo': _A_in['Wo'], 'A_seg_len': _A_in['seg_len'], 'B_x': _B_in['x'], 'B_w1': _B_in['w1'], 'B_w3': _B_in['w3'], 'B_w2': _B_in['w2'], 'gate_w': _w((lambda *s: torch.randn(*s, dtype=torch.bfloat16) * 0.05)(640) * 16.0)}

def reference(A_x, A_mem0, A_Wq, A_Wk, A_Wv, A_Wo, A_seg_len, B_x, B_w1, B_w3, B_w2, gate_w):

    def _A_ref(x, mem0, Wq, Wk, Wv, Wo, seg_len):
        B, S, Dm = x.shape
        H, Dh = (Wq.shape[1], Wq.shape[2])
        M = mem0.shape[1]
        scale = Dh ** (-0.5)
        n_seg = S // seg_len
        L = M + seg_len
        idx = torch.arange(L)
        mask = (idx[:, None] < M) | (idx[:, None] >= idx[None, :])
        mem = mem0
        outs = []
        for s in range(n_seg):
            xs = x[:, s * seg_len:(s + 1) * seg_len, :].clone()
            h = torch.concatenate([mem, xs], axis=1)
            q = torch.einsum('btd,dhe->bhte', h, Wq)
            k = torch.einsum('btd,dhe->bhte', h, Wk)
            v = torch.einsum('btd,dhe->bhte', h, Wv)
            scores = torch.einsum('bhqe,bhke->bhqk', q, k) * scale
            scores = torch.where(mask[None, None], scores, -1000000000.0)
            p = _softmax(scores, axis=-1)
            o = torch.einsum('bhqk,bhke->bhqe', p, v)
            o = torch.einsum('bhte,hed->btd', o, Wo)
            mem = o[:, :M, :].clone()
            outs.append(o[:, M:, :])
        return torch.concatenate(outs, axis=1)

    def _B_ref(x, w1, w3, w2):
        gate = torch.einsum('bsd,df->bsf', x, w1)
        up = torch.einsum('bsd,df->bsf', x, w3)
        h = _silu(gate) * up
        out = torch.einsum('bsf,fd->bsd', h, w2)
        return out
    x = A_x
    g = _sigmoid((x * gate_w).sum(-1, keepdims=True))
    a = _A_ref(x, A_mem0, A_Wq, A_Wk, A_Wv, A_Wo, A_seg_len)
    b = _B_ref(x, B_w1, B_w3, B_w2)
    return g * a + (1 - g) * b
```

```asm
; @launch kernel=gated_mix__memory_aug_recurrent_mem_tr__glu_gated_swiglu__prompt_kernel grid=(256,1,1) block=(256,1,1) lds=163840
.amdgcn_target "amdgcn-amd-amdhsa--gfx950"
.text
.globl gated_mix__memory_aug_recurrent_mem_tr__glu_gated_swiglu__prompt_kernel
.p2align 8
.type gated_mix__memory_aug_recurrent_mem_tr__glu_gated_swiglu__prompt_kernel,@function
gated_mix__memory_aug_recurrent_mem_tr__glu_gated_swiglu__prompt_kernel:
  s_cmp_ge_u32 s2, 256
  s_cbranch_scc1 L_end
  s_load_dwordx2 s[4:5], s[0:1], 112
  s_getpc_b64 s[8:9]
  v_lshlrev_b32 v1, 7, v0
  v_min_u32 v2, 47076, v1
  global_load_dword v255, v2, s[8:9]
  v_add_u32 v1, 32768, v1
  v_min_u32 v2, 47076, v1
  global_load_dword v255, v2, s[8:9]
  s_mov_b32 s6, 0x10000000
  s_mov_b32 s7, 0x20000
  s_and_b32 s38, s2, 7
  s_lshr_b32 s39, s2, 3
  s_waitcnt lgkmcnt(0)
  s_mov_b32 s40, 198005
  s_mov_b32 s41, 1847326
  s_cmp_lt_u32 s38, 4
  s_cbranch_scc1 L_m_nopf
  s_cmp_lt_u32 s39, 8
  s_cbranch_scc1 L_m_nopf
  s_sub_u32 s30, s39, 12
  s_cmp_lt_u32 s30, 10
  s_cbranch_scc1 L_m_nopf
  s_cmp_lt_u32 s39, 30
  s_cbranch_scc1 L_m_pf
  s_lshl_b32 s30, s39, 2
  s_add_u32 s30, s30, s38
  s_sub_u32 s30, s30, 124
  v_lshrrev_b32 v1, 6, v0
  s_nop 0
  v_readfirstlane_b32 s29, v1
  s_load_dwordx2 s[16:17], s[0:1], 104
  s_mov_b32 s18, 256
  s_mov_b32 s19, 0x20000
  v_mov_b32 v32, 0
  s_lshl_b32 s21, s30, 21
  s_lshl_b32 s23, s29, 8
  s_add_u32 s21, s21, s23
  s_lshr_b32 s23, s29, 1
  s_lshl_b32 s23, s23, 14
  s_add_u32 s21, s21, s23
  s_add_u32 s21, s21, 2035712
  s_add_u32 s23, s21, 8192
  s_mov_b32 s24, -1
  s_mov_b32 s25, -1
  buffer_store_dword v32, off, s[4:7], s21 sc1
  s_waitcnt vmcnt(0)
  s_memtime s[26:27]
  s_waitcnt lgkmcnt(0)
  buffer_load_dword v4, off, s[4:7], s21 sc1
  s_waitcnt vmcnt(0)
  s_memtime s[36:37]
  s_waitcnt lgkmcnt(0)
  s_sub_u32 s26, s36, s26
  s_min_u32 s24, s24, s26
  buffer_store_dword v32, off, s[4:7], s23 sc1
  s_waitcnt vmcnt(0)
  s_memtime s[26:27]
  s_waitcnt lgkmcnt(0)
  buffer_load_dword v4, off, s[4:7], s23 sc1
  s_waitcnt vmcnt(0)
  s_memtime s[36:37]
  s_waitcnt lgkmcnt(0)
  s_sub_u32 s26, s36, s26
  s_min_u32 s25, s25, s26
  buffer_store_dword v32, off, s[4:7], s21 sc1
  s_waitcnt vmcnt(0)
  s_memtime s[26:27]
  s_waitcnt lgkmcnt(0)
  buffer_load_dword v4, off, s[4:7], s21 sc1
  s_waitcnt vmcnt(0)
  s_memtime s[36:37]
  s_waitcnt lgkmcnt(0)
  s_sub_u32 s26, s36, s26
  s_min_u32 s24, s24, s26
  buffer_store_dword v32, off, s[4:7], s23 sc1
  s_waitcnt vmcnt(0)
  s_memtime s[26:27]
  s_waitcnt lgkmcnt(0)
  buffer_load_dword v4, off, s[4:7], s23 sc1
  s_waitcnt vmcnt(0)
  s_memtime s[36:37]
  s_waitcnt lgkmcnt(0)
  s_sub_u32 s26, s36, s26
  s_min_u32 s25, s25, s26
  buffer_store_dword v32, off, s[4:7], s21 sc1
  s_waitcnt vmcnt(0)
  s_memtime s[26:27]
  s_waitcnt lgkmcnt(0)
  buffer_load_dword v4, off, s[4:7], s21 sc1
  s_waitcnt vmcnt(0)
  s_memtime s[36:37]
  s_waitcnt lgkmcnt(0)
  s_sub_u32 s26, s36, s26
  s_min_u32 s24, s24, s26
  buffer_store_dword v32, off, s[4:7], s23 sc1
  s_waitcnt vmcnt(0)
  s_memtime s[26:27]
  s_waitcnt lgkmcnt(0)
  buffer_load_dword v4, off, s[4:7], s23 sc1
  s_waitcnt vmcnt(0)
  s_memtime s[36:37]
  s_waitcnt lgkmcnt(0)
  s_sub_u32 s26, s36, s26
  s_min_u32 s25, s25, s26
  buffer_store_dword v32, off, s[4:7], s21 sc1
  s_waitcnt vmcnt(0)
  s_memtime s[26:27]
  s_waitcnt lgkmcnt(0)
  buffer_load_dword v4, off, s[4:7], s21 sc1
  s_waitcnt vmcnt(0)
  s_memtime s[36:37]
  s_waitcnt lgkmcnt(0)
  s_sub_u32 s26, s36, s26
  s_min_u32 s24, s24, s26
  buffer_store_dword v32, off, s[4:7], s23 sc1
  s_waitcnt vmcnt(0)
  s_memtime s[26:27]
  s_waitcnt lgkmcnt(0)
  buffer_load_dword v4, off, s[4:7], s23 sc1
  s_waitcnt vmcnt(0)
  s_memtime s[36:37]
  s_waitcnt lgkmcnt(0)
  s_sub_u32 s26, s36, s26
  s_min_u32 s25, s25, s26
  v_mov_b32 v4, s24
  v_mov_b32 v5, s25
  v_lshlrev_b32 v6, 3, v1
  ds_write_b64 v6, v[4:5]
  s_waitcnt lgkmcnt(0)
  s_barrier
  s_cmp_lg_u32 s29, 0
  s_cbranch_scc1 L_h_pd
  ds_read_b128 v[8:11], v6
  ds_read_b128 v[12:15], v6 offset:16
  s_waitcnt lgkmcnt(0)
  v_min_u32 v8, v8, v10
  v_min_u32 v9, v9, v11
  v_min_u32 v12, v12, v14
  v_min_u32 v13, v13, v15
  v_readfirstlane_b32 s24, v8
  v_readfirstlane_b32 s25, v9
  v_readfirstlane_b32 s36, v12
  v_readfirstlane_b32 s37, v13
  s_min_u32 s26, s24, s36
  s_min_u32 s27, s25, s37
  s_cmp_lt_u32 s27, s26
  s_cselect_b32 s26, 1, 0
  s_getreg_b32 s27, hwreg(HW_REG_XCC_ID)
  s_bfe_u32 s22, s27, 0x10002
  s_xor_b32 s26, s26, s22
  s_cmp_eq_u32 s26, 1
  s_cselect_b32 s24, s25, s24
  s_cselect_b32 s36, s37, s36
  s_cmp_lt_u32 s36, s24
  s_cselect_b32 s24, 0, 1
  s_or_b32 s27, s27, s22
  s_and_b32 s27, s27, 1
  s_xor_b32 s24, s24, s27
  s_lshl_b32 s26, s26, 13
  s_lshl_b32 s24, s24, 14
  s_or_b32 s26, s26, s24
  v_mov_b32 v3, s26
  s_lshl_b32 s21, s30, 2
  s_add_u32 s21, s21, 100761600
  s_mov_b64 exec, 1
  buffer_atomic_swap v3, off, s[4:7], s21
  s_waitcnt vmcnt(0)
  v_mov_b32 v5, 1
  buffer_atomic_add v5, off, s[16:19], 0 sc0
  s_waitcnt vmcnt(0)
  v_readfirstlane_b32 s21, v5
  s_cmp_lg_u32 s21, 47
  s_cbranch_scc1 L_h_pd
  buffer_atomic_swap v5, off, s[16:19], 0 offset:128
L_h_pd:
  s_mov_b64 exec, -1
  s_barrier
  s_branch L_m_nopf
L_m_pf:
  s_load_dwordx4 s[60:63], s[0:1], 16
  s_load_dwordx4 s[64:67], s[0:1], 32
  s_lshr_b32 s33, s2, 3
  s_sub_u32 s33, s33, 8
  s_lshl_b32 s33, s33, 8
  v_add_u32 v40, s33, v0
  v_lshrrev_b32 v41, 4, v40
  v_add_u32 v41, 256, v41
  v_lshlrev_b32 v41, 13, v41
  v_bfe_u32 v42, v0, 1, 3
  v_lshl_add_u32 v41, v42, 10, v41
  v_and_b32 v42, 1, v0
  v_lshl_add_u32 v41, v42, 7, v41
  s_and_b32 s34, s2, 3
  s_lshl_b32 s33, s34, 8
  v_add_u32 v41, s33, v41
  s_waitcnt lgkmcnt(0)
  global_load_dword v255, v41, s[62:63]
  global_load_dword v255, v41, s[64:65]
L_m_nopf:
  s_cmp_ge_u32 s38, 4
  s_cbranch_scc1 L_m_hi
  s_cmp_lt_u32 s39, 16
  s_cbranch_scc1 L_m_rec
  s_sub_u32 s30, s39, 16
  s_lshl_b32 s30, s30, 2
  s_add_u32 s30, s30, s38
  s_branch L_hlp
L_m_hi:
  s_sub_u32 s38, s38, 4
  s_mov_b32 s28, 0
  s_lshl_b32 s30, s39, 2
  s_add_u32 s30, s30, s38
  s_cmp_lt_u32 s39, 8
  s_cbranch_scc1 L_g1
  s_sub_u32 s30, s30, 32
  s_cmp_lt_u32 s39, 12
  s_cbranch_scc1 L_att
  s_sub_u32 s31, s30, 56
  s_lshr_b32 s28, s38, 1
  s_and_b32 s30, s38, 1
  s_mul_i32 s30, s30, 10
  s_add_u32 s30, s30, s39
  s_sub_u32 s30, s30, 12
  s_cmp_lt_u32 s39, 22
  s_cbranch_scc1 L_g3a
  s_sub_u32 s30, s39, 22
  s_cmp_eq_u32 s38, 0
  s_cbranch_scc1 L_g3b
  s_mul_i32 s30, s30, 3
  s_add_u32 s30, s30, s38
  s_sub_u32 s30, s30, 1
  s_mov_b32 s28, 2
  s_cmp_lt_u32 s30, 14
  s_cbranch_scc1 L_g1
  s_mov_b32 s28, 1
  s_sub_u32 s30, s30, 14
  s_branch L_g1
L_m_rec:
  s_lshr_b32 s28, s39, 1
  s_lshl_b32 s28, s28, 2
  s_add_u32 s28, s28, s38
  s_lshl_b32 s28, s28, 1
  s_and_b32 s39, s39, 1
  s_add_u32 s28, s28, s39
  s_load_dwordx2 s[8:9], s[0:1], 16
  s_load_dwordx2 s[12:13], s[0:1], 24
  s_load_dwordx2 s[16:17], s[0:1], 32
  s_load_dwordx2 s[44:45], s[0:1], 40
  s_load_dwordx2 s[24:25], s[0:1], 8
  s_memrealtime s[54:55]
  s_memtime s[50:51]
  s_mov_b32 s10, 5242880
  s_mov_b32 s11, 0x20000
  s_mov_b32 s14, 5242880
  s_mov_b32 s15, 0x20000
  s_mov_b32 s18, 5242880
  s_mov_b32 s19, 0x20000
  s_mov_b32 s46, 5242880
  s_mov_b32 s47, 0x20000
  s_mov_b32 s26, 10240
  s_mov_b32 s27, 0x20000
  v_lshrrev_b32 v20, 6, v0
  s_nop 0
  v_readfirstlane_b32 s29, v20
  v_and_b32 v21, 63, v0
  s_lshr_b32 s30, s28, 1
  s_and_b32 s31, s28, 1
  v_lshlrev_b32 v2, 4, v21
  v_lshrrev_b32 v23, 4, v21
  v_and_b32 v24, 1, v23
  s_lshl_b32 s38, s29, 1
  v_or_b32 v24, s38, v24
  v_lshlrev_b32 v24, 1, v24
  v_and_b32 v25, 15, v21
  v_xor_b32 v25, v25, v24
  v_lshlrev_b32 v25, 4, v25
  s_lshl_b32 s38, s29, 2
  v_add_u32 v23, s38, v23
  v_lshlrev_b32 v23, 13, v23
  s_lshl_b32 s38, s30, 8
  v_add3_u32 v22, v23, v25, s38
  v_lshrrev_b32 v23, 3, v21
  v_lshrrev_b32 v24, 2, v23
  s_and_b32 s38, s29, 1
  s_lshl_b32 s38, s38, 1
  v_or_b32 v24, s38, v24
  v_lshlrev_b32 v24, 1, v24
  v_and_b32 v25, 7, v21
  v_xor_b32 v25, v25, v24
  v_lshlrev_b32 v25, 4, v25
  s_lshl_b32 s38, s29, 3
  v_add_u32 v23, s38, v23
  v_lshlrev_b32 v23, 13, v23
  s_lshl_b32 s38, s30, 8
  s_lshl_b32 s39, s31, 7
  s_add_u32 s38, s38, s39
  v_add3_u32 v26, v23, v25, s38
  s_mul_i32 s33, s30, 163840
  s_mul_i32 s38, s31, 81920
  s_add_u32 s33, s33, s38
  s_lshl_b32 s53, s29, 10
  s_add_u32 s33, s33, s53
  s_waitcnt lgkmcnt(0)
  s_mov_b32 s32, s54
  s_mov_b32 s41, s50
  s_add_u32 m0, s53, 0
  s_mov_b32 s38, 0
  buffer_load_dwordx4 v22, s[8:11], s38 offen lds
  s_add_u32 m0, s53, 4096
  s_mov_b32 s38, 131072
  buffer_load_dwordx4 v22, s[8:11], s38 offen lds
  s_add_u32 m0, s53, 8192
  s_mov_b32 s38, 262144
  buffer_load_dwordx4 v22, s[8:11], s38 offen lds
  s_add_u32 m0, s53, 12288
  s_mov_b32 s38, 393216
  buffer_load_dwordx4 v22, s[8:11], s38 offen lds
  s_add_u32 m0, s53, 16384
  s_mov_b32 s38, 0
  buffer_load_dwordx4 v22, s[12:15], s38 offen lds
  s_add_u32 m0, s53, 20480
  s_mov_b32 s38, 131072
  buffer_load_dwordx4 v22, s[12:15], s38 offen lds
  s_add_u32 m0, s53, 24576
  s_mov_b32 s38, 262144
  buffer_load_dwordx4 v22, s[12:15], s38 offen lds
  s_add_u32 m0, s53, 28672
  s_mov_b32 s38, 393216
  buffer_load_dwordx4 v22, s[12:15], s38 offen lds
  s_add_u32 m0, s53, 32768
  s_mov_b32 s38, 0
  buffer_load_dwordx4 v26, s[16:19], s38 offen lds
  s_add_u32 m0, s53, 36864
  s_mov_b32 s38, 262144
  buffer_load_dwordx4 v26, s[16:19], s38 offen lds
  s_add_u32 m0, s53, 40960
  s_mov_b32 s38, 524288
  buffer_load_dwordx4 v22, s[8:11], s38 offen lds
  s_add_u32 m0, s53, 45056
  s_mov_b32 s38, 655360
  buffer_load_dwordx4 v22, s[8:11], s38 offen lds
  s_add_u32 m0, s53, 49152
  s_mov_b32 s38, 786432
  buffer_load_dwordx4 v22, s[8:11], s38 offen lds
  s_add_u32 m0, s53, 53248
  s_mov_b32 s38, 917504
  buffer_load_dwordx4 v22, s[8:11], s38 offen lds
  s_add_u32 m0, s53, 57344
  s_mov_b32 s38, 524288
  buffer_load_dwordx4 v22, s[12:15], s38 offen lds
  s_add_u32 m0, s53, 61440
  s_mov_b32 s38, 655360
  buffer_load_dwordx4 v22, s[12:15], s38 offen lds
  s_add_u32 m0, s53, 65536
  s_mov_b32 s38, 786432
  buffer_load_dwordx4 v22, s[12:15], s38 offen lds
  s_add_u32 m0, s53, 69632
  s_mov_b32 s38, 917504
  buffer_load_dwordx4 v22, s[12:15], s38 offen lds
  s_add_u32 m0, s53, 73728
  s_mov_b32 s38, 524288
  buffer_load_dwordx4 v26, s[16:19], s38 offen lds
  s_add_u32 m0, s53, 77824
  s_mov_b32 s38, 786432
  buffer_load_dwordx4 v26, s[16:19], s38 offen lds
  s_add_u32 m0, s53, 81920
  s_mov_b32 s38, 1048576
  buffer_load_dwordx4 v22, s[8:11], s38 offen lds
  s_add_u32 m0, s53, 86016
  s_mov_b32 s38, 1179648
  buffer_load_dwordx4 v22, s[8:11], s38 offen lds
  s_add_u32 m0, s53, 90112
  s_mov_b32 s38, 1310720
  buffer_load_dwordx4 v22, s[8:11], s38 offen lds
  s_add_u32 m0, s53, 94208
  s_mov_b32 s38, 1441792
  buffer_load_dwordx4 v22, s[8:11], s38 offen lds
  s_add_u32 m0, s53, 98304
  s_mov_b32 s38, 1048576
  buffer_load_dwordx4 v22, s[12:15], s38 offen lds
  s_add_u32 m0, s53, 102400
  s_mov_b32 s38, 1179648
  buffer_load_dwordx4 v22, s[12:15], s38 offen lds
  s_add_u32 m0, s53, 106496
  s_mov_b32 s38, 1310720
  buffer_load_dwordx4 v22, s[12:15], s38 offen lds
  s_add_u32 m0, s53, 110592
  s_mov_b32 s38, 1441792
  buffer_load_dwordx4 v22, s[12:15], s38 offen lds
  s_add_u32 m0, s53, 114688
  s_mov_b32 s38, 1048576
  buffer_load_dwordx4 v26, s[16:19], s38 offen lds
  s_add_u32 m0, s53, 118784
  s_mov_b32 s38, 1310720
  buffer_load_dwordx4 v26, s[16:19], s38 offen lds
  v_lshrrev_b32 v23, 5, v21
  v_bfe_u32 v24, v21, 4, 1
  v_bfe_u32 v25, v21, 2, 1
  v_bfe_u32 v27, v21, 3, 1
  v_lshlrev_b32 v28, 4, v23
  v_lshl_add_u32 v28, v24, 2, v28
  v_add_u32 v28, v28, v25
  v_lshl_add_u32 v28, v27, 3, v28
  v_lshl_add_u32 v29, v24, 1, v25
  v_lshl_add_u32 v29, v27, 2, v29
  v_and_b32 v30, 3, v21
  v_lshlrev_b32 v30, 3, v30
  s_lshl_b32 s38, s29, 1
  v_xor_b32 v31, s38, v29
  v_lshlrev_b32 v31, 5, v31
  v_lshl_add_u32 v31, v28, 8, v31
  v_add_u32 v31, v31, v30
  v_xor_b32 v32, 32, v31
  v_lshrrev_b32 v33, 1, v29
  v_xor_b32 v33, s29, v33
  v_lshlrev_b32 v33, 5, v33
  v_lshl_add_u32 v33, v28, 7, v33
  v_add_u32 v33, v33, v30
  v_lshlrev_b32 v34, 4, v24
  v_lshl_add_u32 v34, v23, 2, v34
  v_add_u32 v34, v34, v25
  v_mul_u32_u24 v34, 1280, v34
  v_lshl_add_u32 v35, v30, 1, v34
  v_lshl_add_u32 v35, v27, 6, v35
  s_lshl_b32 s38, s29, 7
  v_add_u32 v35, s38, v35
  v_add_u32 v36, v34, v30
  v_lshl_add_u32 v36, v27, 5, v36
  s_lshl_b32 s38, s29, 6
  v_add_u32 v36, s38, v36
  s_mul_i32 s38, s29, 20480
  v_add_u32 v13, s38, v2
  s_load_dwordx2 s[20:21], s[0:1], 104
  s_mov_b32 s22, 256
  s_mov_b32 s23, 0x20000
  s_add_u32 s62, s30, 64
  s_lshl_b32 s62, s62, 7
  s_add_u32 s62, s62, 100663296
  v_and_b32 v108, 0x70, v2
  v_mul_u32_u24 v108, 80, v108
  v_lshrrev_b32 v109, 7, v2
  v_lshl_add_u32 v108, v109, 4, v108
  s_lshl_b32 s63, s29, 7
  s_and_b32 s64, s63, 128
  s_waitcnt vmcnt(20)
  s_barrier
  s_add_u32 m0, s53, 122880
  s_mov_b32 s38, 1572864
  buffer_load_dwordx4 v22, s[8:11], s38 offen lds
  s_add_u32 m0, s53, 126976
  s_mov_b32 s38, 1703936
  buffer_load_dwordx4 v22, s[8:11], s38 offen lds
  s_add_u32 m0, s53, 131072
  s_mov_b32 s38, 1835008
  buffer_load_dwordx4 v22, s[8:11], s38 offen lds
  s_add_u32 m0, s53, 135168
  s_mov_b32 s38, 1966080
  buffer_load_dwordx4 v22, s[8:11], s38 offen lds
  s_add_u32 m0, s53, 139264
  s_mov_b32 s38, 1572864
  buffer_load_dwordx4 v22, s[12:15], s38 offen lds
  s_add_u32 m0, s53, 143360
  s_mov_b32 s38, 1703936
  buffer_load_dwordx4 v22, s[12:15], s38 offen lds
  s_add_u32 m0, s53, 147456
  s_mov_b32 s38, 1835008
  buffer_load_dwordx4 v22, s[12:15], s38 offen lds
  s_add_u32 m0, s53, 151552
  s_mov_b32 s38, 1966080
  buffer_load_dwordx4 v22, s[12:15], s38 offen lds
  s_add_u32 m0, s53, 155648
  s_mov_b32 s38, 1572864
  buffer_load_dwordx4 v26, s[16:19], s38 offen lds
  s_add_u32 m0, s53, 159744
  s_mov_b32 s38, 1835008
  buffer_load_dwordx4 v26, s[16:19], s38 offen lds
  v_add_u32 v38, 0, v31
  v_add_u32 v39, 0, v32
  v_add_u32 v40, 32768, v33
  ds_read_b64_tr_b16 a[0:1], v38 offset:0
  ds_read_b64_tr_b16 a[160:161], v38 offset:16384
  ds_read_b64_tr_b16 a[80:81], v39 offset:0
  ds_read_b64_tr_b16 a[240:241], v39 offset:16384
  ds_read_b64_tr_b16 v[176:177], v40 offset:0
  ds_read_b64_tr_b16 a[2:3], v38 offset:512
  ds_read_b64_tr_b16 a[162:163], v38 offset:16896
  ds_read_b64_tr_b16 a[82:83], v39 offset:512
  ds_read_b64_tr_b16 a[242:243], v39 offset:16896
  ds_read_b64_tr_b16 v[178:179], v40 offset:256
  s_waitcnt lgkmcnt(0)
  ds_read_b64_tr_b16 a[4:5], v38 offset:8192
  ds_read_b64_tr_b16 a[164:165], v38 offset:24576
  ds_read_b64_tr_b16 a[84:85], v39 offset:8192
  ds_read_b64_tr_b16 a[244:245], v39 offset:24576
  ds_read_b64_tr_b16 v[180:181], v40 offset:4096
  ds_read_b64_tr_b16 a[6:7], v38 offset:8704
  ds_read_b64_tr_b16 a[166:167], v38 offset:25088
  ds_read_b64_tr_b16 a[86:87], v39 offset:8704
  ds_read_b64_tr_b16 a[246:247], v39 offset:25088
  ds_read_b64_tr_b16 v[182:183], v40 offset:4352
  s_waitcnt lgkmcnt(0)
  s_waitcnt vmcnt(20)
  s_barrier
  s_add_u32 m0, s53, 0
  s_mov_b32 s38, 2097152
  buffer_load_dwordx4 v22, s[8:11], s38 offen lds
  s_add_u32 m0, s53, 4096
  s_mov_b32 s38, 2228224
  buffer_load_dwordx4 v22, s[8:11], s38 offen lds
  s_add_u32 m0, s53, 8192
  s_mov_b32 s38, 2359296
  buffer_load_dwordx4 v22, s[8:11], s38 offen lds
  s_add_u32 m0, s53, 12288
  s_mov_b32 s38, 2490368
  buffer_load_dwordx4 v22, s[8:11], s38 offen lds
  s_add_u32 m0, s53, 16384
  s_mov_b32 s38, 2097152
  buffer_load_dwordx4 v22, s[12:15], s38 offen lds
  s_add_u32 m0, s53, 20480
  s_mov_b32 s38, 2228224
  buffer_load_dwordx4 v22, s[12:15], s38 offen lds
  s_add_u32 m0, s53, 24576
  s_mov_b32 s38, 2359296
  buffer_load_dwordx4 v22, s[12:15], s38 offen lds
  s_add_u32 m0, s53, 28672
  s_mov_b32 s38, 2490368
  buffer_load_dwordx4 v22, s[12:15], s38 offen lds
  s_add_u32 m0, s53, 32768
  s_mov_b32 s38, 2097152
  buffer_load_dwordx4 v26, s[16:19], s38 offen lds
  s_add_u32 m0, s53, 36864
  s_mov_b32 s38, 2359296
  buffer_load_dwordx4 v26, s[16:19], s38 offen lds
  v_add_u32 v38, 40960, v31
  v_add_u32 v39, 40960, v32
  v_add_u32 v40, 73728, v33
  ds_read_b64_tr_b16 a[8:9], v38 offset:0
  ds_read_b64_tr_b16 a[168:169], v38 offset:16384
  ds_read_b64_tr_b16 a[88:89], v39 offset:0
  ds_read_b64_tr_b16 a[248:249], v39 offset:16384
  ds_read_b64_tr_b16 v[184:185], v40 offset:0
  ds_read_b64_tr_b16 a[10:11], v38 offset:512
  ds_read_b64_tr_b16 a[170:171], v38 offset:16896
  ds_read_b64_tr_b16 a[90:91], v39 offset:512
  ds_read_b64_tr_b16 a[250:251], v39 offset:16896
  ds_read_b64_tr_b16 v[186:187], v40 offset:256
  s_waitcnt lgkmcnt(0)
  ds_read_b64_tr_b16 a[12:13], v38 offset:8192
  ds_read_b64_tr_b16 a[172:173], v38 offset:24576
  ds_read_b64_tr_b16 a[92:93], v39 offset:8192
  ds_read_b64_tr_b16 a[252:253], v39 offset:24576
  ds_read_b64_tr_b16 v[188:189], v40 offset:4096
  ds_read_b64_tr_b16 a[14:15], v38 offset:8704
  ds_read_b64_tr_b16 a[174:175], v38 offset:25088
  ds_read_b64_tr_b16 a[94:95], v39 offset:8704
  ds_read_b64_tr_b16 a[254:255], v39 offset:25088
  ds_read_b64_tr_b16 v[190:191], v40 offset:4352
  s_waitcnt lgkmcnt(0)
  s_waitcnt vmcnt(20)
  s_barrier
  s_add_u32 m0, s53, 40960
  s_mov_b32 s38, 2621440
  buffer_load_dwordx4 v22, s[8:11], s38 offen lds
  s_add_u32 m0, s53, 45056
  s_mov_b32 s38, 2752512
  buffer_load_dwordx4 v22, s[8:11], s38 offen lds
  s_add_u32 m0, s53, 49152
  s_mov_b32 s38, 2883584
  buffer_load_dwordx4 v22, s[8:11], s38 offen lds
  s_add_u32 m0, s53, 53248
  s_mov_b32 s38, 3014656
  buffer_load_dwordx4 v22, s[8:11], s38 offen lds
  s_add_u32 m0, s53, 57344
  s_mov_b32 s38, 2621440
  buffer_load_dwordx4 v22, s[12:15], s38 offen lds
  s_add_u32 m0, s53, 61440
  s_mov_b32 s38, 2752512
  buffer_load_dwordx4 v22, s[12:15], s38 offen lds
  s_add_u32 m0, s53, 65536
  s_mov_b32 s38, 2883584
  buffer_load_dwordx4 v22, s[12:15], s38 offen lds
  s_add_u32 m0, s53, 69632
  s_mov_b32 s38, 3014656
  buffer_load_dwordx4 v22, s[12:15], s38 offen lds
  s_add_u32 m0, s53, 73728
  s_mov_b32 s38, 2621440
  buffer_load_dwordx4 v26, s[16:19], s38 offen lds
  s_add_u32 m0, s53, 77824
  s_mov_b32 s38, 2883584
  buffer_load_dwordx4 v26, s[16:19], s38 offen lds
  v_add_u32 v38, 81920, v31
  v_add_u32 v39, 81920, v32
  v_add_u32 v40, 114688, v33
  ds_read_b64_tr_b16 a[16:17], v38 offset:0
  ds_read_b64_tr_b16 a[176:177], v38 offset:16384
  ds_read_b64_tr_b16 a[96:97], v39 offset:0
  ds_read_b64_tr_b16 v[112:113], v39 offset:16384
  ds_read_b64_tr_b16 v[192:193], v40 offset:0
  ds_read_b64_tr_b16 a[18:19], v38 offset:512
  ds_read_b64_tr_b16 a[178:179], v38 offset:16896
  ds_read_b64_tr_b16 a[98:99], v39 offset:512
  ds_read_b64_tr_b16 v[114:115], v39 offset:16896
  ds_read_b64_tr_b16 v[194:195], v40 offset:256
  s_waitcnt lgkmcnt(0)
  ds_read_b64_tr_b16 a[20:21], v38 offset:8192
  ds_read_b64_tr_b16 a[180:181], v38 offset:24576
  ds_read_b64_tr_b16 a[100:101], v39 offset:8192
  ds_read_b64_tr_b16 v[116:117], v39 offset:24576
  ds_read_b64_tr_b16 v[196:197], v40 offset:4096
  ds_read_b64_tr_b16 a[22:23], v38 offset:8704
  ds_read_b64_tr_b16 a[182:183], v38 offset:25088
  ds_read_b64_tr_b16 a[102:103], v39 offset:8704
  ds_read_b64_tr_b16 v[118:119], v39 offset:25088
  ds_read_b64_tr_b16 v[198:199], v40 offset:4352
  s_waitcnt lgkmcnt(0)
  s_waitcnt vmcnt(20)
  s_barrier
  s_add_u32 m0, s53, 81920
  s_mov_b32 s38, 3145728
  buffer_load_dwordx4 v22, s[8:11], s38 offen lds
  s_add_u32 m0, s53, 86016
  s_mov_b32 s38, 3276800
  buffer_load_dwordx4 v22, s[8:11], s38 offen lds
  s_add_u32 m0, s53, 90112
  s_mov_b32 s38, 3407872
  buffer_load_dwordx4 v22, s[8:11], s38 offen lds
  s_add_u32 m0, s53, 94208
  s_mov_b32 s38, 3538944
  buffer_load_dwordx4 v22, s[8:11], s38 offen lds
  s_add_u32 m0, s53, 98304
  s_mov_b32 s38, 3145728
  buffer_load_dwordx4 v22, s[12:15], s38 offen lds
  s_add_u32 m0, s53, 102400
  s_mov_b32 s38, 3276800
  buffer_load_dwordx4 v22, s[12:15], s38 offen lds
  s_add_u32 m0, s53, 106496
  s_mov_b32 s38, 3407872
  buffer_load_dwordx4 v22, s[12:15], s38 offen lds
  s_add_u32 m0, s53, 110592
  s_mov_b32 s38, 3538944
  buffer_load_dwordx4 v22, s[12:15], s38 offen lds
  s_add_u32 m0, s53, 114688
  s_mov_b32 s38, 3145728
  buffer_load_dwordx4 v26, s[16:19], s38 offen lds
  s_add_u32 m0, s53, 118784
  s_mov_b32 s38, 3407872
  buffer_load_dwordx4 v26, s[16:19], s38 offen lds
  v_add_u32 v38, 122880, v31
  v_add_u32 v39, 122880, v32
  v_add_u32 v40, 155648, v33
  ds_read_b64_tr_b16 a[24:25], v38 offset:0
  ds_read_b64_tr_b16 a[184:185], v38 offset:16384
  ds_read_b64_tr_b16 a[104:105], v39 offset:0
  ds_read_b64_tr_b16 v[120:121], v39 offset:16384
  ds_read_b64_tr_b16 v[200:201], v40 offset:0
  ds_read_b64_tr_b16 a[26:27], v38 offset:512
  ds_read_b64_tr_b16 a[186:187], v38 offset:16896
  ds_read_b64_tr_b16 a[106:107], v39 offset:512
  ds_read_b64_tr_b16 v[122:123], v39 offset:16896
  ds_read_b64_tr_b16 v[202:203], v40 offset:256
  s_waitcnt lgkmcnt(0)
  ds_read_b64_tr_b16 a[28:29], v38 offset:8192
  ds_read_b64_tr_b16 a[188:189], v38 offset:24576
  ds_read_b64_tr_b16 a[108:109], v39 offset:8192
  ds_read_b64_tr_b16 v[124:125], v39 offset:24576
  ds_read_b64_tr_b16 v[204:205], v40 offset:4096
  ds_read_b64_tr_b16 a[30:31], v38 offset:8704
  ds_read_b64_tr_b16 a[190:191], v38 offset:25088
  ds_read_b64_tr_b16 a[110:111], v39 offset:8704
  ds_read_b64_tr_b16 v[126:127], v39 offset:25088
  ds_read_b64_tr_b16 v[206:207], v40 offset:4352
  s_waitcnt lgkmcnt(0)
  s_waitcnt vmcnt(20)
  s_barrier
  s_add_u32 m0, s53, 122880
  s_mov_b32 s38, 3670016
  buffer_load_dwordx4 v22, s[8:11], s38 offen lds
  s_add_u32 m0, s53, 126976
  s_mov_b32 s38, 3801088
  buffer_load_dwordx4 v22, s[8:11], s38 offen lds
  s_add_u32 m0, s53, 131072
  s_mov_b32 s38, 3932160
  buffer_load_dwordx4 v22, s[8:11], s38 offen lds
  s_add_u32 m0, s53, 135168
  s_mov_b32 s38, 4063232
  buffer_load_dwordx4 v22, s[8:11], s38 offen lds
  s_add_u32 m0, s53, 139264
  s_mov_b32 s38, 3670016
  buffer_load_dwordx4 v22, s[12:15], s38 offen lds
  s_add_u32 m0, s53, 143360
  s_mov_b32 s38, 3801088
  buffer_load_dwordx4 v22, s[12:15], s38 offen lds
  s_add_u32 m0, s53, 147456
  s_mov_b32 s38, 3932160
  buffer_load_dwordx4 v22, s[12:15], s38 offen lds
  s_add_u32 m0, s53, 151552
  s_mov_b32 s38, 4063232
  buffer_load_dwordx4 v22, s[12:15], s38 offen lds
  s_add_u32 m0, s53, 155648
  s_mov_b32 s38, 3670016
  buffer_load_dwordx4 v26, s[16:19], s38 offen lds
  s_add_u32 m0, s53, 159744
  s_mov_b32 s38, 3932160
  buffer_load_dwordx4 v26, s[16:19], s38 offen lds
  v_add_u32 v38, 0, v31
  v_add_u32 v39, 0, v32
  v_add_u32 v40, 32768, v33
  ds_read_b64_tr_b16 a[32:33], v38 offset:0
  ds_read_b64_tr_b16 a[192:193], v38 offset:16384
  ds_read_b64_tr_b16 a[112:113], v39 offset:0
  ds_read_b64_tr_b16 v[128:129], v39 offset:16384
  ds_read_b64_tr_b16 v[208:209], v40 offset:0
  ds_read_b64_tr_b16 a[34:35], v38 offset:512
  ds_read_b64_tr_b16 a[194:195], v38 offset:16896
  ds_read_b64_tr_b16 a[114:115], v39 offset:512
  ds_read_b64_tr_b16 v[130:131], v39 offset:16896
  ds_read_b64_tr_b16 v[210:211], v40 offset:256
  s_waitcnt lgkmcnt(0)
  ds_read_b64_tr_b16 a[36:37], v38 offset:8192
  ds_read_b64_tr_b16 a[196:197], v38 offset:24576
  ds_read_b64_tr_b16 a[116:117], v39 offset:8192
  ds_read_b64_tr_b16 v[132:133], v39 offset:24576
  ds_read_b64_tr_b16 v[212:213], v40 offset:4096
  ds_read_b64_tr_b16 a[38:39], v38 offset:8704
  ds_read_b64_tr_b16 a[198:199], v38 offset:25088
  ds_read_b64_tr_b16 a[118:119], v39 offset:8704
  ds_read_b64_tr_b16 v[134:135], v39 offset:25088
  ds_read_b64_tr_b16 v[214:215], v40 offset:4352
  s_waitcnt lgkmcnt(0)
  s_waitcnt vmcnt(20)
  s_barrier
  s_add_u32 m0, s53, 0
  s_mov_b32 s38, 4194304
  buffer_load_dwordx4 v22, s[8:11], s38 offen lds
  s_add_u32 m0, s53, 4096
  s_mov_b32 s38, 4325376
  buffer_load_dwordx4 v22, s[8:11], s38 offen lds
  s_add_u32 m0, s53, 8192
  s_mov_b32 s38, 4456448
  buffer_load_dwordx4 v22, s[8:11], s38 offen lds
  s_add_u32 m0, s53, 12288
  s_mov_b32 s38, 4587520
  buffer_load_dwordx4 v22, s[8:11], s38 offen lds
  s_add_u32 m0, s53, 16384
  s_mov_b32 s38, 4194304
  buffer_load_dwordx4 v22, s[12:15], s38 offen lds
  s_add_u32 m0, s53, 20480
  s_mov_b32 s38, 4325376
  buffer_load_dwordx4 v22, s[12:15], s38 offen lds
  s_add_u32 m0, s53, 24576
  s_mov_b32 s38, 4456448
  buffer_load_dwordx4 v22, s[12:15], s38 offen lds
  s_add_u32 m0, s53, 28672
  s_mov_b32 s38, 4587520
  buffer_load_dwordx4 v22, s[12:15], s38 offen lds
  s_add_u32 m0, s53, 32768
  s_mov_b32 s38, 4194304
  buffer_load_dwordx4 v26, s[16:19], s38 offen lds
  s_add_u32 m0, s53, 36864
  s_mov_b32 s38, 4456448
  buffer_load_dwordx4 v26, s[16:19], s38 offen lds
  v_add_u32 v38, 40960, v31
  v_add_u32 v39, 40960, v32
  v_add_u32 v40, 73728, v33
  ds_read_b64_tr_b16 a[40:41], v38 offset:0
  ds_read_b64_tr_b16 a[200:201], v38 offset:16384
  ds_read_b64_tr_b16 a[120:121], v39 offset:0
  ds_read_b64_tr_b16 v[136:137], v39 offset:16384
  ds_read_b64_tr_b16 v[216:217], v40 offset:0
  ds_read_b64_tr_b16 a[42:43], v38 offset:512
  ds_read_b64_tr_b16 a[202:203], v38 offset:16896
  ds_read_b64_tr_b16 a[122:123], v39 offset:512
  ds_read_b64_tr_b16 v[138:139], v39 offset:16896
  ds_read_b64_tr_b16 v[218:219], v40 offset:256
  s_waitcnt lgkmcnt(0)
  ds_read_b64_tr_b16 a[44:45], v38 offset:8192
  ds_read_b64_tr_b16 a[204:205], v38 offset:24576
  ds_read_b64_tr_b16 a[124:125], v39 offset:8192
  ds_read_b64_tr_b16 v[140:141], v39 offset:24576
  ds_read_b64_tr_b16 v[220:221], v40 offset:4096
  ds_read_b64_tr_b16 a[46:47], v38 offset:8704
  ds_read_b64_tr_b16 a[206:207], v38 offset:25088
  ds_read_b64_tr_b16 a[126:127], v39 offset:8704
  ds_read_b64_tr_b16 v[142:143], v39 offset:25088
  ds_read_b64_tr_b16 v[222:223], v40 offset:4352
  s_waitcnt lgkmcnt(0)
  s_waitcnt vmcnt(20)
  s_barrier
  s_add_u32 m0, s53, 40960
  s_mov_b32 s38, 4718592
  buffer_load_dwordx4 v22, s[8:11], s38 offen lds
  s_add_u32 m0, s53, 45056
  s_mov_b32 s38, 4849664
  buffer_load_dwordx4 v22, s[8:11], s38 offen lds
  s_add_u32 m0, s53, 49152
  s_mov_b32 s38, 4980736
  buffer_load_dwordx4 v22, s[8:11], s38 offen lds
  s_add_u32 m0, s53, 53248
  s_mov_b32 s38, 5111808
  buffer_load_dwordx4 v22, s[8:11], s38 offen lds
  s_add_u32 m0, s53, 57344
  s_mov_b32 s38, 4718592
  buffer_load_dwordx4 v22, s[12:15], s38 offen lds
  s_add_u32 m0, s53, 61440
  s_mov_b32 s38, 4849664
  buffer_load_dwordx4 v22, s[12:15], s38 offen lds
  s_add_u32 m0, s53, 65536
  s_mov_b32 s38, 4980736
  buffer_load_dwordx4 v22, s[12:15], s38 offen lds
  s_add_u32 m0, s53, 69632
  s_mov_b32 s38, 5111808
  buffer_load_dwordx4 v22, s[12:15], s38 offen lds
  s_add_u32 m0, s53, 73728
  s_mov_b32 s38, 4718592
  buffer_load_dwordx4 v26, s[16:19], s38 offen lds
  s_add_u32 m0, s53, 77824
  s_mov_b32 s38, 4980736
  buffer_load_dwordx4 v26, s[16:19], s38 offen lds
  v_add_u32 v38, 81920, v31
  v_add_u32 v39, 81920, v32
  v_add_u32 v40, 114688, v33
  ds_read_b64_tr_b16 a[48:49], v38 offset:0
  ds_read_b64_tr_b16 a[208:209], v38 offset:16384
  ds_read_b64_tr_b16 a[128:129], v39 offset:0
  ds_read_b64_tr_b16 v[144:145], v39 offset:16384
  ds_read_b64_tr_b16 v[224:225], v40 offset:0
  ds_read_b64_tr_b16 a[50:51], v38 offset:512
  ds_read_b64_tr_b16 a[210:211], v38 offset:16896
  ds_read_b64_tr_b16 a[130:131], v39 offset:512
  ds_read_b64_tr_b16 v[146:147], v39 offset:16896
  ds_read_b64_tr_b16 v[226:227], v40 offset:256
  s_waitcnt lgkmcnt(0)
  ds_read_b64_tr_b16 a[52:53], v38 offset:8192
  ds_read_b64_tr_b16 a[212:213], v38 offset:24576
  ds_read_b64_tr_b16 a[132:133], v39 offset:8192
  ds_read_b64_tr_b16 v[148:149], v39 offset:24576
  ds_read_b64_tr_b16 v[228:229], v40 offset:4096
  ds_read_b64_tr_b16 a[54:55], v38 offset:8704
  ds_read_b64_tr_b16 a[214:215], v38 offset:25088
  ds_read_b64_tr_b16 a[134:135], v39 offset:8704
  ds_read_b64_tr_b16 v[150:151], v39 offset:25088
  ds_read_b64_tr_b16 v[230:231], v40 offset:4352
  s_waitcnt lgkmcnt(0)
  s_waitcnt vmcnt(20)
  s_barrier
  s_add_u32 m0, s53, 81920
  s_add_u32 s38, s33, 0
  buffer_load_dwordx4 v2, s[44:47], s38 offen lds
  s_add_u32 m0, s53, 86016
  s_add_u32 s38, s33, 4096
  buffer_load_dwordx4 v2, s[44:47], s38 offen lds
  s_add_u32 m0, s53, 90112
  s_add_u32 s38, s33, 8192
  buffer_load_dwordx4 v2, s[44:47], s38 offen lds
  s_add_u32 m0, s53, 94208
  s_add_u32 s38, s33, 12288
  buffer_load_dwordx4 v2, s[44:47], s38 offen lds
  s_add_u32 m0, s53, 98304
  s_add_u32 s38, s33, 16384
  buffer_load_dwordx4 v2, s[44:47], s38 offen lds
  s_add_u32 m0, s53, 102400
  s_add_u32 s38, s33, 20480
  buffer_load_dwordx4 v2, s[44:47], s38 offen lds
  s_add_u32 m0, s53, 106496
  s_add_u32 s38, s33, 24576
  buffer_load_dwordx4 v2, s[44:47], s38 offen lds
  s_add_u32 m0, s53, 110592
  s_add_u32 s38, s33, 28672
  buffer_load_dwordx4 v2, s[44:47], s38 offen lds
  s_add_u32 m0, s53, 114688
  s_add_u32 s38, s33, 32768
  buffer_load_dwordx4 v2, s[44:47], s38 offen lds
  s_add_u32 m0, s53, 118784
  s_add_u32 s38, s33, 36864
  buffer_load_dwordx4 v2, s[44:47], s38 offen lds
  v_add_u32 v38, 122880, v31
  v_add_u32 v39, 122880, v32
  v_add_u32 v40, 155648, v33
  ds_read_b64_tr_b16 a[56:57], v38 offset:0
  ds_read_b64_tr_b16 a[216:217], v38 offset:16384
  ds_read_b64_tr_b16 a[136:137], v39 offset:0
  ds_read_b64_tr_b16 v[152:153], v39 offset:16384
  ds_read_b64_tr_b16 v[232:233], v40 offset:0
  ds_read_b64_tr_b16 a[58:59], v38 offset:512
  ds_read_b64_tr_b16 a[218:219], v38 offset:16896
  ds_read_b64_tr_b16 a[138:139], v39 offset:512
  ds_read_b64_tr_b16 v[154:155], v39 offset:16896
  ds_read_b64_tr_b16 v[234:235], v40 offset:256
  s_waitcnt lgkmcnt(0)
  ds_read_b64_tr_b16 a[60:61], v38 offset:8192
  ds_read_b64_tr_b16 a[220:221], v38 offset:24576
  ds_read_b64_tr_b16 a[140:141], v39 offset:8192
  ds_read_b64_tr_b16 v[156:157], v39 offset:24576
  ds_read_b64_tr_b16 v[236:237], v40 offset:4096
  ds_read_b64_tr_b16 a[62:63], v38 offset:8704
  ds_read_b64_tr_b16 a[222:223], v38 offset:25088
  ds_read_b64_tr_b16 a[142:143], v39 offset:8704
  ds_read_b64_tr_b16 v[158:159], v39 offset:25088
  ds_read_b64_tr_b16 v[238:239], v40 offset:4352
  s_waitcnt lgkmcnt(0)
  s_waitcnt vmcnt(20)
  s_barrier
  buffer_load_dword v93, off, s[20:23], 0 offset:128 sc1
  buffer_load_dwordx4 v[96:99], v108, s[24:27], s63 offen
  buffer_load_dwordx4 v[100:103], v108, s[24:27], s63 offen offset:512
  buffer_load_dwordx4 v[104:107], v108, s[24:27], s64 offen offset:1024
  s_add_u32 m0, s53, 122880
  s_add_u32 s38, s33, 40960
  buffer_load_dwordx4 v2, s[44:47], s38 offen lds
  s_add_u32 m0, s53, 126976
  s_add_u32 s38, s33, 45056
  buffer_load_dwordx4 v2, s[44:47], s38 offen lds
  s_add_u32 m0, s53, 131072
  s_add_u32 s38, s33, 49152
  buffer_load_dwordx4 v2, s[44:47], s38 offen lds
  s_add_u32 m0, s53, 135168
  s_add_u32 s38, s33, 53248
  buffer_load_dwordx4 v2, s[44:47], s38 offen lds
  s_add_u32 m0, s53, 139264
  s_add_u32 s38, s33, 57344
  buffer_load_dwordx4 v2, s[44:47], s38 offen lds
  s_add_u32 m0, s53, 143360
  s_add_u32 s38, s33, 61440
  buffer_load_dwordx4 v2, s[44:47], s38 offen lds
  s_add_u32 m0, s53, 147456
  s_add_u32 s38, s33, 65536
  buffer_load_dwordx4 v2, s[44:47], s38 offen lds
  s_add_u32 m0, s53, 151552
  s_add_u32 s38, s33, 69632
  buffer_load_dwordx4 v2, s[44:47], s38 offen lds
  s_add_u32 m0, s53, 155648
  s_add_u32 s38, s33, 73728
  buffer_load_dwordx4 v2, s[44:47], s38 offen lds
  s_add_u32 m0, s53, 159744
  s_add_u32 s38, s33, 77824
  buffer_load_dwordx4 v2, s[44:47], s38 offen lds
  v_add_u32 v38, 0, v31
  v_add_u32 v39, 0, v32
  v_add_u32 v40, 32768, v33
  ds_read_b64_tr_b16 a[64:65], v38 offset:0
  ds_read_b64_tr_b16 a[224:225], v38 offset:16384
  ds_read_b64_tr_b16 a[144:145], v39 offset:0
  ds_read_b64_tr_b16 v[160:161], v39 offset:16384
  ds_read_b64_tr_b16 v[240:241], v40 offset:0
  ds_read_b64_tr_b16 a[66:67], v38 offset:512
  ds_read_b64_tr_b16 a[226:227], v38 offset:16896
  ds_read_b64_tr_b16 a[146:147], v39 offset:512
  ds_read_b64_tr_b16 v[162:163], v39 offset:16896
  ds_read_b64_tr_b16 v[242:243], v40 offset:256
  s_waitcnt lgkmcnt(0)
  ds_read_b64_tr_b16 a[68:69], v38 offset:8192
  ds_read_b64_tr_b16 a[228:229], v38 offset:24576
  ds_read_b64_tr_b16 a[148:149], v39 offset:8192
  ds_read_b64_tr_b16 v[164:165], v39 offset:24576
  ds_read_b64_tr_b16 v[244:245], v40 offset:4096
  ds_read_b64_tr_b16 a[70:71], v38 offset:8704
  ds_read_b64_tr_b16 a[230:231], v38 offset:25088
  ds_read_b64_tr_b16 a[150:151], v39 offset:8704
  ds_read_b64_tr_b16 v[166:167], v39 offset:25088
  ds_read_b64_tr_b16 v[246:247], v40 offset:4352
  s_waitcnt lgkmcnt(0)
  s_waitcnt vmcnt(20)
  s_barrier
  v_add_u32 v38, 40960, v31
  v_add_u32 v39, 40960, v32
  v_add_u32 v40, 73728, v33
  ds_read_b64_tr_b16 a[72:73], v38 offset:0
  ds_read_b64_tr_b16 a[232:233], v38 offset:16384
  ds_read_b64_tr_b16 a[152:153], v39 offset:0
  ds_read_b64_tr_b16 v[168:169], v39 offset:16384
  ds_read_b64_tr_b16 v[248:249], v40 offset:0
  ds_read_b64_tr_b16 a[74:75], v38 offset:512
  ds_read_b64_tr_b16 a[234:235], v38 offset:16896
  ds_read_b64_tr_b16 a[154:155], v39 offset:512
  ds_read_b64_tr_b16 v[170:171], v39 offset:16896
  ds_read_b64_tr_b16 v[250:251], v40 offset:256
  s_waitcnt lgkmcnt(0)
  ds_read_b64_tr_b16 a[76:77], v38 offset:8192
  ds_read_b64_tr_b16 a[236:237], v38 offset:24576
  ds_read_b64_tr_b16 a[156:157], v39 offset:8192
  ds_read_b64_tr_b16 v[172:173], v39 offset:24576
  ds_read_b64_tr_b16 v[252:253], v40 offset:4096
  ds_read_b64_tr_b16 a[78:79], v38 offset:8704
  ds_read_b64_tr_b16 a[238:239], v38 offset:25088
  ds_read_b64_tr_b16 a[158:159], v39 offset:8704
  ds_read_b64_tr_b16 v[174:175], v39 offset:25088
  ds_read_b64_tr_b16 v[254:255], v40 offset:4352
  s_waitcnt lgkmcnt(0)
  s_waitcnt vmcnt(10)
  v_cmp_eq_u32 vcc, 0, v93
  s_mov_b32 s65, 0
  s_cbranch_vccnz L_rec_nofast
  s_mov_b32 s65, 1
  s_mov_b32 s38, 100761600
  buffer_load_dwordx4 v[84:87], off, s[4:7], s38 sc1
  buffer_load_dwordx4 v[88:91], off, s[4:7], s38 offset:16 sc1
  buffer_load_dword v92, off, s[4:7], s62 sc1
L_rec_nofast:
  s_barrier
  v_add_u32 v38, 81920, v35
  v_add_u32 v39, 81920, v36
  ds_read_b64_tr_b16 v[44:45], v38 offset:0
  ds_read_b64_tr_b16 v[46:47], v38 offset:2560
  ds_read_b64_tr_b16 v[48:49], v38 offset:10240
  ds_read_b64_tr_b16 v[50:51], v38 offset:12800
  ds_read_b64_tr_b16 v[52:53], v38 offset:8
  ds_read_b64_tr_b16 v[54:55], v38 offset:2568
  ds_read_b64_tr_b16 v[56:57], v38 offset:10248
  ds_read_b64_tr_b16 v[58:59], v38 offset:12808
  ds_read_b64_tr_b16 v[60:61], v38 offset:512
  ds_read_b64_tr_b16 v[62:63], v38 offset:3072
  ds_read_b64_tr_b16 v[64:65], v38 offset:10752
  ds_read_b64_tr_b16 v[66:67], v38 offset:13312
  s_waitcnt lgkmcnt(0)
  ds_read_b64_tr_b16 v[68:69], v38 offset:520
  ds_read_b64_tr_b16 v[70:71], v38 offset:3080
  ds_read_b64_tr_b16 v[72:73], v38 offset:10760
  ds_read_b64_tr_b16 v[74:75], v38 offset:13320
  ds_read_b64_tr_b16 v[76:77], v39 offset:1024
  ds_read_b64_tr_b16 v[78:79], v39 offset:3584
  ds_read_b64_tr_b16 v[80:81], v39 offset:11264
  ds_read_b64_tr_b16 v[82:83], v39 offset:13824
  s_waitcnt lgkmcnt(0)
  ds_write_b128 v13, v[44:47] offset:0
  ds_write_b128 v13, v[48:51] offset:1024
  ds_write_b128 v13, v[52:55] offset:4096
  ds_write_b128 v13, v[56:59] offset:5120
  ds_write_b128 v13, v[60:63] offset:8192
  ds_write_b128 v13, v[64:67] offset:9216
  ds_write_b128 v13, v[68:71] offset:12288
  ds_write_b128 v13, v[72:75] offset:13312
  ds_write_b128 v13, v[76:79] offset:16384
  ds_write_b128 v13, v[80:83] offset:17408
  s_waitcnt lgkmcnt(0)
  s_waitcnt vmcnt(0)
  s_barrier
  v_add_u32 v38, 122880, v35
  v_add_u32 v39, 122880, v36
  ds_read_b64_tr_b16 v[44:45], v38 offset:0
  ds_read_b64_tr_b16 v[46:47], v38 offset:2560
  ds_read_b64_tr_b16 v[48:49], v38 offset:10240
  ds_read_b64_tr_b16 v[50:51], v38 offset:12800
  ds_read_b64_tr_b16 v[52:53], v38 offset:8
  ds_read_b64_tr_b16 v[54:55], v38 offset:2568
  ds_read_b64_tr_b16 v[56:57], v38 offset:10248
  ds_read_b64_tr_b16 v[58:59], v38 offset:12808
  ds_read_b64_tr_b16 v[60:61], v38 offset:512
  ds_read_b64_tr_b16 v[62:63], v38 offset:3072
  ds_read_b64_tr_b16 v[64:65], v38 offset:10752
  ds_read_b64_tr_b16 v[66:67], v38 offset:13312
  s_waitcnt lgkmcnt(0)
  ds_read_b64_tr_b16 v[68:69], v38 offset:520
  ds_read_b64_tr_b16 v[70:71], v38 offset:3080
  ds_read_b64_tr_b16 v[72:73], v38 offset:10760
  ds_read_b64_tr_b16 v[74:75], v38 offset:13320
  ds_read_b64_tr_b16 v[76:77], v39 offset:1024
  ds_read_b64_tr_b16 v[78:79], v39 offset:3584
  ds_read_b64_tr_b16 v[80:81], v39 offset:11264
  ds_read_b64_tr_b16 v[82:83], v39 offset:13824
  s_waitcnt lgkmcnt(0)
  ds_write_b128 v13, v[44:47] offset:2048
  ds_write_b128 v13, v[48:51] offset:3072
  ds_write_b128 v13, v[52:55] offset:6144
  ds_write_b128 v13, v[56:59] offset:7168
  ds_write_b128 v13, v[60:63] offset:10240
  ds_write_b128 v13, v[64:67] offset:11264
  ds_write_b128 v13, v[68:71] offset:14336
  ds_write_b128 v13, v[72:75] offset:15360
  ds_write_b128 v13, v[76:79] offset:18432
  ds_write_b128 v13, v[80:83] offset:19456
  s_waitcnt lgkmcnt(0)
  s_barrier
  s_cmp_eq_u32 s65, 1
  s_cbranch_scc1 L_rec_fast
  s_load_dwordx2 s[20:21], s[0:1], 104
  s_mov_b32 s22, 256
  s_mov_b32 s23, 0x20000
  s_mov_b32 s38, 0
  s_waitcnt lgkmcnt(0)
L_rec_wi:
  buffer_load_dword v41, off, s[20:23], 0 offset:128 sc1
  s_waitcnt vmcnt(0)
  v_cmp_eq_u32 vcc, 0, v41
  s_cbranch_vccz L_rec_wd
  s_sleep 8
  s_add_u32 s38, s38, 1
  s_cmp_lt_u32 s38, 0x100000
  s_cbranch_scc1 L_rec_wi
  s_branch L_rec_done
L_rec_wd:
  s_mov_b32 s38, 100761600
  buffer_load_dwordx4 v[84:87], off, s[4:7], s38 sc1
  buffer_load_dwordx4 v[88:91], off, s[4:7], s38 offset:16 sc1
  buffer_load_dword v92, off, s[4:7], s62 sc1
  s_waitcnt vmcnt(0)
L_rec_fast:
  s_mov_b32 s10, 0
  s_mov_b32 s9, s62
L_rec_kvw:
  v_cmp_gt_u32 vcc, 2, v92
  s_cbranch_vccz L_rec_kvok
  s_sleep 2
  buffer_load_dword v92, off, s[4:7], s9 sc1
  s_add_u32 s10, s10, 1
  s_cmp_lt_u32 s10, 0x400000
  s_waitcnt vmcnt(0)
  s_cbranch_scc1 L_rec_kvw
  s_branch L_rec_done
L_rec_kvok:
  s_lshl_b32 s36, s30, 14
  s_add_u32 s36, s36, 16777216
  s_mul_i32 s56, s29, 3072
  s_add_u32 s36, s36, s56
  s_lshl_b32 s38, s31, 12
  s_add_u32 s36, s36, s38
  s_xor_b32 s20, s38, 4096
  s_lshl_b32 s21, s31, 13
  s_mov_b32 s37, 94208
  s_mov_b32 s58, 106496
  s_mov_b32 s52, 118784
  s_add_u32 m0, s37, s56
  s_nop 0
  buffer_load_dwordx4 v2, s[4:7], s36 offen offset:0 sc1 lds
  buffer_load_dwordx4 v2, s[4:7], s36 offen offset:1024 sc1 lds
  buffer_load_dwordx4 v2, s[4:7], s36 offen offset:2048 sc1 lds
  s_add_u32 s36, s36, 524288
  s_add_u32 m0, s58, s56
  s_nop 0
  buffer_load_dwordx4 v2, s[4:7], s36 offen offset:0 sc1 lds
  buffer_load_dwordx4 v2, s[4:7], s36 offen offset:1024 sc1 lds
  buffer_load_dwordx4 v2, s[4:7], s36 offen offset:2048 sc1 lds
  s_mov_b32 s57, s9
  s_mov_b32 s59, s10
  v_and_b32 v22, 15, v21
  v_lshrrev_b32 v23, 4, v21
  v_bfe_u32 v24, v21, 3, 1
  v_mov_b32 v26, 0x44444444
  v_mov_b32 v27, 0xeeeeeeee
  v_cmp_eq_u32 vcc, 1, v24
  s_nop 1
  v_cndmask_b32 v1, v26, v27, vcc
  v_mov_b32 v26, 0
  v_mov_b32 v27, 0xf149f2ca
  v_cmp_gt_u32 vcc, 2, v23
  s_nop 1
  v_cndmask_b32 v12, v26, v27, vcc
  s_lshl_b32 s38, s29, 10
  s_add_u32 s38, s38, 131072
  v_lshlrev_b32 v26, 5, v22
  v_lshl_add_u32 v26, v23, 3, v26
  v_add_u32 v4, s38, v26
  v_bfe_u32 v26, v21, 2, 2
  v_lshl_add_u32 v26, v23, 3, v26
  v_lshlrev_b32 v26, 5, v26
  v_and_b32 v27, 3, v21
  v_lshl_add_u32 v26, v27, 3, v26
  v_add_u32 v5, 131072, v26
  v_and_b32 v29, 1, v23
  v_lshrrev_b32 v30, 1, v23
  v_lshlrev_b32 v26, 4, v22
  v_lshl_add_u32 v26, v29, 3, v26
  v_add_u32 v7, 135168, v26
  v_lshl_add_u32 v26, v30, 2, v26
  s_lshl_b32 s38, s29, 8
  s_add_u32 s38, s38, 135168
  v_add_u32 v6, s38, v26
  v_lshl_add_u32 v31, v29, 2, v27
  v_lshlrev_b32 v31, 4, v31
  v_lshrrev_b32 v26, 2, v22
  v_lshl_add_u32 v26, v30, 2, v26
  s_lshl_b32 s38, s29, 3
  v_add_u32 v26, s38, v26
  v_xor_b32 v28, s28, v26
  v_and_b32 v28, 63, v28
  v_lshl_add_u32 v26, v26, 14, v31
  v_lshl_add_u32 v8, v28, 7, v26
  v_lshl_add_u32 v26, v30, 1, v24
  s_lshl_b32 s38, s29, 2
  s_add_u32 s38, s38, 64
  v_add_u32 v26, s38, v26
  v_xor_b32 v28, s28, v26
  v_and_b32 v28, 63, v28
  v_lshl_add_u32 v26, v26, 14, v31
  v_lshl_add_u32 v26, v28, 7, v26
  v_bfe_u32 v28, v21, 2, 1
  v_lshl_add_u32 v9, v28, 3, v26
  v_readfirstlane_b32 s8, v84
  v_readfirstlane_b32 s9, v85
  v_readfirstlane_b32 s10, v86
  v_readfirstlane_b32 s11, v87
  v_readfirstlane_b32 s12, v88
  v_readfirstlane_b32 s13, v89
  v_readfirstlane_b32 s14, v90
  v_readfirstlane_b32 s15, v91
  s_mov_b32 s38, 0
  s_mov_b32 s16, 0
  s_bfe_u32 s39, s8, 0x1000e
  s_add_u32 s16, s16, s39
  s_bfe_u32 s39, s9, 0x1000e
  s_add_u32 s16, s16, s39
  s_bfe_u32 s39, s10, 0x1000e
  s_add_u32 s16, s16, s39
  s_bfe_u32 s39, s11, 0x1000e
  s_add_u32 s16, s16, s39
  s_bfe_u32 s39, s12, 0x1000e
  s_add_u32 s16, s16, s39
  s_bfe_u32 s39, s13, 0x1000e
  s_add_u32 s16, s16, s39
  s_bfe_u32 s39, s14, 0x1000e
  s_add_u32 s16, s16, s39
  s_bfe_u32 s39, s15, 0x1000e
  s_add_u32 s16, s16, s39
  s_cmp_ge_u32 s16, 4
  s_cselect_b32 s16, 1, 0
  s_and_b32 s8, s8, 8192
  s_add_u32 s38, s38, s8
  s_and_b32 s9, s9, 8192
  s_xor_b32 s9, s9, 8192
  s_add_u32 s38, s38, s9
  s_and_b32 s10, s10, 8192
  s_add_u32 s38, s38, s10
  s_and_b32 s11, s11, 8192
  s_xor_b32 s11, s11, 8192
  s_add_u32 s38, s38, s11
  s_and_b32 s12, s12, 8192
  s_add_u32 s38, s38, s12
  s_and_b32 s13, s13, 8192
  s_xor_b32 s13, s13, 8192
  s_add_u32 s38, s38, s13
  s_and_b32 s14, s14, 8192
  s_add_u32 s38, s38, s14
  s_and_b32 s15, s15, 8192
  s_xor_b32 s15, s15, 8192
  s_add_u32 s38, s38, s15
  s_cmp_ge_u32 s38, 49152
  s_cselect_b32 s8, 8192, s8
  s_cmp_le_u32 s38, 16384
  s_cselect_b32 s8, 0, s8
  s_cmp_ge_u32 s38, 49152
  s_cselect_b32 s9, 8192, s9
  s_cmp_le_u32 s38, 16384
  s_cselect_b32 s9, 0, s9
  s_xor_b32 s9, s9, 8192
  s_cmp_ge_u32 s38, 49152
  s_cselect_b32 s10, 8192, s10
  s_cmp_le_u32 s38, 16384
  s_cselect_b32 s10, 0, s10
  s_cmp_ge_u32 s38, 49152
  s_cselect_b32 s11, 8192, s11
  s_cmp_le_u32 s38, 16384
  s_cselect_b32 s11, 0, s11
  s_xor_b32 s11, s11, 8192
  s_cmp_ge_u32 s38, 49152
  s_cselect_b32 s12, 8192, s12
  s_cmp_le_u32 s38, 16384
  s_cselect_b32 s12, 0, s12
  s_cmp_ge_u32 s38, 49152
  s_cselect_b32 s13, 8192, s13
  s_cmp_le_u32 s38, 16384
  s_cselect_b32 s13, 0, s13
  s_xor_b32 s13, s13, 8192
  s_cmp_ge_u32 s38, 49152
  s_cselect_b32 s14, 8192, s14
  s_cmp_le_u32 s38, 16384
  s_cselect_b32 s14, 0, s14
  s_cmp_ge_u32 s38, 49152
  s_cselect_b32 s15, 8192, s15
  s_cmp_le_u32 s38, 16384
  s_cselect_b32 s15, 0, s15
  s_xor_b32 s15, s15, 8192
  s_getreg_b32 s38, hwreg(HW_REG_XCC_ID)
  s_bitcmp1_b32 s38, 1
  s_cselect_b32 s39, s10, s8
  s_cselect_b32 s17, 4194304, 0
  s_add_u32 s39, s39, s17
  s_xor_b32 s38, s38, s16
  s_and_b32 s38, s38, 1
  s_lshl_b32 s38, s38, 14
  s_add_u32 s38, s38, s39
  v_add_u32 v3, s38, v2
  s_add_u32 s35, s12, 8388608
  s_add_u32 s62, s13, 10485760
  s_add_u32 s63, s35, 0x140000
  s_mov_b32 s43, 0x3e0293ee
  s_mov_b32 s44, s43
  s_mov_b32 s45, s43
  s_mov_b32 s97, 4290772927
  s_mov_b32 s33, 0
  s_mov_b32 s34, 0
  s_mov_b32 s42, 0
  s_mov_b32 s96, 0
  s_add_u32 s54, s53, 4096
  s_and_b32 s55, s53, 1024
  s_add_u32 s55, s55, 32768
  s_bfe_u32 s14, s40, 0x80008
  s_bfe_u32 s15, s40, 0x80010
  s_and_b32 s40, s40, 255
  s_mov_b32 s9, s57
  s_mov_b32 s10, s59
  s_lshl_b32 s59, s28, 7
  s_add_u32 s59, s59, 100663296
  s_lshl_b32 s57, s30, 12
  s_lshl_b32 s38, s31, 10
  s_add_u32 s57, s57, s38
  s_add_u32 s57, s57, 50331648
  s_cmp_eq_u32 s29, 3
  s_cselect_b32 s38, 0, 1
  v_mul_u32_u24 v10, s38, v2
  s_lshl_b32 s38, s28, 4
  s_lshl_b32 s39, s28, 7
  s_add_u32 s39, s39, 16384
  v_mov_b32 v11, s38
  v_mov_b32 v26, s39
  v_and_b32 v27, 1, v21
  v_cmp_eq_u32 vcc, 1, v27
  s_nop 1
  v_cndmask_b32 v11, v11, v26, vcc
  s_cmp_eq_u32 s29, 0
  s_cselect_b32 s64, 65536, 0
  s_bitcmp0_b32 s29, 0
  s_cbranch_scc1 L_rec_pub2
  s_lshl_b32 s38, s28, 6
  s_lshl_b32 s39, s29, 4
  s_add_u32 s38, s38, s39
  s_add_u32 s38, s38, 1024
  s_cmp_eq_u32 s29, 3
  s_cselect_b32 s38, 0, s38
  v_mov_b32 v11, s38
L_rec_pub2:
  v_mov_b32 v16, 0x3f803f80
  v_mov_b32 v17, 0x3f803f80
  v_mov_b32 v18, 0x3f803f80
  v_mov_b32 v19, 0x3f803f80
  s_add_u32 s16, s40, 36
  s_add_u32 s17, s14, 12
  v_mov_b32 v20, v96
  v_mov_b32 v36, v100
  v_mov_b32 v52, v104
  v_mov_b32 v21, v97
  v_mov_b32 v37, v101
  v_mov_b32 v53, v105
  v_mov_b32 v22, v98
  v_mov_b32 v38, v102
  v_mov_b32 v54, v106
  v_mov_b32 v23, v99
  v_mov_b32 v39, v103
  v_mov_b32 v55, v107
  s_waitcnt vmcnt(0) lgkmcnt(0)
  s_barrier
  s_add_u32 s38, s37, s20
  v_add_u32 v14, s38, v2
  ds_read_b128 v[80:83], v14 offset:0
  ds_read_b128 v[84:87], v14 offset:1024
  ds_read_b128 v[88:91], v14 offset:2048
  ds_read_b128 v[92:95], v14 offset:3072
  ds_read_b128 v[96:99], v14 offset:4096
  ds_read_b128 v[100:103], v14 offset:5120
  ds_read_b128 v[104:107], v14 offset:6144
  ds_read_b128 v[108:111], v14 offset:7168
  v_mov_b64 v[60:61], 0
  v_mov_b64 v[62:63], 0
  v_mov_b64 v[64:65], 0
  v_mov_b64 v[66:67], 0
  v_mov_b64 v[68:69], 0
  v_mov_b64 v[70:71], 0
  v_mov_b64 v[72:73], 0
  v_mov_b64 v[74:75], 0
  v_mov_b64 v[76:77], 0
  v_mov_b64 v[78:79], 0
  s_and_b32 s50, s33, 3
  s_lshl_b32 s50, s50, 15
  s_xor_b32 s49, s50, s64
  s_add_u32 s50, s50, s63
  s_add_u32 s49, s49, s63
  s_cmp_eq_u32 s29, 3
  s_cselect_b32 s50, s9, s50
  s_cselect_b32 s49, s59, s49
  v_add_u32 v15, 81920, v2
  v_add_u32 v14, s53, v15
  v_mov_b32 v56, v14
  s_mov_b32 s12, 90
  s_branch L_rec_c0
L_rec_step:
  s_add_u32 s11, s33, 3
  s_min_u32 s11, s11, 64
  s_cmp_lt_u32 s33, 5
  s_cselect_b32 s11, 0, s11
  s_add_u32 s19, s34, s55
  s_mov_b32 s18, 0
  s_add_u32 s51, s34, s53
  s_add_u32 s65, s34, s54
  s_cmp_lg_u32 s29, 2
  s_cbranch_scc1 L_rec_no3
  s_memrealtime s[100:101]
  s_memtime s[46:47]
  s_waitcnt lgkmcnt(0)
  s_sub_u32 s100, s100, s32
  s_sub_u32 s46, s46, s41
  v_cvt_f32_u32 v14, s100
  v_cvt_f32_u32 v15, s46
  v_rcp_f32 v14, v14
  s_nop 0
  v_mul_f32 v14, v14, v15
  v_max_f32 v14, 0x41800000, v14
  v_min_f32 v14, 0x41d00000, v14
  v_rcp_f32 v15, v14
  v_mul_f32 v14, 0x42924925, v14
  v_cvt_u32_f32 v14, v14
  s_nop 0
  v_readfirstlane_b32 s8, v14
  v_mul_f32 v15, 0x47800000, v15
  v_cvt_u32_f32 v15, v15
  s_nop 0
  v_readfirstlane_b32 s48, v15
L_rec_ts:
  s_memrealtime s[100:101]
  v_cmp_gt_i32 vcc, 0, v0
  s_waitcnt lgkmcnt(0)
  s_sub_u32 s39, s24, s26
  s_min_u32 s39, s39, 0x8000
  s_mul_i32 s39, s39, s48
  s_lshr_b32 s39, s39, 16
  s_add_u32 s12, s12, 1
  s_min_u32 s12, s12, s39
  v_subrev_u32 v15, s100, v0
  s_cbranch_vccnz L_rec_failT
L_rec_ts2:
  v_lshlrev_b32 v15, 1, v15
  s_nop 1
  v_max_i32_dpp v15, v15, v15 row_ror:1 row_mask:0xf bank_mask:0xf
  s_nop 1
  v_max_i32_dpp v15, v15, v15 row_ror:2 row_mask:0xf bank_mask:0xf
  s_nop 1
  v_max_i32_dpp v15, v15, v15 row_ror:4 row_mask:0xf bank_mask:0xf
  s_nop 1
  v_max_i32_dpp v15, v15, v15 row_ror:8 row_mask:0xf bank_mask:0xf
  s_nop 0
  v_readlane_b32 s38, v15, 0
  v_readlane_b32 s39, v15, 16
  v_readlane_b32 s46, v15, 32
  v_readlane_b32 s47, v15, 48
  s_max_i32 s38, s38, s39
  s_max_i32 s46, s46, s47
  s_max_i32 s38, s38, s46
  s_min_i32 s38, s38, 4000
  s_max_i32 s38, s38, -4000
  s_add_i32 s38, s38, s40
  s_cmp_le_u32 s33, 6
  s_cselect_b32 s39, 12, 0
  s_add_i32 s38, s38, s39
  s_mul_i32 s38, s38, s8
  s_ashr_i32 s38, s38, 12
  s_max_i32 s38, s38, 0
.p2align 3
L_dl_1:
  s_sub_u32 s38, s38, 1
  s_cbranch_scc0 L_dl_1
  s_branch L_rec_a0
L_rec_no3:
  s_cmp_lg_u32 s29, 3
  s_cbranch_scc1 L_rec_a0
L_rec_sc:
  v_cmp_gt_u32 vcc, s11, v0
  s_cbranch_vccnz L_rec_slow
L_rec_a0:
  s_barrier
  buffer_load_dwordx4 v[20:23], v3, s[4:7], s51 offen sc1
  s_mov_b32 s38, s14
.p2align 3
L_dl_2:
  s_sub_u32 s38, s38, 1
  s_cbranch_scc0 L_dl_2
  buffer_load_dwordx4 v[36:39], v3, s[4:7], s65 offen sc1
  s_mov_b32 s38, s15
.p2align 3
L_dl_3:
  s_sub_u32 s38, s38, 1
  s_cbranch_scc0 L_dl_3
  buffer_load_dwordx4 v[52:55], v3, s[4:7], s19 offen sc1
  s_and_b32 s50, s33, 3
  s_lshl_b32 s50, s50, 15
  s_xor_b32 s49, s50, s64
  s_add_u32 s50, s50, s63
  s_add_u32 s49, s49, s63
  s_cmp_eq_u32 s29, 3
  s_cselect_b32 s50, s9, s50
  s_cselect_b32 s49, s59, s49
  v_add_u32 v15, 81920, v2
  v_add_u32 v14, s53, v15
  v_mov_b32 v56, v14
  s_waitcnt vmcnt(2)
L_rec_c0:
  ds_write_b128 v14, v[20:23] offset:0
  v_max3_u32 v25, v20, v21, v22
  v_max_u32 v25, v25, v23
  v_cmp_eq_u32 vcc, s97, v25
  s_cbranch_vccnz L_rec_bad0
L_rec_ok0:
  s_waitcnt lgkmcnt(0)
L_rec_go:
  s_barrier
  ds_read_b128 v[20:23], v15 offset:0
  ds_read_b128 v[24:27], v15 offset:1024
  ds_read_b128 v[28:31], v15 offset:2048
  ds_read_b128 v[32:35], v15 offset:3072
  s_waitcnt lgkmcnt(3)
  v_smfmac_f32_16x16x64_bf16 v[60:63], v[20:23], a[0:7], v1
  v_smfmac_f32_16x16x64_bf16 v[68:71], v[20:23], a[160:167], v1
  v_smfmac_f32_16x16x64_bf16 v[64:67], v[20:23], a[80:87], v1
  v_smfmac_f32_16x16x64_bf16 v[72:75], v[20:23], a[240:247], v1
  s_waitcnt vmcnt(1)
  ds_write_b128 v14, v[36:39] offset:4096
  s_waitcnt lgkmcnt(1)
  v_smfmac_f32_16x16x64_bf16 v[60:63], v[24:27], a[8:15], v1
  v_smfmac_f32_16x16x64_bf16 v[68:71], v[24:27], a[168:175], v1
  v_smfmac_f32_16x16x64_bf16 v[64:67], v[24:27], a[88:95], v1
  s_waitcnt vmcnt(0)
  ds_write_b128 v56, v[52:55] offset:8192
  v_smfmac_f32_16x16x64_bf16 v[72:75], v[24:27], a[248:255], v1
  v_max3_u32 v41, v36, v37, v38
  v_max3_u32 v41, v41, v39, v52
  v_smfmac_f32_16x16x64_bf16 v[60:63], v[28:31], a[16:23], v1
  v_max3_u32 v41, v41, v53, v54
  v_max_u32 v41, v41, v55
  v_cmp_eq_u32 vcc, s97, v41
  v_smfmac_f32_16x16x64_bf16 v[68:71], v[28:31], a[176:183], v1
  v_smfmac_f32_16x16x64_bf16 v[64:67], v[28:31], a[96:103], v1
  s_cbranch_vccnz L_rec_bad1
L_rec_ok1:
  v_smfmac_f32_16x16x64_bf16 v[72:75], v[28:31], v[112:119], v1
  s_waitcnt lgkmcnt(0)
  s_barrier
  ds_read_b128 v[36:39], v15 offset:4096
  ds_read_b128 v[40:43], v15 offset:5120
  ds_read_b128 v[44:47], v15 offset:6144
  v_smfmac_f32_16x16x64_bf16 v[60:63], v[32:35], a[24:31], v1
  ds_read_b128 v[48:51], v15 offset:7168
  ds_read_b128 v[52:55], v15 offset:8192
  ds_read_b128 v[56:59], v15 offset:9216
  v_smfmac_f32_16x16x64_bf16 v[68:71], v[32:35], a[184:191], v1
  v_smfmac_f32_16x16x64_bf16 v[64:67], v[32:35], a[104:111], v1
  v_smfmac_f32_16x16x64_bf16 v[72:75], v[32:35], v[120:127], v1
  s_waitcnt lgkmcnt(5)
  v_smfmac_f32_16x16x64_bf16 v[60:63], v[36:39], a[32:39], v1
  v_smfmac_f32_16x16x64_bf16 v[68:71], v[36:39], a[192:199], v1
  s_waitcnt lgkmcnt(4)
  v_smfmac_f32_16x16x64_bf16 v[60:63], v[40:43], a[40:47], v1
  v_smfmac_f32_16x16x64_bf16 v[68:71], v[40:43], a[200:207], v1
  s_waitcnt lgkmcnt(0)
  v_smfmac_f32_16x16x64_bf16 v[60:63], v[44:47], a[48:55], v1
  s_memrealtime s[98:99]
  s_memtime s[26:27]
  v_smfmac_f32_16x16x64_bf16 v[68:71], v[44:47], a[208:215], v1
  v_smfmac_f32_16x16x64_bf16 v[60:63], v[48:51], a[56:63], v1
  v_smfmac_f32_16x16x64_bf16 v[68:71], v[48:51], a[216:223], v1
  v_smfmac_f32_16x16x64_bf16 v[60:63], v[52:55], a[64:71], v1
  v_smfmac_f32_16x16x64_bf16 v[68:71], v[52:55], a[224:231], v1
  s_cmp_eq_u32 s29, 3
  s_cselect_b32 s38, s33, s97
  v_smfmac_f32_16x16x64_bf16 v[60:63], v[56:59], a[72:79], v1
  s_waitcnt lgkmcnt(0)
  s_add_u32 s98, s98, s12
  s_and_b32 s98, s98, 0x7fffffff
  v_smfmac_f32_16x16x64_bf16 v[68:71], v[56:59], a[232:239], v1
  s_cmp_eq_u32 s29, 2
  s_cselect_b32 s38, s98, s38
  v_mov_b32 v14, s38
  v_smfmac_f32_16x16x64_bf16 v[64:67], v[36:39], a[112:119], v1
  buffer_store_dword v14, v11, s[4:7], s49 offen sc1
  v_smfmac_f32_16x16x64_bf16 v[72:75], v[36:39], v[128:135], v1
  s_nop 0
  v_smfmac_f32_16x16x64_bf16 v[64:67], v[40:43], a[120:127], v1
  v_permlane32_swap_b32 v60, v68
  v_smfmac_f32_16x16x64_bf16 v[72:75], v[40:43], v[136:143], v1
  v_permlane32_swap_b32 v61, v69
  v_smfmac_f32_16x16x64_bf16 v[64:67], v[44:47], a[128:135], v1
  v_permlane32_swap_b32 v62, v70
  v_smfmac_f32_16x16x64_bf16 v[72:75], v[44:47], v[144:151], v1
  v_permlane32_swap_b32 v63, v71
  v_smfmac_f32_16x16x64_bf16 v[64:67], v[48:51], a[136:143], v1
  v_add_f32 v60, v60, v68
  v_add_f32 v61, v61, v69
  v_smfmac_f32_16x16x64_bf16 v[72:75], v[48:51], v[152:159], v1
  v_add_f32 v62, v62, v70
  v_add_f32 v63, v63, v71
  v_smfmac_f32_16x16x64_bf16 v[64:67], v[52:55], a[144:151], v1
  v_cvt_pk_bf16_f32 v68, v60, v61
  v_cvt_pk_bf16_f32 v69, v62, v63
  v_smfmac_f32_16x16x64_bf16 v[72:75], v[52:55], v[160:167], v1
  ds_write_b64 v4, v[68:69] offset:0
  v_smfmac_f32_16x16x64_bf16 v[64:67], v[56:59], a[152:159], v1
  v_smfmac_f32_16x16x64_bf16 v[72:75], v[56:59], v[168:175], v1
  s_nop 7
  v_permlane32_swap_b32 v64, v72
  v_permlane32_swap_b32 v65, v73
  v_permlane32_swap_b32 v66, v74
  v_permlane32_swap_b32 v67, v75
  v_pk_add_f32 v[64:65], v[64:65], v[72:73]
  v_pk_add_f32 v[66:67], v[66:67], v[74:75]
  v_cvt_pk_bf16_f32 v72, v64, v65
  v_cvt_pk_bf16_f32 v73, v66, v67
  ds_write_b64 v4, v[72:73] offset:512
  v_smfmac_f32_16x16x64_bf16 v[76:79], v[20:23], v[176:183], v1
  s_add_u32 s38, s37, s21
  v_add_u32 v15, s38, v2
  s_add_u32 m0, s52, s56
  s_cmp_lt_u32 s29, 2
  v_smfmac_f32_16x16x64_bf16 v[76:79], v[24:27], v[184:191], v1
  v_mov_b32 v70, v12
  v_mov_b32 v71, v12
  v_smfmac_f32_16x16x64_bf16 v[76:79], v[28:31], v[192:199], v1
  v_smfmac_f32_16x16x64_bf16 v[76:79], v[32:35], v[200:207], v1
  s_waitcnt lgkmcnt(0)
  s_barrier
  ds_read_b64_tr_b16 v[20:21], v5 offset:0
  ds_read_b64_tr_b16 v[22:23], v5 offset:128
  v_smfmac_f32_16x16x64_bf16 v[76:79], v[36:39], v[208:215], v1
  ds_read_b64_tr_b16 v[24:25], v5 offset:1024
  ds_read_b64_tr_b16 v[26:27], v5 offset:1152
  v_smfmac_f32_16x16x64_bf16 v[76:79], v[40:43], v[216:223], v1
  ds_read_b64_tr_b16 v[28:29], v5 offset:2048
  ds_read_b64_tr_b16 v[30:31], v5 offset:2176
  v_smfmac_f32_16x16x64_bf16 v[76:79], v[44:47], v[224:231], v1
  ds_read_b64_tr_b16 v[32:33], v5 offset:3072
  ds_read_b64_tr_b16 v[34:35], v5 offset:3200
  v_smfmac_f32_16x16x64_bf16 v[76:79], v[48:51], v[232:239], v1
  v_mov_b32 v68, v12
  v_mov_b32 v69, v12
  v_smfmac_f32_16x16x64_bf16 v[76:79], v[52:55], v[240:247], v1
  v_smfmac_f32_16x16x64_bf16 v[76:79], v[56:59], v[248:255], v1
  s_waitcnt lgkmcnt(6)
  v_mfma_f32_16x16x32_bf16 v[68:71], v[20:23], v[20:23], v[68:71]
  ds_read_b128 v[36:39], v15 offset:0
  v_mfma_f32_16x16x32_bf16 v[60:63], v[80:83], v[20:23], 0
  ds_read_b128 v[40:43], v15 offset:1024
  v_mfma_f32_16x16x32_bf16 v[64:67], v[96:99], v[20:23], 0
  ds_read_b128 v[44:47], v15 offset:2048
  s_waitcnt lgkmcnt(3)
  v_mfma_f32_16x16x32_bf16 v[68:71], v[24:27], v[24:27], v[68:71]
  ds_read_b128 v[48:51], v15 offset:3072
  v_mfma_f32_16x16x32_bf16 v[60:63], v[84:87], v[24:27], v[60:63]
  v_permlane32_swap_b32 v76, v78
  v_mfma_f32_16x16x32_bf16 v[64:67], v[100:103], v[24:27], v[64:67]
  v_permlane32_swap_b32 v77, v79
  v_mfma_f32_16x16x32_bf16 v[68:71], v[28:31], v[28:31], v[68:71]
  v_add_f32 v76, v76, v78
  v_add_f32 v77, v77, v79
  v_mfma_f32_16x16x32_bf16 v[60:63], v[88:91], v[28:31], v[60:63]
  v_cvt_pk_bf16_f32 v76, v76, v77
  v_mfma_f32_16x16x32_bf16 v[64:67], v[104:107], v[28:31], v[64:67]
  ds_write_b32 v6, v76
  v_mfma_f32_16x16x32_bf16 v[68:71], v[32:35], v[32:35], v[68:71]
  s_cbranch_scc1 L_rec_ntl
  buffer_load_dword v0, v10, s[4:7], s50 offen sc1
L_rec_ntl:
  v_mfma_f32_16x16x32_bf16 v[60:63], v[92:95], v[32:35], v[60:63]
  s_cmp_ge_u32 s33, 63
  v_mfma_f32_16x16x32_bf16 v[64:67], v[108:111], v[32:35], v[64:67]
  s_cbranch_scc1 L_rec_last
  ds_read_b128 v[80:83], v13 offset:0
  ds_read_b128 v[84:87], v13 offset:1024
  ds_read_b128 v[88:91], v13 offset:2048
  ds_read_b128 v[92:95], v13 offset:3072
  v_max3_f32 v14, v68, v69, v70
  v_max3_f32 v72, v71, v60, v61
  v_max3_f32 v14, v14, v62, v63
  v_max3_f32 v72, v72, v64, v65
  v_max3_f32 v14, v14, v66, v67
  v_max_f32 v14, v14, v72
  v_mov_b32 v72, v14
  ds_read_b128 v[96:99], v13 offset:4096
  ds_read_b128 v[100:103], v13 offset:5120
  v_permlane32_swap_b32 v14, v72
  v_max_f32 v14, v14, v72
  v_mov_b32 v72, v14
  s_waitcnt lgkmcnt(6)
  s_barrier
  v_permlane16_swap_b32 v14, v72
  v_max_f32 v14, v14, v72
  v_mul_f32 v14, s43, v14
  v_pk_fma_f32 v[60:61], v[60:61], s[44:45], v[14:15] op_sel_hi:[1,1,0] neg_lo:[0,0,1] neg_hi:[0,0,1]
  v_pk_fma_f32 v[62:63], v[62:63], s[44:45], v[14:15] op_sel_hi:[1,1,0] neg_lo:[0,0,1] neg_hi:[0,0,1]
  v_pk_fma_f32 v[64:65], v[64:65], s[44:45], v[14:15] op_sel_hi:[1,1,0] neg_lo:[0,0,1] neg_hi:[0,0,1]
  v_pk_fma_f32 v[66:67], v[66:67], s[44:45], v[14:15] op_sel_hi:[1,1,0] neg_lo:[0,0,1] neg_hi:[0,0,1]
  v_pk_fma_f32 v[68:69], v[68:69], s[44:45], v[14:15] op_sel_hi:[1,1,0] neg_lo:[0,0,1] neg_hi:[0,0,1]
  v_pk_fma_f32 v[70:71], v[70:71], s[44:45], v[14:15] op_sel_hi:[1,1,0] neg_lo:[0,0,1] neg_hi:[0,0,1]
  v_exp_f32 v60, v60
  ds_read_b64 v[52:53], v7 offset:0
  v_exp_f32 v61, v61
  ds_read_b64 v[54:55], v7 offset:256
  v_exp_f32 v62, v62
  ds_read_b64 v[56:57], v7 offset:512
  v_cvt_pk_bf16_f32 v72, v60, v61
  v_exp_f32 v63, v63
  ds_read_b64 v[58:59], v7 offset:768
  v_exp_f32 v64, v64
  v_cvt_pk_bf16_f32 v73, v62, v63
  v_mov_b32_dpp v72, v72 row_shr:8 row_mask:0xf bank_mask:0xf
  v_exp_f32 v65, v65
  v_exp_f32 v66, v66
  v_cvt_pk_bf16_f32 v74, v64, v65
  v_mov_b32_dpp v73, v73 row_shr:8 row_mask:0xf bank_mask:0xf
  v_exp_f32 v67, v67
  v_exp_f32 v68, v68
  v_cvt_pk_bf16_f32 v75, v66, v67
  v_mov_b32_dpp v74, v74 row_shr:8 row_mask:0xf bank_mask:0xf
  v_exp_f32 v69, v69
  v_mov_b32_dpp v75, v75 row_shr:8 row_mask:0xf bank_mask:0xf
  v_exp_f32 v70, v70
  s_nop 0
  v_mfma_f32_16x16x32_bf16 v[64:67], v[16:19], v[72:75], 0
  v_exp_f32 v71, v71
  buffer_load_dwordx4 v2, s[4:7], s36 offen offset:0 sc1 lds
  v_mfma_f32_16x16x32_bf16 v[20:23], v[36:39], v[72:75], 0
  v_cvt_pk_bf16_f32 v76, v68, v69
  v_cvt_pk_bf16_f32 v77, v70, v71
  v_mfma_f32_16x16x32_bf16 v[24:27], v[40:43], v[72:75], 0
  ds_read_b128 v[104:107], v13 offset:6144
  ds_read_b128 v[108:111], v13 offset:7168
  v_mov_b32_dpp v76, v76 row_shr:8 row_mask:0xf bank_mask:0xf
  v_mfma_f32_16x16x32_bf16 v[28:31], v[44:47], v[72:75], 0
  v_mov_b32_dpp v77, v77 row_shr:8 row_mask:0xf bank_mask:0xf
  v_mov_b64 v[60:61], 0
  buffer_load_dwordx4 v2, s[4:7], s36 offen offset:1024 sc1 lds
  v_mfma_f32_16x16x32_bf16 v[32:35], v[48:51], v[72:75], 0
  v_mov_b64 v[62:63], 0
  v_mov_b64 v[68:69], 0
  buffer_load_dwordx4 v2, s[4:7], s36 offen offset:2048 sc1 lds
  v_mfma_f32_16x16x16_bf16 v[64:67], v[16:17], v[76:77], v[64:67]
  ds_read_b128 v[36:39], v13 offset:8192
  v_mov_b64 v[70:71], 0
  s_waitcnt lgkmcnt(3)
  v_mfma_f32_16x16x16_bf16 v[20:23], v[52:53], v[76:77], v[20:23]
  ds_read_b128 v[40:43], v13 offset:9216
  v_mov_b64 v[72:73], 0
  v_mfma_f32_16x16x16_bf16 v[24:27], v[54:55], v[76:77], v[24:27]
  ds_read_b128 v[44:47], v13 offset:10240
  v_mov_b64 v[74:75], 0
  v_mfma_f32_16x16x16_bf16 v[28:31], v[56:57], v[76:77], v[28:31]
  ds_read_b128 v[48:51], v13 offset:11264
  v_rcp_f32 v14, v64
  v_mfma_f32_16x16x16_bf16 v[32:35], v[58:59], v[76:77], v[32:35]
  ds_read_b128 v[52:55], v13 offset:12288
  ds_read_b128 v[56:59], v13 offset:13312
  v_mov_b64 v[64:65], 0
  v_mov_b64 v[66:67], 0
  v_pk_mul_f32 v[20:21], v[20:21], v[14:15] op_sel_hi:[1,0]
  v_pk_mul_f32 v[22:23], v[22:23], v[14:15] op_sel_hi:[1,0]
  v_cvt_pk_bf16_f32 v20, v20, v21
  v_cvt_pk_bf16_f32 v21, v22, v23
  v_pk_mul_f32 v[24:25], v[24:25], v[14:15] op_sel_hi:[1,0]
  v_pk_mul_f32 v[26:27], v[26:27], v[14:15] op_sel_hi:[1,0]
  v_cvt_pk_bf16_f32 v22, v24, v25
  v_cvt_pk_bf16_f32 v23, v26, v27
  v_pk_mul_f32 v[28:29], v[28:29], v[14:15] op_sel_hi:[1,0]
  v_pk_mul_f32 v[30:31], v[30:31], v[14:15] op_sel_hi:[1,0]
  v_smfmac_f32_16x16x64_bf16 v[60:63], v[20:23], v[80:87], v1
  v_cvt_pk_bf16_f32 v24, v28, v29
  v_cvt_pk_bf16_f32 v25, v30, v31
  v_mul_f32 v32, v14, v32
  v_mul_f32 v33, v14, v33
  ds_read_b128 v[80:83], v13 offset:14336
  ds_read_b128 v[84:87], v13 offset:15360
  v_smfmac_f32_16x16x64_bf16 v[68:71], v[20:23], v[96:103], v1
  v_mul_f32 v34, v14, v34
  v_mul_f32 v35, v14, v35
  v_cvt_pk_bf16_f32 v26, v32, v33
  v_cvt_pk_bf16_f32 v27, v34, v35
  ds_read_b128 v[96:99], v13 offset:18432
  ds_read_b128 v[100:103], v13 offset:19456
  v_smfmac_f32_16x16x64_bf16 v[60:63], v[24:27], v[88:95], v1
  ds_read_b128 v[88:91], v13 offset:16384
  ds_read_b128 v[92:95], v13 offset:17408
  v_mov_b64 v[28:29], 0
  s_waitcnt lgkmcnt(12)
  v_smfmac_f32_16x16x64_bf16 v[68:71], v[24:27], v[104:111], v1
  v_mov_b64 v[30:31], 0
  s_add_u32 s38, s35, 524288
  s_waitcnt lgkmcnt(10)
  v_smfmac_f32_16x16x64_bf16 v[72:75], v[20:23], v[36:43], v1
  s_nop 1
  s_waitcnt lgkmcnt(6)
  v_smfmac_f32_16x16x64_bf16 v[64:67], v[20:23], v[52:59], v1
  v_cvt_pk_bf16_f32 v76, v60, v61
  v_cvt_pk_bf16_f32 v77, v62, v63
  v_smfmac_f32_16x16x64_bf16 v[72:75], v[24:27], v[44:51], v1
  v_cvt_pk_bf16_f32 v78, v68, v69
  v_cvt_pk_bf16_f32 v79, v70, v71
  s_waitcnt lgkmcnt(4)
  v_smfmac_f32_16x16x64_bf16 v[64:67], v[24:27], v[80:87], v1
  buffer_store_dwordx4 v[76:79], v8, s[4:7], s35 offen sc1
  s_waitcnt lgkmcnt(0)
  v_smfmac_f32_16x16x64_bf16 v[28:31], v[20:23], v[88:95], v1
  v_smfmac_f32_16x16x64_bf16 v[28:31], v[24:27], v[96:103], v1
  v_cvt_pk_bf16_f32 v104, v72, v73
  v_cvt_pk_bf16_f32 v105, v74, v75
  s_nop 1
  v_cvt_pk_bf16_f32 v106, v64, v65
  v_cvt_pk_bf16_f32 v107, v66, v67
  buffer_store_dwordx4 v[104:107], v8, s[4:7], s38 offen sc1
  s_nop 0
  v_cvt_pk_bf16_f32 v108, v28, v29
  v_cvt_pk_bf16_f32 v109, v30, v31
  buffer_store_dwordx2 v[108:109], v9, s[4:7], s35 offen sc1
  s_memtime s[24:25]
  s_waitcnt vmcnt(6)
  s_cmp_lg_u32 s29, 3
  s_cbranch_scc1 L_rec_n3
  v_and_b32 v44, 32, v2
  v_mul_u32_u24 v44, 63, v44
  v_lshrrev_b32 v44, 1, v44
  s_lshl_b32 s39, s31, 11
  v_add3_u32 v44, v44, v5, s39
  v_add_u32 v45, 135168, v2
  ds_read_b64_tr_b16 v[36:37], v44 offset:16
  ds_read_b64_tr_b16 v[38:39], v44 offset:144
  ds_read_b128 v[40:43], v45
  s_waitcnt lgkmcnt(0)
  buffer_store_dwordx4 v[36:39], v2, s[4:7], s57 offen sc1
  buffer_store_dwordx4 v[40:43], v2, s[4:7], s57 offen offset:2048 sc1
  s_cmp_lt_u32 s33, 59
  s_cbranch_scc1 L_rec_n3
  s_add_u32 s38, s33, 1
  s_waitcnt vmcnt(0)
  v_mov_b32 v46, s38
  buffer_store_dword v46, off, s[4:7], s59 sc1
L_rec_n3:
  s_cmp_lt_u32 s33, 5
  s_cbranch_scc1 L_rec_kv2
L_rec_kv2d:
  s_add_u32 s38, s58, s20
  v_add_u32 v14, s38, v2
  ds_read_b128 v[80:83], v14 offset:0
  ds_read_b128 v[84:87], v14 offset:1024
  ds_read_b128 v[88:91], v14 offset:2048
  ds_read_b128 v[92:95], v14 offset:3072
  ds_read_b128 v[96:99], v14 offset:4096
  ds_read_b128 v[100:103], v14 offset:5120
  ds_read_b128 v[104:107], v14 offset:6144
  ds_read_b128 v[108:111], v14 offset:7168
  v_mov_b64 v[60:61], 0
  v_mov_b64 v[62:63], 0
  v_mov_b64 v[64:65], 0
  v_mov_b64 v[66:67], 0
  v_mov_b64 v[68:69], 0
  v_mov_b64 v[70:71], 0
  v_mov_b64 v[72:73], 0
  v_mov_b64 v[74:75], 0
  v_mov_b64 v[76:77], 0
  v_mov_b64 v[78:79], 0
L_rec_next:
  s_add_u32 s33, s33, 1
  s_add_u32 s34, s34, 65536
  s_and_b32 s34, s34, 524287
  s_add_u32 s57, s57, 131072
  s_mov_b32 s38, s35
  s_mov_b32 s35, s62
  s_mov_b32 s62, s38
  s_mov_b32 s38, s37
  s_mov_b32 s37, s58
  s_mov_b32 s58, s52
  s_mov_b32 s52, s38
  s_add_u32 s36, s36, 524288
  s_branch L_rec_step
L_rec_bad0:
  s_cmp_eq_u32 s33, 0
  s_cbranch_scc1 L_rec_ok0
  s_cmp_lt_u32 s33, 3
  s_cselect_b32 s38, 0, 1
  s_lshl_b32 s38, s38, 1
  s_add_u32 s40, s40, s38
  s_min_u32 s40, s40, s16
L_rec_re0:
  s_add_u32 s96, s96, 1
  s_add_u32 s10, s10, 1
  s_bitcmp1_b32 s10, 22
  s_cbranch_scc1 L_rec_done
  buffer_load_dwordx4 v[20:23], v3, s[4:7], s51 offen sc1
  buffer_load_dwordx4 v[36:39], v3, s[4:7], s65 offen sc1
  buffer_load_dwordx4 v[52:55], v3, s[4:7], s19 offen sc1
  s_waitcnt vmcnt(0)
  v_max3_u32 v25, v20, v21, v22
  v_max_u32 v25, v25, v23
  v_cmp_eq_u32 vcc, s97, v25
  s_cbranch_vccnz L_rec_re0
  v_max3_u32 v41, v36, v37, v38
  v_max_u32 v41, v41, v39
  v_cmp_eq_u32 vcc, s97, v41
  s_cbranch_vccnz L_rec_re0
  v_max3_u32 v57, v52, v53, v54
  v_max_u32 v57, v57, v55
  v_cmp_eq_u32 vcc, s97, v57
  s_cbranch_vccnz L_rec_re0
  s_branch L_rec_c0
L_rec_bad1:
  s_cmp_eq_u32 s33, 0
  s_cbranch_scc1 L_rec_ok1
  s_cmp_lt_u32 s33, 3
  s_cselect_b32 s38, 0, 1
  s_add_u32 s14, s14, s38
  s_min_u32 s14, s14, s17
L_rec_re1:
  s_add_u32 s42, s42, 1
  s_add_u32 s10, s10, 1
  s_bitcmp1_b32 s10, 22
  s_cbranch_scc1 L_rec_done
  buffer_load_dwordx4 v[36:39], v3, s[4:7], s65 offen sc1
  buffer_load_dwordx4 v[52:55], v3, s[4:7], s19 offen sc1
  s_waitcnt vmcnt(0)
  v_max3_u32 v41, v36, v37, v38
  v_max_u32 v41, v41, v39
  v_cmp_eq_u32 vcc, s97, v41
  s_cbranch_vccnz L_rec_re1
  v_max3_u32 v57, v52, v53, v54
  v_max_u32 v57, v57, v55
  v_cmp_eq_u32 vcc, s97, v57
  s_cbranch_vccnz L_rec_re1
  ds_write_b128 v14, v[36:39] offset:4096
  ds_write_b128 v56, v[52:55] offset:8192
  s_branch L_rec_ok1
L_rec_kv2:
  buffer_load_dword v20, off, s[4:7], s9 sc1
  s_add_u32 s10, s10, 1
  s_cmp_ge_u32 s10, 0x400000
  s_cbranch_scc1 L_rec_done
  s_waitcnt vmcnt(0)
  s_add_u32 s38, s33, 3
  v_cmp_gt_u32 vcc, s38, v20
  s_cbranch_vccnz L_rec_kv2
  s_add_u32 s36, s36, 524288
  buffer_load_dwordx4 v2, s[4:7], s36 offen offset:0 sc1 lds
  buffer_load_dwordx4 v2, s[4:7], s36 offen offset:1024 sc1 lds
  buffer_load_dwordx4 v2, s[4:7], s36 offen offset:2048 sc1 lds
  s_cmp_eq_u32 s33, 4
  s_cselect_b32 s38, 0, 524288
  s_sub_u32 s36, s36, s38
  s_branch L_rec_kv2d
L_rec_slow:
  buffer_load_dword v0, off, s[4:7], s9 sc1
  s_add_u32 s10, s10, 1
  s_waitcnt vmcnt(0)
  s_cmp_lt_u32 s10, 0x400000
  s_cbranch_scc1 L_rec_sc
  s_branch L_rec_done
L_rec_failT:
  s_add_u32 s42, s42, 0x10000
  s_add_u32 s18, s18, 1
  s_cmp_lt_u32 s18, 64
  s_cbranch_scc1 L_rec_ft2
  v_mov_b32 v15, 0
  s_branch L_rec_ts2
L_rec_ft2:
  buffer_load_dword v0, v10, s[4:7], s50 offen sc1
  s_waitcnt vmcnt(0)
  s_branch L_rec_ts
L_rec_last:
  s_waitcnt lgkmcnt(0)
  s_barrier
  s_cmp_lg_u32 s29, 3
  s_cbranch_scc1 L_rec_done
  v_and_b32 v44, 32, v2
  v_mul_u32_u24 v44, 63, v44
  v_lshrrev_b32 v44, 1, v44
  s_lshl_b32 s39, s31, 11
  v_add3_u32 v44, v44, v5, s39
  v_add_u32 v45, 135168, v2
  ds_read_b64_tr_b16 v[36:37], v44 offset:16
  ds_read_b64_tr_b16 v[38:39], v44 offset:144
  ds_read_b128 v[40:43], v45
  s_waitcnt lgkmcnt(0)
  buffer_store_dwordx4 v[36:39], v2, s[4:7], s57 offen sc1
  buffer_store_dwordx4 v[40:43], v2, s[4:7], s57 offen offset:2048 sc1
  s_waitcnt vmcnt(0)
  v_mov_b32 v46, 64
  buffer_store_dword v46, off, s[4:7], s59 sc1
L_rec_done:
  s_waitcnt vmcnt(0)
  s_branch L_end
L_g1:
  v_lshrrev_b32 v1, 6, v0
  s_nop 0
  v_readfirstlane_b32 s29, v1
  v_and_b32 v2, 63, v0
  v_lshlrev_b32 v3, 4, v2
  s_load_dwordx2 s[16:17], s[0:1], 0
  s_mov_b32 s18, 2621440
  s_mov_b32 s19, 0x20000
  s_mov_b32 s11, 0x20000
  s_mov_b32 s15, 0x20000
  s_cmp_eq_u32 s28, 1
  s_cbranch_scc1 L_g1_tq
  s_cmp_eq_u32 s28, 2
  s_cbranch_scc1 L_g1_tf
  s_load_dwordx2 s[8:9], s[0:1], 24
  s_load_dwordx2 s[12:13], s[0:1], 32
  s_mov_b32 s10, 5242880
  s_mov_b32 s14, 5242880
  s_mov_b32 s31, 8192
  s_lshl_b32 s32, s30, 8
  s_mov_b32 s33, s32
  s_lshl_b32 s34, s30, 14
  s_add_u32 s34, s34, 16777216
  s_mov_b32 s35, 524288
  s_add_u32 s36, s30, 64
  s_branch L_g1_t
L_g1_tq:
  s_load_dwordx2 s[8:9], s[0:1], 16
  s_load_dwordx2 s[12:13], s[0:1], 16
  s_mov_b32 s10, 5242880
  s_mov_b32 s14, 5242880
  s_mov_b32 s31, 8192
  s_lshl_b32 s32, s30, 9
  s_add_u32 s33, s32, 256
  s_lshl_b32 s34, s30, 14
  s_add_u32 s34, s34, 67108864
  s_mov_b32 s35, 262144
  s_add_u32 s36, s30, 96
  s_branch L_g1_t
L_g1_tf:
  s_load_dwordx2 s[8:9], s[0:1], 64
  s_load_dwordx2 s[12:13], s[0:1], 72
  s_mov_b32 s10, 2211840
  s_mov_b32 s14, 2211840
  s_mov_b32 s31, 3456
  s_lshl_b32 s32, s30, 8
  s_mov_b32 s33, s32
  s_lshl_b32 s34, s30, 13
  s_add_u32 s34, s34, 58720256
  s_mov_b32 s35, 110592
  s_add_u32 s36, s30, 112
L_g1_t:
  s_lshl_b32 s36, s36, 7
  s_add_u32 s36, s36, 100663296
  s_mov_b32 s37, 0
  s_cmp_eq_u32 s28, 2
  s_cselect_b32 s37, 2, s37
  s_lshr_b32 s38, s29, 1
  s_and_b32 s39, s29, 1
  s_cmp_eq_u32 s28, 0
  s_cselect_b32 s37, s38, s37
  s_lshl_b32 s40, s30, 2
  s_add_u32 s40, s40, s29
  s_cmp_ge_u32 s40, 54
  s_cselect_b32 s40, 3, 2
  s_cmp_eq_u32 s28, 2
  s_cselect_b32 s37, s40, s37
  v_lshrrev_b32 v4, 4, v2
  v_lshlrev_b32 v5, 2, v4
  s_lshl_b32 s40, s38, 1
  v_or_b32 v5, s40, v5
  v_and_b32 v6, 15, v2
  v_xor_b32 v5, v5, v6
  v_lshlrev_b32 v5, 4, v5
  s_lshl_b32 s40, s28, 4
  s_add_u32 s40, s40, s30
  s_cmp_eq_u32 s40, 45
  s_cselect_b32 s40, 0x7f, -1
  v_and_b32 v5, s40, v5
  s_lshl_b32 s40, s29, 2
  v_add_u32 v4, s40, v4
  v_mul_lo_u32 v4, v4, s31
  v_add3_u32 v8, v4, v5, s32
  v_add3_u32 v9, v4, v5, s33
  s_lshl_b32 s41, s31, 4
  s_lshl_b32 s45, s29, 10
  v_lshrrev_b32 v4, 4, v2
  v_bfe_u32 v5, v2, 2, 2
  v_and_b32 v6, 3, v2
  v_lshl_add_u32 v7, v4, 3, v5
  v_lshlrev_b32 v7, 8, v7
  v_and_b32 v10, 1, v4
  v_lshlrev_b32 v10, 1, v10
  v_lshl_or_b32 v10, v5, 2, v10
  s_cmp_eq_u32 s37, 1
  s_cbranch_scc1 L_g1_av
  s_cmp_ge_u32 s37, 2
  s_cbranch_scc1 L_g1_af
  s_lshl_b32 s40, s39, 3
  v_add_u32 v11, s40, v6
  v_xor_b32 v12, v11, v10
  v_lshl_add_u32 v12, v12, 4, v7
  v_add_u32 v11, 4, v11
  v_xor_b32 v14, v11, v10
  v_lshl_add_u32 v14, v14, 4, v7
  s_lshl_b32 s40, s38, 14
  v_add_u32 v12, s40, v12
  v_add_u32 v14, s40, v14
  v_add_u32 v13, 8, v12
  v_add_u32 v15, 8, v14
  s_branch L_g1_ad
L_g1_af:
  s_lshl_b32 s40, s29, 2
  v_add_u32 v11, s40, v6
  v_xor_b32 v12, v11, v10
  v_lshl_add_u32 v12, v12, 4, v7
  v_add_u32 v13, 8, v12
  v_add_u32 v14, 16384, v12
  v_add_u32 v15, 16384, v13
  s_branch L_g1_ad
L_g1_av:
  v_lshrrev_b32 v11, 1, v6
  s_lshl_b32 s40, s39, 3
  v_add_u32 v11, s40, v11
  v_and_b32 v16, 1, v6
  v_lshl_add_u32 v16, v16, 3, v7
  v_add_u32 v16, 16384, v16
  v_add_u32 v17, 0, v11
  v_xor_b32 v17, v17, v10
  v_lshl_add_u32 v12, v17, 4, v16
  v_add_u32 v17, 2, v11
  v_xor_b32 v17, v17, v10
  v_lshl_add_u32 v13, v17, 4, v16
  v_add_u32 v17, 4, v11
  v_xor_b32 v17, v17, v10
  v_lshl_add_u32 v14, v17, 4, v16
  v_add_u32 v17, 6, v11
  v_xor_b32 v17, v17, v10
  v_lshl_add_u32 v15, v17, 4, v16
L_g1_ad:
  s_waitcnt lgkmcnt(0)
  s_mov_b32 s51, s38
  s_cmp_eq_u32 s28, 0
  s_cbranch_scc1 L_g1a_kd
  s_load_dwordx2 s[20:21], s[0:1], 104
  s_mov_b32 s22, 256
  s_mov_b32 s23, 0x20000
  s_mov_b32 s38, 0
  s_waitcnt lgkmcnt(0)
L_g1a_wi:
  buffer_load_dword v1, off, s[20:23], 0 offset:128 sc1
  s_waitcnt vmcnt(0)
  v_cmp_eq_u32 vcc, 0, v1
  s_cbranch_vccz L_g1a_wd
  s_sleep 8
  s_add_u32 s38, s38, 1
  s_cmp_lt_u32 s38, 0x100000
  s_cbranch_scc1 L_g1a_wi
  s_branch L_end
L_g1a_wd:
  s_cmp_eq_u32 s28, 2
  s_cbranch_scc1 L_g1a_kd
  s_and_b32 s22, s2, 31
  s_add_u32 s22, s22, 64
  s_lshl_b32 s22, s22, 7
  s_add_u32 s22, s22, 100663296
  s_mov_b32 s38, 0
L_g1a_ki:
  buffer_load_dword v1, off, s[4:7], s22 sc1
  s_waitcnt vmcnt(0)
  v_cmp_gt_u32 vcc, 3, v1
  s_cbranch_vccz L_g1a_kd
  s_sleep 16
  s_add_u32 s38, s38, 1
  s_cmp_lt_u32 s38, 0x100000
  s_cbranch_scc1 L_g1a_ki
  s_branch L_end
L_g1a_kd:
  s_mov_b32 s38, s51
  s_add_u32 m0, s45, 0
  s_nop 0
  buffer_load_dwordx4 v8, s[8:11], 0 offen lds
  v_add_u32 v8, s41, v8
  s_add_u32 m0, s45, 4096
  s_nop 0
  buffer_load_dwordx4 v8, s[8:11], 0 offen lds
  v_add_u32 v8, s41, v8
  s_add_u32 m0, s45, 8192
  s_nop 0
  buffer_load_dwordx4 v8, s[8:11], 0 offen lds
  v_add_u32 v8, s41, v8
  s_add_u32 m0, s45, 12288
  s_nop 0
  buffer_load_dwordx4 v8, s[8:11], 0 offen lds
  v_add_u32 v8, s41, v8
  s_add_u32 m0, s45, 16384
  s_nop 0
  buffer_load_dwordx4 v9, s[12:15], 0 offen lds
  v_add_u32 v9, s41, v9
  s_add_u32 m0, s45, 20480
  s_nop 0
  buffer_load_dwordx4 v9, s[12:15], 0 offen lds
  v_add_u32 v9, s41, v9
  s_add_u32 m0, s45, 24576
  s_nop 0
  buffer_load_dwordx4 v9, s[12:15], 0 offen lds
  v_add_u32 v9, s41, v9
  s_add_u32 m0, s45, 28672
  s_nop 0
  buffer_load_dwordx4 v9, s[12:15], 0 offen lds
  v_add_u32 v9, s41, v9
  s_add_u32 m0, s45, 32768
  s_nop 0
  buffer_load_dwordx4 v8, s[8:11], 0 offen lds
  v_add_u32 v8, s41, v8
  s_add_u32 m0, s45, 36864
  s_nop 0
  buffer_load_dwordx4 v8, s[8:11], 0 offen lds
  v_add_u32 v8, s41, v8
  s_add_u32 m0, s45, 40960
  s_nop 0
  buffer_load_dwordx4 v8, s[8:11], 0 offen lds
  v_add_u32 v8, s41, v8
  s_add_u32 m0, s45, 45056
  s_nop 0
  buffer_load_dwordx4 v8, s[8:11], 0 offen lds
  v_add_u32 v8, s41, v8
  s_add_u32 m0, s45, 49152
  s_nop 0
  buffer_load_dwordx4 v9, s[12:15], 0 offen lds
  v_add_u32 v9, s41, v9
  s_add_u32 m0, s45, 53248
  s_nop 0
  buffer_load_dwordx4 v9, s[12:15], 0 offen lds
  v_add_u32 v9, s41, v9
  s_add_u32 m0, s45, 57344
  s_nop 0
  buffer_load_dwordx4 v9, s[12:15], 0 offen lds
  v_add_u32 v9, s41, v9
  s_add_u32 m0, s45, 61440
  s_nop 0
  buffer_load_dwordx4 v9, s[12:15], 0 offen lds
  v_add_u32 v9, s41, v9
  s_add_u32 m0, s45, 65536
  s_nop 0
  buffer_load_dwordx4 v8, s[8:11], 0 offen lds
  v_add_u32 v8, s41, v8
  s_add_u32 m0, s45, 69632
  s_nop 0
  buffer_load_dwordx4 v8, s[8:11], 0 offen lds
  v_add_u32 v8, s41, v8
  s_add_u32 m0, s45, 73728
  s_nop 0
  buffer_load_dwordx4 v8, s[8:11], 0 offen lds
  v_add_u32 v8, s41, v8
  s_add_u32 m0, s45, 77824
  s_nop 0
  buffer_load_dwordx4 v8, s[8:11], 0 offen lds
  v_add_u32 v8, s41, v8
  s_add_u32 m0, s45, 81920
  s_nop 0
  buffer_load_dwordx4 v9, s[12:15], 0 offen lds
  v_add_u32 v9, s41, v9
  s_add_u32 m0, s45, 86016
  s_nop 0
  buffer_load_dwordx4 v9, s[12:15], 0 offen lds
  v_add_u32 v9, s41, v9
  s_add_u32 m0, s45, 90112
  s_nop 0
  buffer_load_dwordx4 v9, s[12:15], 0 offen lds
  v_add_u32 v9, s41, v9
  s_add_u32 m0, s45, 94208
  s_nop 0
  buffer_load_dwordx4 v9, s[12:15], 0 offen lds
  v_add_u32 v9, s41, v9
  s_add_u32 m0, s45, 98304
  s_nop 0
  buffer_load_dwordx4 v8, s[8:11], 0 offen lds
  v_add_u32 v8, s41, v8
  s_add_u32 m0, s45, 102400
  s_nop 0
  buffer_load_dwordx4 v8, s[8:11], 0 offen lds
  v_add_u32 v8, s41, v8
  s_add_u32 m0, s45, 106496
  s_nop 0
  buffer_load_dwordx4 v8, s[8:11], 0 offen lds
  v_add_u32 v8, s41, v8
  s_add_u32 m0, s45, 110592
  s_nop 0
  buffer_load_dwordx4 v8, s[8:11], 0 offen lds
  v_add_u32 v8, s41, v8
  s_add_u32 m0, s45, 114688
  s_nop 0
  buffer_load_dwordx4 v9, s[12:15], 0 offen lds
  v_add_u32 v9, s41, v9
  s_add_u32 m0, s45, 118784
  s_nop 0
  buffer_load_dwordx4 v9, s[12:15], 0 offen lds
  v_add_u32 v9, s41, v9
  s_add_u32 m0, s45, 122880
  s_nop 0
  buffer_load_dwordx4 v9, s[12:15], 0 offen lds
  v_add_u32 v9, s41, v9
  s_add_u32 m0, s45, 126976
  s_nop 0
  buffer_load_dwordx4 v9, s[12:15], 0 offen lds
  v_add_u32 v9, s41, v9
  s_waitcnt vmcnt(24)
  s_barrier
  s_add_u32 m0, s45, 131072
  s_nop 0
  buffer_load_dwordx4 v8, s[8:11], 0 offen lds
  v_add_u32 v8, s41, v8
  s_add_u32 m0, s45, 135168
  s_nop 0
  buffer_load_dwordx4 v8, s[8:11], 0 offen lds
  v_add_u32 v8, s41, v8
  s_add_u32 m0, s45, 139264
  s_nop 0
  buffer_load_dwordx4 v8, s[8:11], 0 offen lds
  v_add_u32 v8, s41, v8
  s_add_u32 m0, s45, 143360
  s_nop 0
  buffer_load_dwordx4 v8, s[8:11], 0 offen lds
  v_add_u32 v8, s41, v8
  s_add_u32 m0, s45, 147456
  s_nop 0
  buffer_load_dwordx4 v9, s[12:15], 0 offen lds
  v_add_u32 v9, s41, v9
  s_add_u32 m0, s45, 151552
  s_nop 0
  buffer_load_dwordx4 v9, s[12:15], 0 offen lds
  v_add_u32 v9, s41, v9
  s_add_u32 m0, s45, 155648
  s_nop 0
  buffer_load_dwordx4 v9, s[12:15], 0 offen lds
  v_add_u32 v9, s41, v9
  s_add_u32 m0, s45, 159744
  s_nop 0
  buffer_load_dwordx4 v9, s[12:15], 0 offen lds
  v_add_u32 v9, s41, v9
  v_add_u32 v20, 0, v12
  v_add_u32 v21, 0, v13
  v_add_u32 v22, 0, v14
  v_add_u32 v23, 0, v15
  ds_read_b64_tr_b16 a[0:1], v20 offset:0
  ds_read_b64_tr_b16 a[2:3], v20 offset:1024
  ds_read_b64_tr_b16 a[4:5], v21 offset:0
  ds_read_b64_tr_b16 a[6:7], v21 offset:1024
  ds_read_b64_tr_b16 a[8:9], v22 offset:0
  ds_read_b64_tr_b16 a[10:11], v22 offset:1024
  ds_read_b64_tr_b16 a[12:13], v23 offset:0
  ds_read_b64_tr_b16 a[14:15], v23 offset:1024
  s_waitcnt lgkmcnt(0)
  ds_read_b64_tr_b16 a[16:17], v20 offset:8192
  ds_read_b64_tr_b16 a[18:19], v20 offset:9216
  ds_read_b64_tr_b16 a[20:21], v21 offset:8192
  ds_read_b64_tr_b16 a[22:23], v21 offset:9216
  ds_read_b64_tr_b16 a[24:25], v22 offset:8192
  ds_read_b64_tr_b16 a[26:27], v22 offset:9216
  ds_read_b64_tr_b16 a[28:29], v23 offset:8192
  ds_read_b64_tr_b16 a[30:31], v23 offset:9216
  s_waitcnt lgkmcnt(0)
  s_waitcnt vmcnt(24)
  s_barrier
  s_add_u32 m0, s45, 0
  s_nop 0
  buffer_load_dwordx4 v8, s[8:11], 0 offen lds
  v_add_u32 v8, s41, v8
  s_add_u32 m0, s45, 4096
  s_nop 0
  buffer_load_dwordx4 v8, s[8:11], 0 offen lds
  v_add_u32 v8, s41, v8
  s_add_u32 m0, s45, 8192
  s_nop 0
  buffer_load_dwordx4 v8, s[8:11], 0 offen lds
  v_add_u32 v8, s41, v8
  s_add_u32 m0, s45, 12288
  s_nop 0
  buffer_load_dwordx4 v8, s[8:11], 0 offen lds
  v_add_u32 v8, s41, v8
  s_add_u32 m0, s45, 16384
  s_nop 0
  buffer_load_dwordx4 v9, s[12:15], 0 offen lds
  v_add_u32 v9, s41, v9
  s_add_u32 m0, s45, 20480
  s_nop 0
  buffer_load_dwordx4 v9, s[12:15], 0 offen lds
  v_add_u32 v9, s41, v9
  s_add_u32 m0, s45, 24576
  s_nop 0
  buffer_load_dwordx4 v9, s[12:15], 0 offen lds
  v_add_u32 v9, s41, v9
  s_add_u32 m0, s45, 28672
  s_nop 0
  buffer_load_dwordx4 v9, s[12:15], 0 offen lds
  v_add_u32 v9, s41, v9
  v_add_u32 v20, 32768, v12
  v_add_u32 v21, 32768, v13
  v_add_u32 v22, 32768, v14
  v_add_u32 v23, 32768, v15
  ds_read_b64_tr_b16 a[32:33], v20 offset:0
  ds_read_b64_tr_b16 a[34:35], v20 offset:1024
  ds_read_b64_tr_b16 a[36:37], v21 offset:0
  ds_read_b64_tr_b16 a[38:39], v21 offset:1024
  ds_read_b64_tr_b16 a[40:41], v22 offset:0
  ds_read_b64_tr_b16 a[42:43], v22 offset:1024
  ds_read_b64_tr_b16 a[44:45], v23 offset:0
  ds_read_b64_tr_b16 a[46:47], v23 offset:1024
  s_waitcnt lgkmcnt(0)
  ds_read_b64_tr_b16 a[48:49], v20 offset:8192
  ds_read_b64_tr_b16 a[50:51], v20 offset:9216
  ds_read_b64_tr_b16 a[52:53], v21 offset:8192
  ds_read_b64_tr_b16 a[54:55], v21 offset:9216
  ds_read_b64_tr_b16 a[56:57], v22 offset:8192
  ds_read_b64_tr_b16 a[58:59], v22 offset:9216
  ds_read_b64_tr_b16 a[60:61], v23 offset:8192
  ds_read_b64_tr_b16 a[62:63], v23 offset:9216
  s_waitcnt lgkmcnt(0)
  s_waitcnt vmcnt(24)
  s_barrier
  s_add_u32 m0, s45, 32768
  s_nop 0
  buffer_load_dwordx4 v8, s[8:11], 0 offen lds
  v_add_u32 v8, s41, v8
  s_add_u32 m0, s45, 36864
  s_nop 0
  buffer_load_dwordx4 v8, s[8:11], 0 offen lds
  v_add_u32 v8, s41, v8
  s_add_u32 m0, s45, 40960
  s_nop 0
  buffer_load_dwordx4 v8, s[8:11], 0 offen lds
  v_add_u32 v8, s41, v8
  s_add_u32 m0, s45, 45056
  s_nop 0
  buffer_load_dwordx4 v8, s[8:11], 0 offen lds
  v_add_u32 v8, s41, v8
  s_add_u32 m0, s45, 49152
  s_nop 0
  buffer_load_dwordx4 v9, s[12:15], 0 offen lds
  v_add_u32 v9, s41, v9
  s_add_u32 m0, s45, 53248
  s_nop 0
  buffer_load_dwordx4 v9, s[12:15], 0 offen lds
  v_add_u32 v9, s41, v9
  s_add_u32 m0, s45, 57344
  s_nop 0
  buffer_load_dwordx4 v9, s[12:15], 0 offen lds
  v_add_u32 v9, s41, v9
  s_add_u32 m0, s45, 61440
  s_nop 0
  buffer_load_dwordx4 v9, s[12:15], 0 offen lds
  v_add_u32 v9, s41, v9
  v_add_u32 v20, 65536, v12
  v_add_u32 v21, 65536, v13
  v_add_u32 v22, 65536, v14
  v_add_u32 v23, 65536, v15
  ds_read_b64_tr_b16 a[64:65], v20 offset:0
  ds_read_b64_tr_b16 a[66:67], v20 offset:1024
  ds_read_b64_tr_b16 a[68:69], v21 offset:0
  ds_read_b64_tr_b16 a[70:71], v21 offset:1024
  ds_read_b64_tr_b16 a[72:73], v22 offset:0
  ds_read_b64_tr_b16 a[74:75], v22 offset:1024
  ds_read_b64_tr_b16 a[76:77], v23 offset:0
  ds_read_b64_tr_b16 a[78:79], v23 offset:1024
  s_waitcnt lgkmcnt(0)
  ds_read_b64_tr_b16 a[80:81], v20 offset:8192
  ds_read_b64_tr_b16 a[82:83], v20 offset:9216
  ds_read_b64_tr_b16 a[84:85], v21 offset:8192
  ds_read_b64_tr_b16 a[86:87], v21 offset:9216
  ds_read_b64_tr_b16 a[88:89], v22 offset:8192
  ds_read_b64_tr_b16 a[90:91], v22 offset:9216
  ds_read_b64_tr_b16 a[92:93], v23 offset:8192
  ds_read_b64_tr_b16 a[94:95], v23 offset:9216
  s_waitcnt lgkmcnt(0)
  s_waitcnt vmcnt(24)
  s_barrier
  s_add_u32 m0, s45, 65536
  s_nop 0
  buffer_load_dwordx4 v8, s[8:11], 0 offen lds
  v_add_u32 v8, s41, v8
  s_add_u32 m0, s45, 69632
  s_nop 0
  buffer_load_dwordx4 v8, s[8:11], 0 offen lds
  v_add_u32 v8, s41, v8
  s_add_u32 m0, s45, 73728
  s_nop 0
  buffer_load_dwordx4 v8, s[8:11], 0 offen lds
  v_add_u32 v8, s41, v8
  s_add_u32 m0, s45, 77824
  s_nop 0
  buffer_load_dwordx4 v8, s[8:11], 0 offen lds
  v_add_u32 v8, s41, v8
  s_add_u32 m0, s45, 81920
  s_nop 0
  buffer_load_dwordx4 v9, s[12:15], 0 offen lds
  v_add_u32 v9, s41, v9
  s_add_u32 m0, s45, 86016
  s_nop 0
  buffer_load_dwordx4 v9, s[12:15], 0 offen lds
  v_add_u32 v9, s41, v9
  s_add_u32 m0, s45, 90112
  s_nop 0
  buffer_load_dwordx4 v9, s[12:15], 0 offen lds
  v_add_u32 v9, s41, v9
  s_add_u32 m0, s45, 94208
  s_nop 0
  buffer_load_dwordx4 v9, s[12:15], 0 offen lds
  v_add_u32 v9, s41, v9
  v_add_u32 v20, 98304, v12
  v_add_u32 v21, 98304, v13
  v_add_u32 v22, 98304, v14
  v_add_u32 v23, 98304, v15
  ds_read_b64_tr_b16 a[96:97], v20 offset:0
  ds_read_b64_tr_b16 a[98:99], v20 offset:1024
  ds_read_b64_tr_b16 a[100:101], v21 offset:0
  ds_read_b64_tr_b16 a[102:103], v21 offset:1024
  ds_read_b64_tr_b16 a[104:105], v22 offset:0
  ds_read_b64_tr_b16 a[106:107], v22 offset:1024
  ds_read_b64_tr_b16 a[108:109], v23 offset:0
  ds_read_b64_tr_b16 a[110:111], v23 offset:1024
  s_waitcnt lgkmcnt(0)
  ds_read_b64_tr_b16 a[112:113], v20 offset:8192
  ds_read_b64_tr_b16 a[114:115], v20 offset:9216
  ds_read_b64_tr_b16 a[116:117], v21 offset:8192
  ds_read_b64_tr_b16 a[118:119], v21 offset:9216
  ds_read_b64_tr_b16 a[120:121], v22 offset:8192
  ds_read_b64_tr_b16 a[122:123], v22 offset:9216
  ds_read_b64_tr_b16 a[124:125], v23 offset:8192
  ds_read_b64_tr_b16 a[126:127], v23 offset:9216
  s_waitcnt lgkmcnt(0)
  s_waitcnt vmcnt(24)
  s_barrier
  s_add_u32 m0, s45, 98304
  s_nop 0
  buffer_load_dwordx4 v8, s[8:11], 0 offen lds
  v_add_u32 v8, s41, v8
  s_add_u32 m0, s45, 102400
  s_nop 0
  buffer_load_dwordx4 v8, s[8:11], 0 offen lds
  v_add_u32 v8, s41, v8
  s_add_u32 m0, s45, 106496
  s_nop 0
  buffer_load_dwordx4 v8, s[8:11], 0 offen lds
  v_add_u32 v8, s41, v8
  s_add_u32 m0, s45, 110592
  s_nop 0
  buffer_load_dwordx4 v8, s[8:11], 0 offen lds
  v_add_u32 v8, s41, v8
  s_add_u32 m0, s45, 114688
  s_nop 0
  buffer_load_dwordx4 v9, s[12:15], 0 offen lds
  v_add_u32 v9, s41, v9
  s_add_u32 m0, s45, 118784
  s_nop 0
  buffer_load_dwordx4 v9, s[12:15], 0 offen lds
  v_add_u32 v9, s41, v9
  s_add_u32 m0, s45, 122880
  s_nop 0
  buffer_load_dwordx4 v9, s[12:15], 0 offen lds
  v_add_u32 v9, s41, v9
  s_add_u32 m0, s45, 126976
  s_nop 0
  buffer_load_dwordx4 v9, s[12:15], 0 offen lds
  v_add_u32 v9, s41, v9
  v_add_u32 v20, 131072, v12
  v_add_u32 v21, 131072, v13
  v_add_u32 v22, 131072, v14
  v_add_u32 v23, 131072, v15
  ds_read_b64_tr_b16 a[128:129], v20 offset:0
  ds_read_b64_tr_b16 a[130:131], v20 offset:1024
  ds_read_b64_tr_b16 a[132:133], v21 offset:0
  ds_read_b64_tr_b16 a[134:135], v21 offset:1024
  ds_read_b64_tr_b16 a[136:137], v22 offset:0
  ds_read_b64_tr_b16 a[138:139], v22 offset:1024
  ds_read_b64_tr_b16 a[140:141], v23 offset:0
  ds_read_b64_tr_b16 a[142:143], v23 offset:1024
  s_waitcnt lgkmcnt(0)
  ds_read_b64_tr_b16 a[144:145], v20 offset:8192
  ds_read_b64_tr_b16 a[146:147], v20 offset:9216
  ds_read_b64_tr_b16 a[148:149], v21 offset:8192
  ds_read_b64_tr_b16 a[150:151], v21 offset:9216
  ds_read_b64_tr_b16 a[152:153], v22 offset:8192
  ds_read_b64_tr_b16 a[154:155], v22 offset:9216
  ds_read_b64_tr_b16 a[156:157], v23 offset:8192
  ds_read_b64_tr_b16 a[158:159], v23 offset:9216
  s_waitcnt lgkmcnt(0)
  s_waitcnt vmcnt(24)
  s_barrier
  s_add_u32 m0, s45, 131072
  s_nop 0
  buffer_load_dwordx4 v8, s[8:11], 0 offen lds
  v_add_u32 v8, s41, v8
  s_add_u32 m0, s45, 135168
  s_nop 0
  buffer_load_dwordx4 v8, s[8:11], 0 offen lds
  v_add_u32 v8, s41, v8
  s_add_u32 m0, s45, 139264
  s_nop 0
  buffer_load_dwordx4 v8, s[8:11], 0 offen lds
  v_add_u32 v8, s41, v8
  s_add_u32 m0, s45, 143360
  s_nop 0
  buffer_load_dwordx4 v8, s[8:11], 0 offen lds
  v_add_u32 v8, s41, v8
  s_add_u32 m0, s45, 147456
  s_nop 0
  buffer_load_dwordx4 v9, s[12:15], 0 offen lds
  v_add_u32 v9, s41, v9
  s_add_u32 m0, s45, 151552
  s_nop 0
  buffer_load_dwordx4 v9, s[12:15], 0 offen lds
  v_add_u32 v9, s41, v9
  s_add_u32 m0, s45, 155648
  s_nop 0
  buffer_load_dwordx4 v9, s[12:15], 0 offen lds
  v_add_u32 v9, s41, v9
  s_add_u32 m0, s45, 159744
  s_nop 0
  buffer_load_dwordx4 v9, s[12:15], 0 offen lds
  v_add_u32 v9, s41, v9
  v_add_u32 v20, 0, v12
  v_add_u32 v21, 0, v13
  v_add_u32 v22, 0, v14
  v_add_u32 v23, 0, v15
  ds_read_b64_tr_b16 a[160:161], v20 offset:0
  ds_read_b64_tr_b16 a[162:163], v20 offset:1024
  ds_read_b64_tr_b16 a[164:165], v21 offset:0
  ds_read_b64_tr_b16 a[166:167], v21 offset:1024
  ds_read_b64_tr_b16 a[168:169], v22 offset:0
  ds_read_b64_tr_b16 a[170:171], v22 offset:1024
  ds_read_b64_tr_b16 a[172:173], v23 offset:0
  ds_read_b64_tr_b16 a[174:175], v23 offset:1024
  s_waitcnt lgkmcnt(0)
  ds_read_b64_tr_b16 a[176:177], v20 offset:8192
  ds_read_b64_tr_b16 a[178:179], v20 offset:9216
  ds_read_b64_tr_b16 a[180:181], v21 offset:8192
  ds_read_b64_tr_b16 a[182:183], v21 offset:9216
  ds_read_b64_tr_b16 a[184:185], v22 offset:8192
  ds_read_b64_tr_b16 a[186:187], v22 offset:9216
  ds_read_b64_tr_b16 a[188:189], v23 offset:8192
  ds_read_b64_tr_b16 a[190:191], v23 offset:9216
  s_waitcnt lgkmcnt(0)
  s_waitcnt vmcnt(24)
  s_barrier
  v_add_u32 v20, 32768, v12
  v_add_u32 v21, 32768, v13
  v_add_u32 v22, 32768, v14
  v_add_u32 v23, 32768, v15
  ds_read_b64_tr_b16 a[192:193], v20 offset:0
  ds_read_b64_tr_b16 a[194:195], v20 offset:1024
  ds_read_b64_tr_b16 a[196:197], v21 offset:0
  ds_read_b64_tr_b16 a[198:199], v21 offset:1024
  ds_read_b64_tr_b16 a[200:201], v22 offset:0
  ds_read_b64_tr_b16 a[202:203], v22 offset:1024
  ds_read_b64_tr_b16 a[204:205], v23 offset:0
  ds_read_b64_tr_b16 a[206:207], v23 offset:1024
  s_waitcnt lgkmcnt(0)
  ds_read_b64_tr_b16 a[208:209], v20 offset:8192
  ds_read_b64_tr_b16 a[210:211], v20 offset:9216
  ds_read_b64_tr_b16 a[212:213], v21 offset:8192
  ds_read_b64_tr_b16 a[214:215], v21 offset:9216
  ds_read_b64_tr_b16 a[216:217], v22 offset:8192
  ds_read_b64_tr_b16 a[218:219], v22 offset:9216
  ds_read_b64_tr_b16 a[220:221], v23 offset:8192
  ds_read_b64_tr_b16 a[222:223], v23 offset:9216
  s_waitcnt lgkmcnt(0)
  s_waitcnt vmcnt(16)
  s_barrier
  v_lshrrev_b32 v4, 3, v2
  v_and_b32 v5, 7, v2
  v_xor_b32 v5, v5, v4
  s_lshl_b32 s40, s29, 3
  v_add_u32 v4, s40, v4
  v_mul_u32_u24 v4, 1280, v4
  v_lshl_add_u32 v8, v5, 4, v4
  v_and_b32 v4, 15, v2
  v_lshrrev_b32 v5, 4, v2
  v_and_b32 v6, 7, v2
  v_xor_b32 v5, v5, v6
  v_lshlrev_b32 v5, 4, v5
  v_lshl_add_u32 v9, v4, 7, v5
  s_mov_b32 s42, 0
  s_mov_b32 s43, 0
  s_mov_b32 s46, 0
  s_mov_b32 s47, 40960
  s_mov_b32 s48, 81920
  s_lshl_b32 s40, s38, 13
  s_lshl_b32 s44, s39, 11
  s_add_u32 s44, s44, s40
  s_cmp_eq_u32 s28, 0
  s_cselect_b32 s40, 4096, 0
  s_add_u32 s44, s44, s40
  s_mul_i32 s40, s39, 12288
  s_cmp_eq_u32 s37, 1
  s_cselect_b32 s44, s40, s44
  s_lshl_b32 s40, s29, 11
  s_cmp_ge_u32 s37, 2
  s_cselect_b32 s44, s40, s44
  s_add_u32 s34, s34, s44
  s_mov_b32 s49, 0xbfb8aa3b
  s_add_u32 s52, s46, s45
  s_min_u32 s44, s43, 2580480
  s_add_u32 s43, s43, 40960
  s_add_u32 m0, s52, 0
  s_add_u32 s53, s44, 0
  buffer_load_dwordx4 v8, s[16:19], s53 offen lds
  s_add_u32 m0, s52, 4096
  s_add_u32 s53, s44, 128
  buffer_load_dwordx4 v8, s[16:19], s53 offen lds
  s_add_u32 m0, s52, 8192
  s_add_u32 s53, s44, 256
  buffer_load_dwordx4 v8, s[16:19], s53 offen lds
  s_add_u32 m0, s52, 12288
  s_add_u32 s53, s44, 384
  buffer_load_dwordx4 v8, s[16:19], s53 offen lds
  s_add_u32 m0, s52, 16384
  s_add_u32 s53, s44, 512
  buffer_load_dwordx4 v8, s[16:19], s53 offen lds
  s_add_u32 m0, s52, 20480
  s_add_u32 s53, s44, 640
  buffer_load_dwordx4 v8, s[16:19], s53 offen lds
  s_add_u32 m0, s52, 24576
  s_add_u32 s53, s44, 768
  buffer_load_dwordx4 v8, s[16:19], s53 offen lds
  s_add_u32 m0, s52, 28672
  s_add_u32 s53, s44, 896
  buffer_load_dwordx4 v8, s[16:19], s53 offen lds
  s_add_u32 m0, s52, 32768
  s_add_u32 s53, s44, 1024
  buffer_load_dwordx4 v8, s[16:19], s53 offen lds
  s_add_u32 m0, s52, 36864
  s_add_u32 s53, s44, 1152
  buffer_load_dwordx4 v8, s[16:19], s53 offen lds
  v_add_u32 v20, 65536, v12
  v_add_u32 v21, 65536, v13
  v_add_u32 v22, 65536, v14
  v_add_u32 v23, 65536, v15
  ds_read_b64_tr_b16 a[224:225], v20 offset:0
  ds_read_b64_tr_b16 a[226:227], v20 offset:1024
  ds_read_b64_tr_b16 a[228:229], v21 offset:0
  ds_read_b64_tr_b16 a[230:231], v21 offset:1024
  ds_read_b64_tr_b16 a[232:233], v22 offset:0
  ds_read_b64_tr_b16 a[234:235], v22 offset:1024
  ds_read_b64_tr_b16 a[236:237], v23 offset:0
  ds_read_b64_tr_b16 a[238:239], v23 offset:1024
  s_waitcnt lgkmcnt(0)
  ds_read_b64_tr_b16 a[240:241], v20 offset:8192
  ds_read_b64_tr_b16 a[242:243], v20 offset:9216
  ds_read_b64_tr_b16 a[244:245], v21 offset:8192
  ds_read_b64_tr_b16 a[246:247], v21 offset:9216
  ds_read_b64_tr_b16 a[248:249], v22 offset:8192
  ds_read_b64_tr_b16 a[250:251], v22 offset:9216
  ds_read_b64_tr_b16 a[252:253], v23 offset:8192
  ds_read_b64_tr_b16 a[254:255], v23 offset:9216
  s_waitcnt lgkmcnt(0)
  s_waitcnt vmcnt(18)
  s_barrier
  s_add_u32 s52, s47, s45
  s_min_u32 s44, s43, 2580480
  s_add_u32 s43, s43, 40960
  s_add_u32 m0, s52, 0
  s_add_u32 s53, s44, 0
  buffer_load_dwordx4 v8, s[16:19], s53 offen lds
  s_add_u32 m0, s52, 4096
  s_add_u32 s53, s44, 128
  buffer_load_dwordx4 v8, s[16:19], s53 offen lds
  s_add_u32 m0, s52, 8192
  s_add_u32 s53, s44, 256
  buffer_load_dwordx4 v8, s[16:19], s53 offen lds
  s_add_u32 m0, s52, 12288
  s_add_u32 s53, s44, 384
  buffer_load_dwordx4 v8, s[16:19], s53 offen lds
  s_add_u32 m0, s52, 16384
  s_add_u32 s53, s44, 512
  buffer_load_dwordx4 v8, s[16:19], s53 offen lds
  s_add_u32 m0, s52, 20480
  s_add_u32 s53, s44, 640
  buffer_load_dwordx4 v8, s[16:19], s53 offen lds
  s_add_u32 m0, s52, 24576
  s_add_u32 s53, s44, 768
  buffer_load_dwordx4 v8, s[16:19], s53 offen lds
  s_add_u32 m0, s52, 28672
  s_add_u32 s53, s44, 896
  buffer_load_dwordx4 v8, s[16:19], s53 offen lds
  s_add_u32 m0, s52, 32768
  s_add_u32 s53, s44, 1024
  buffer_load_dwordx4 v8, s[16:19], s53 offen lds
  s_add_u32 m0, s52, 36864
  s_add_u32 s53, s44, 1152
  buffer_load_dwordx4 v8, s[16:19], s53 offen lds
  v_add_u32 v20, 98304, v12
  v_add_u32 v21, 98304, v13
  v_add_u32 v22, 98304, v14
  v_add_u32 v23, 98304, v15
  ds_read_b64_tr_b16 v[192:193], v20 offset:0
  ds_read_b64_tr_b16 v[194:195], v20 offset:1024
  ds_read_b64_tr_b16 v[196:197], v21 offset:0
  ds_read_b64_tr_b16 v[198:199], v21 offset:1024
  ds_read_b64_tr_b16 v[200:201], v22 offset:0
  ds_read_b64_tr_b16 v[202:203], v22 offset:1024
  ds_read_b64_tr_b16 v[204:205], v23 offset:0
  ds_read_b64_tr_b16 v[206:207], v23 offset:1024
  s_waitcnt lgkmcnt(0)
  ds_read_b64_tr_b16 v[208:209], v20 offset:8192
  ds_read_b64_tr_b16 v[210:211], v20 offset:9216
  ds_read_b64_tr_b16 v[212:213], v21 offset:8192
  ds_read_b64_tr_b16 v[214:215], v21 offset:9216
  ds_read_b64_tr_b16 v[216:217], v22 offset:8192
  ds_read_b64_tr_b16 v[218:219], v22 offset:9216
  ds_read_b64_tr_b16 v[220:221], v23 offset:8192
  ds_read_b64_tr_b16 v[222:223], v23 offset:9216
  s_waitcnt lgkmcnt(0)
  s_waitcnt vmcnt(20)
  s_barrier
  v_add_u32 v20, 131072, v12
  v_add_u32 v21, 131072, v13
  v_add_u32 v22, 131072, v14
  v_add_u32 v23, 131072, v15
  ds_read_b64_tr_b16 v[224:225], v20 offset:0
  ds_read_b64_tr_b16 v[226:227], v20 offset:1024
  ds_read_b64_tr_b16 v[228:229], v21 offset:0
  ds_read_b64_tr_b16 v[230:231], v21 offset:1024
  ds_read_b64_tr_b16 v[232:233], v22 offset:0
  ds_read_b64_tr_b16 v[234:235], v22 offset:1024
  ds_read_b64_tr_b16 v[236:237], v23 offset:0
  ds_read_b64_tr_b16 v[238:239], v23 offset:1024
  s_waitcnt lgkmcnt(0)
  ds_read_b64_tr_b16 v[240:241], v20 offset:8192
  ds_read_b64_tr_b16 v[242:243], v20 offset:9216
  ds_read_b64_tr_b16 v[244:245], v21 offset:8192
  ds_read_b64_tr_b16 v[246:247], v21 offset:9216
  ds_read_b64_tr_b16 v[248:249], v22 offset:8192
  ds_read_b64_tr_b16 v[250:251], v22 offset:9216
  ds_read_b64_tr_b16 v[252:253], v23 offset:8192
  ds_read_b64_tr_b16 v[254:255], v23 offset:9216
  s_waitcnt lgkmcnt(0)
  s_barrier
  s_load_dwordx2 s[20:21], s[0:1], 104
  s_mov_b32 s22, 256
  s_mov_b32 s23, 0x20000
  v_mov_b32 v7, 0
  s_waitcnt vmcnt(10) lgkmcnt(0)
  s_barrier
  v_add_u32 v4, s46, v9
  v_xor_b32 v6, 64, v4
  v_add_u32 v10, s47, v9
  v_xor_b32 v11, 64, v10
  ds_read_b128 v[64:67], v4 offset:0
  ds_read_b128 v[68:71], v4 offset:2048
  ds_read_b128 v[72:75], v6 offset:0
  ds_read_b128 v[76:79], v6 offset:2048
  ds_read_b128 v[80:83], v4 offset:4096
  ds_read_b128 v[84:87], v4 offset:6144
  s_cmp_eq_u32 s37, 1
  s_cbranch_scc1 L_g1_V
  s_cmp_eq_u32 s37, 2
  s_cbranch_scc1 L_g1_F
  s_cmp_eq_u32 s37, 3
  s_cbranch_scc1 L_g1_I
  s_sub_u32 s34, s34, s35
  s_branch L_g1_K0
L_g1_Kloop:
  s_waitcnt lgkmcnt(4)
  v_mfma_f32_16x16x32_bf16 v[32:35], a[0:3], v[64:67], 0
  buffer_store_dwordx4 v[96:99], v3, s[4:7], s34 offen offset:0 sc1
  v_mfma_f32_16x16x32_bf16 v[36:39], a[0:3], v[68:71], 0
  s_nop 0
  s_nop 0
  ds_read_b128 v[88:91], v6 offset:4096
  ds_read_b128 v[92:95], v6 offset:6144
  v_mfma_f32_16x16x32_bf16 v[40:43], a[4:7], v[64:67], 0
  s_nop 0
  s_nop 0
  v_mfma_f32_16x16x32_bf16 v[44:47], a[4:7], v[68:71], 0
  buffer_store_dwordx4 v[100:103], v3, s[4:7], s34 offen offset:1024 sc1
  v_mfma_f32_16x16x32_bf16 v[48:51], a[8:11], v[64:67], 0
  s_nop 0
  s_nop 0
  v_mfma_f32_16x16x32_bf16 v[52:55], a[8:11], v[68:71], 0
  s_nop 0
  s_nop 0
  v_mfma_f32_16x16x32_bf16 v[56:59], a[12:15], v[64:67], 0
  buffer_store_dwordx4 v[104:107], v3, s[4:7], s54 offen offset:0 sc1
  v_mfma_f32_16x16x32_bf16 v[60:63], a[12:15], v[68:71], 0
  s_nop 0
  s_nop 0
  s_waitcnt lgkmcnt(4)
  v_mfma_f32_16x16x32_bf16 v[32:35], a[16:19], v[72:75], v[32:35]
  s_nop 0
  s_nop 0
  v_mfma_f32_16x16x32_bf16 v[36:39], a[16:19], v[76:79], v[36:39]
  buffer_store_dwordx4 v[108:111], v3, s[4:7], s54 offen offset:1024 sc1
  ds_read_b128 v[64:67], v4 offset:8192
  ds_read_b128 v[68:71], v4 offset:10240
  v_mfma_f32_16x16x32_bf16 v[40:43], a[20:23], v[72:75], v[40:43]
  s_nop 0
  s_nop 0
  v_mfma_f32_16x16x32_bf16 v[44:47], a[20:23], v[76:79], v[44:47]
  s_nop 0
  s_nop 0
  v_mfma_f32_16x16x32_bf16 v[48:51], a[24:27], v[72:75], v[48:51]
  v_mfma_f32_16x16x32_bf16 v[52:55], a[24:27], v[76:79], v[52:55]
  v_mfma_f32_16x16x32_bf16 v[56:59], a[28:31], v[72:75], v[56:59]
  v_mfma_f32_16x16x32_bf16 v[60:63], a[28:31], v[76:79], v[60:63]
  s_waitcnt lgkmcnt(4)
  v_mfma_f32_16x16x32_bf16 v[32:35], a[32:35], v[80:83], v[32:35]
  v_mfma_f32_16x16x32_bf16 v[36:39], a[32:35], v[84:87], v[36:39]
  ds_read_b128 v[72:75], v6 offset:8192
  ds_read_b128 v[76:79], v6 offset:10240
  v_mfma_f32_16x16x32_bf16 v[40:43], a[36:39], v[80:83], v[40:43]
  v_mfma_f32_16x16x32_bf16 v[44:47], a[36:39], v[84:87], v[44:47]
  v_mfma_f32_16x16x32_bf16 v[48:51], a[40:43], v[80:83], v[48:51]
  v_mfma_f32_16x16x32_bf16 v[52:55], a[40:43], v[84:87], v[52:55]
  v_mfma_f32_16x16x32_bf16 v[56:59], a[44:47], v[80:83], v[56:59]
  v_mfma_f32_16x16x32_bf16 v[60:63], a[44:47], v[84:87], v[60:63]
  s_waitcnt lgkmcnt(4)
  v_mfma_f32_16x16x32_bf16 v[32:35], a[48:51], v[88:91], v[32:35]
  v_mfma_f32_16x16x32_bf16 v[36:39], a[48:51], v[92:95], v[36:39]
  ds_read_b128 v[80:83], v4 offset:12288
  ds_read_b128 v[84:87], v4 offset:14336
  v_mfma_f32_16x16x32_bf16 v[40:43], a[52:55], v[88:91], v[40:43]
  v_mfma_f32_16x16x32_bf16 v[44:47], a[52:55], v[92:95], v[44:47]
  v_mfma_f32_16x16x32_bf16 v[48:51], a[56:59], v[88:91], v[48:51]
  v_mfma_f32_16x16x32_bf16 v[52:55], a[56:59], v[92:95], v[52:55]
  v_mfma_f32_16x16x32_bf16 v[56:59], a[60:63], v[88:91], v[56:59]
  v_mfma_f32_16x16x32_bf16 v[60:63], a[60:63], v[92:95], v[60:63]
  s_waitcnt lgkmcnt(4)
  v_mfma_f32_16x16x32_bf16 v[32:35], a[64:67], v[64:67], v[32:35]
  v_mfma_f32_16x16x32_bf16 v[36:39], a[64:67], v[68:71], v[36:39]
  ds_read_b128 v[88:91], v6 offset:12288
  ds_read_b128 v[92:95], v6 offset:14336
  v_mfma_f32_16x16x32_bf16 v[40:43], a[68:71], v[64:67], v[40:43]
  v_mfma_f32_16x16x32_bf16 v[44:47], a[68:71], v[68:71], v[44:47]
  v_mfma_f32_16x16x32_bf16 v[48:51], a[72:75], v[64:67], v[48:51]
  v_mfma_f32_16x16x32_bf16 v[52:55], a[72:75], v[68:71], v[52:55]
  v_mfma_f32_16x16x32_bf16 v[56:59], a[76:79], v[64:67], v[56:59]
  v_mfma_f32_16x16x32_bf16 v[60:63], a[76:79], v[68:71], v[60:63]
  s_waitcnt lgkmcnt(4)
  v_mfma_f32_16x16x32_bf16 v[32:35], a[80:83], v[72:75], v[32:35]
  v_mfma_f32_16x16x32_bf16 v[36:39], a[80:83], v[76:79], v[36:39]
  ds_read_b128 v[64:67], v4 offset:16384
  ds_read_b128 v[68:71], v4 offset:18432
  v_mfma_f32_16x16x32_bf16 v[40:43], a[84:87], v[72:75], v[40:43]
  v_mfma_f32_16x16x32_bf16 v[44:47], a[84:87], v[76:79], v[44:47]
  v_mfma_f32_16x16x32_bf16 v[48:51], a[88:91], v[72:75], v[48:51]
  v_mfma_f32_16x16x32_bf16 v[52:55], a[88:91], v[76:79], v[52:55]
  v_mfma_f32_16x16x32_bf16 v[56:59], a[92:95], v[72:75], v[56:59]
  v_mfma_f32_16x16x32_bf16 v[60:63], a[92:95], v[76:79], v[60:63]
  s_waitcnt lgkmcnt(4)
  v_mfma_f32_16x16x32_bf16 v[32:35], a[96:99], v[80:83], v[32:35]
  v_mfma_f32_16x16x32_bf16 v[36:39], a[96:99], v[84:87], v[36:39]
  ds_read_b128 v[72:75], v6 offset:16384
  ds_read_b128 v[76:79], v6 offset:18432
  v_mfma_f32_16x16x32_bf16 v[40:43], a[100:103], v[80:83], v[40:43]
  v_mfma_f32_16x16x32_bf16 v[44:47], a[100:103], v[84:87], v[44:47]
  v_mfma_f32_16x16x32_bf16 v[48:51], a[104:107], v[80:83], v[48:51]
  v_mfma_f32_16x16x32_bf16 v[52:55], a[104:107], v[84:87], v[52:55]
  v_mfma_f32_16x16x32_bf16 v[56:59], a[108:111], v[80:83], v[56:59]
  v_mfma_f32_16x16x32_bf16 v[60:63], a[108:111], v[84:87], v[60:63]
  s_waitcnt lgkmcnt(4)
  v_mfma_f32_16x16x32_bf16 v[32:35], a[112:115], v[88:91], v[32:35]
  v_mfma_f32_16x16x32_bf16 v[36:39], a[112:115], v[92:95], v[36:39]
  ds_read_b128 v[80:83], v4 offset:20480
  ds_read_b128 v[84:87], v4 offset:22528
  v_mfma_f32_16x16x32_bf16 v[40:43], a[116:119], v[88:91], v[40:43]
  v_mfma_f32_16x16x32_bf16 v[44:47], a[116:119], v[92:95], v[44:47]
  v_mfma_f32_16x16x32_bf16 v[48:51], a[120:123], v[88:91], v[48:51]
  v_mfma_f32_16x16x32_bf16 v[52:55], a[120:123], v[92:95], v[52:55]
  v_mfma_f32_16x16x32_bf16 v[56:59], a[124:127], v[88:91], v[56:59]
  v_mfma_f32_16x16x32_bf16 v[60:63], a[124:127], v[92:95], v[60:63]
  s_waitcnt lgkmcnt(4)
  v_mfma_f32_16x16x32_bf16 v[32:35], a[128:131], v[64:67], v[32:35]
  v_mfma_f32_16x16x32_bf16 v[36:39], a[128:131], v[68:71], v[36:39]
  ds_read_b128 v[88:91], v6 offset:20480
  ds_read_b128 v[92:95], v6 offset:22528
  v_mfma_f32_16x16x32_bf16 v[40:43], a[132:135], v[64:67], v[40:43]
  v_mfma_f32_16x16x32_bf16 v[44:47], a[132:135], v[68:71], v[44:47]
  v_mfma_f32_16x16x32_bf16 v[48:51], a[136:139], v[64:67], v[48:51]
  v_mfma_f32_16x16x32_bf16 v[52:55], a[136:139], v[68:71], v[52:55]
  v_mfma_f32_16x16x32_bf16 v[56:59], a[140:143], v[64:67], v[56:59]
  v_mfma_f32_16x16x32_bf16 v[60:63], a[140:143], v[68:71], v[60:63]
  s_branch L_g1_K1
L_g1_K0:
  s_waitcnt lgkmcnt(4)
  v_mfma_f32_16x16x32_bf16 v[32:35], a[0:3], v[64:67], 0
  v_mfma_f32_16x16x32_bf16 v[36:39], a[0:3], v[68:71], 0
  ds_read_b128 v[88:91], v6 offset:4096
  ds_read_b128 v[92:95], v6 offset:6144
  v_mfma_f32_16x16x32_bf16 v[40:43], a[4:7], v[64:67], 0
  v_mfma_f32_16x16x32_bf16 v[44:47], a[4:7], v[68:71], 0
  v_mfma_f32_16x16x32_bf16 v[48:51], a[8:11], v[64:67], 0
  v_mfma_f32_16x16x32_bf16 v[52:55], a[8:11], v[68:71], 0
  v_mfma_f32_16x16x32_bf16 v[56:59], a[12:15], v[64:67], 0
  v_mfma_f32_16x16x32_bf16 v[60:63], a[12:15], v[68:71], 0
  s_waitcnt lgkmcnt(4)
  v_mfma_f32_16x16x32_bf16 v[32:35], a[16:19], v[72:75], v[32:35]
  v_mfma_f32_16x16x32_bf16 v[36:39], a[16:19], v[76:79], v[36:39]
  ds_read_b128 v[64:67], v4 offset:8192
  ds_read_b128 v[68:71], v4 offset:10240
  v_mfma_f32_16x16x32_bf16 v[40:43], a[20:23], v[72:75], v[40:43]
  v_mfma_f32_16x16x32_bf16 v[44:47], a[20:23], v[76:79], v[44:47]
  v_mfma_f32_16x16x32_bf16 v[48:51], a[24:27], v[72:75], v[48:51]
  v_mfma_f32_16x16x32_bf16 v[52:55], a[24:27], v[76:79], v[52:55]
  v_mfma_f32_16x16x32_bf16 v[56:59], a[28:31], v[72:75], v[56:59]
  v_mfma_f32_16x16x32_bf16 v[60:63], a[28:31], v[76:79], v[60:63]
  s_waitcnt lgkmcnt(4)
  v_mfma_f32_16x16x32_bf16 v[32:35], a[32:35], v[80:83], v[32:35]
  v_mfma_f32_16x16x32_bf16 v[36:39], a[32:35], v[84:87], v[36:39]
  ds_read_b128 v[72:75], v6 offset:8192
  ds_read_b128 v[76:79], v6 offset:10240
  v_mfma_f32_16x16x32_bf16 v[40:43], a[36:39], v[80:83], v[40:43]
  v_mfma_f32_16x16x32_bf16 v[44:47], a[36:39], v[84:87], v[44:47]
  v_mfma_f32_16x16x32_bf16 v[48:51], a[40:43], v[80:83], v[48:51]
  v_mfma_f32_16x16x32_bf16 v[52:55], a[40:43], v[84:87], v[52:55]
  v_mfma_f32_16x16x32_bf16 v[56:59], a[44:47], v[80:83], v[56:59]
  v_mfma_f32_16x16x32_bf16 v[60:63], a[44:47], v[84:87], v[60:63]
  s_waitcnt lgkmcnt(4)
  v_mfma_f32_16x16x32_bf16 v[32:35], a[48:51], v[88:91], v[32:35]
  v_mfma_f32_16x16x32_bf16 v[36:39], a[48:51], v[92:95], v[36:39]
  ds_read_b128 v[80:83], v4 offset:12288
  ds_read_b128 v[84:87], v4 offset:14336
  v_mfma_f32_16x16x32_bf16 v[40:43], a[52:55], v[88:91], v[40:43]
  v_mfma_f32_16x16x32_bf16 v[44:47], a[52:55], v[92:95], v[44:47]
  v_mfma_f32_16x16x32_bf16 v[48:51], a[56:59], v[88:91], v[48:51]
  v_mfma_f32_16x16x32_bf16 v[52:55], a[56:59], v[92:95], v[52:55]
  v_mfma_f32_16x16x32_bf16 v[56:59], a[60:63], v[88:91], v[56:59]
  v_mfma_f32_16x16x32_bf16 v[60:63], a[60:63], v[92:95], v[60:63]
  s_waitcnt lgkmcnt(4)
  v_mfma_f32_16x16x32_bf16 v[32:35], a[64:67], v[64:67], v[32:35]
  v_mfma_f32_16x16x32_bf16 v[36:39], a[64:67], v[68:71], v[36:39]
  ds_read_b128 v[88:91], v6 offset:12288
  ds_read_b128 v[92:95], v6 offset:14336
  v_mfma_f32_16x16x32_bf16 v[40:43], a[68:71], v[64:67], v[40:43]
  v_mfma_f32_16x16x32_bf16 v[44:47], a[68:71], v[68:71], v[44:47]
  v_mfma_f32_16x16x32_bf16 v[48:51], a[72:75], v[64:67], v[48:51]
  v_mfma_f32_16x16x32_bf16 v[52:55], a[72:75], v[68:71], v[52:55]
  v_mfma_f32_16x16x32_bf16 v[56:59], a[76:79], v[64:67], v[56:59]
  v_mfma_f32_16x16x32_bf16 v[60:63], a[76:79], v[68:71], v[60:63]
  s_waitcnt lgkmcnt(4)
  v_mfma_f32_16x16x32_bf16 v[32:35], a[80:83], v[72:75], v[32:35]
  v_mfma_f32_16x16x32_bf16 v[36:39], a[80:83], v[76:79], v[36:39]
  ds_read_b128 v[64:67], v4 offset:16384
  ds_read_b128 v[68:71], v4 offset:18432
  v_mfma_f32_16x16x32_bf16 v[40:43], a[84:87], v[72:75], v[40:43]
  v_mfma_f32_16x16x32_bf16 v[44:47], a[84:87], v[76:79], v[44:47]
  v_mfma_f32_16x16x32_bf16 v[48:51], a[88:91], v[72:75], v[48:51]
  v_mfma_f32_16x16x32_bf16 v[52:55], a[88:91], v[76:79], v[52:55]
  v_mfma_f32_16x16x32_bf16 v[56:59], a[92:95], v[72:75], v[56:59]
  v_mfma_f32_16x16x32_bf16 v[60:63], a[92:95], v[76:79], v[60:63]
  s_waitcnt lgkmcnt(4)
  v_mfma_f32_16x16x32_bf16 v[32:35], a[96:99], v[80:83], v[32:35]
  v_mfma_f32_16x16x32_bf16 v[36:39], a[96:99], v[84:87], v[36:39]
  ds_read_b128 v[72:75], v6 offset:16384
  ds_read_b128 v[76:79], v6 offset:18432
  v_mfma_f32_16x16x32_bf16 v[40:43], a[100:103], v[80:83], v[40:43]
  v_mfma_f32_16x16x32_bf16 v[44:47], a[100:103], v[84:87], v[44:47]
  v_mfma_f32_16x16x32_bf16 v[48:51], a[104:107], v[80:83], v[48:51]
  v_mfma_f32_16x16x32_bf16 v[52:55], a[104:107], v[84:87], v[52:55]
  v_mfma_f32_16x16x32_bf16 v[56:59], a[108:111], v[80:83], v[56:59]
  v_mfma_f32_16x16x32_bf16 v[60:63], a[108:111], v[84:87], v[60:63]
  s_waitcnt lgkmcnt(4)
  v_mfma_f32_16x16x32_bf16 v[32:35], a[112:115], v[88:91], v[32:35]
  v_mfma_f32_16x16x32_bf16 v[36:39], a[112:115], v[92:95], v[36:39]
  ds_read_b128 v[80:83], v4 offset:20480
  ds_read_b128 v[84:87], v4 offset:22528
  v_mfma_f32_16x16x32_bf16 v[40:43], a[116:119], v[88:91], v[40:43]
  v_mfma_f32_16x16x32_bf16 v[44:47], a[116:119], v[92:95], v[44:47]
  v_mfma_f32_16x16x32_bf16 v[48:51], a[120:123], v[88:91], v[48:51]
  v_mfma_f32_16x16x32_bf16 v[52:55], a[120:123], v[92:95], v[52:55]
  v_mfma_f32_16x16x32_bf16 v[56:59], a[124:127], v[88:91], v[56:59]
  v_mfma_f32_16x16x32_bf16 v[60:63], a[124:127], v[92:95], v[60:63]
  s_waitcnt lgkmcnt(4)
  v_mfma_f32_16x16x32_bf16 v[32:35], a[128:131], v[64:67], v[32:35]
  v_mfma_f32_16x16x32_bf16 v[36:39], a[128:131], v[68:71], v[36:39]
  ds_read_b128 v[88:91], v6 offset:20480
  ds_read_b128 v[92:95], v6 offset:22528
  v_mfma_f32_16x16x32_bf16 v[40:43], a[132:135], v[64:67], v[40:43]
  v_mfma_f32_16x16x32_bf16 v[44:47], a[132:135], v[68:71], v[44:47]
  v_mfma_f32_16x16x32_bf16 v[48:51], a[136:139], v[64:67], v[48:51]
  v_mfma_f32_16x16x32_bf16 v[52:55], a[136:139], v[68:71], v[52:55]
  v_mfma_f32_16x16x32_bf16 v[56:59], a[140:143], v[64:67], v[56:59]
  v_mfma_f32_16x16x32_bf16 v[60:63], a[140:143], v[68:71], v[60:63]
L_g1_K1:
  s_waitcnt lgkmcnt(4)
  v_mfma_f32_16x16x32_bf16 v[32:35], a[144:147], v[72:75], v[32:35]
  v_mfma_f32_16x16x32_bf16 v[36:39], a[144:147], v[76:79], v[36:39]
  ds_read_b128 v[64:67], v4 offset:24576
  ds_read_b128 v[68:71], v4 offset:26624
  v_mfma_f32_16x16x32_bf16 v[40:43], a[148:151], v[72:75], v[40:43]
  v_mfma_f32_16x16x32_bf16 v[44:47], a[148:151], v[76:79], v[44:47]
  v_mfma_f32_16x16x32_bf16 v[48:51], a[152:155], v[72:75], v[48:51]
  v_mfma_f32_16x16x32_bf16 v[52:55], a[152:155], v[76:79], v[52:55]
  v_mfma_f32_16x16x32_bf16 v[56:59], a[156:159], v[72:75], v[56:59]
  v_mfma_f32_16x16x32_bf16 v[60:63], a[156:159], v[76:79], v[60:63]
  s_waitcnt vmcnt(0)
  s_barrier
  s_cmp_lg_u32 s29, 0
  s_cbranch_scc1 L_g1f_4
  v_cmp_eq_u32 vcc, 0, v7
  s_cbranch_vccz L_g1f_4p
  buffer_load_dword v7, off, s[20:23], 0 offset:128 sc1
  s_branch L_g1f_4
L_g1f_4p:
  v_mov_b32 v5, s42
  buffer_store_dword v5, off, s[4:7], s36 sc1
L_g1f_4:
  s_add_u32 s52, s48, s45
  s_min_u32 s44, s43, 2580480
  s_add_u32 s43, s43, 40960
  s_waitcnt lgkmcnt(4)
  v_mfma_f32_16x16x32_bf16 v[32:35], a[160:163], v[80:83], v[32:35]
  v_mfma_f32_16x16x32_bf16 v[36:39], a[160:163], v[84:87], v[36:39]
  ds_read_b128 v[72:75], v6 offset:24576
  ds_read_b128 v[76:79], v6 offset:26624
  v_mfma_f32_16x16x32_bf16 v[40:43], a[164:167], v[80:83], v[40:43]
  v_mfma_f32_16x16x32_bf16 v[44:47], a[164:167], v[84:87], v[44:47]
  s_add_u32 m0, s52, 0
  s_add_u32 s53, s44, 0
  buffer_load_dwordx4 v8, s[16:19], s53 offen lds
  v_mfma_f32_16x16x32_bf16 v[48:51], a[168:171], v[80:83], v[48:51]
  v_mfma_f32_16x16x32_bf16 v[52:55], a[168:171], v[84:87], v[52:55]
  v_mfma_f32_16x16x32_bf16 v[56:59], a[172:175], v[80:83], v[56:59]
  v_mfma_f32_16x16x32_bf16 v[60:63], a[172:175], v[84:87], v[60:63]
  s_add_u32 m0, s52, 4096
  s_add_u32 s53, s44, 128
  buffer_load_dwordx4 v8, s[16:19], s53 offen lds
  s_waitcnt lgkmcnt(4)
  v_mfma_f32_16x16x32_bf16 v[32:35], a[176:179], v[88:91], v[32:35]
  v_mfma_f32_16x16x32_bf16 v[36:39], a[176:179], v[92:95], v[36:39]
  ds_read_b128 v[80:83], v4 offset:28672
  ds_read_b128 v[84:87], v4 offset:30720
  v_mfma_f32_16x16x32_bf16 v[40:43], a[180:183], v[88:91], v[40:43]
  v_mfma_f32_16x16x32_bf16 v[44:47], a[180:183], v[92:95], v[44:47]
  s_add_u32 m0, s52, 8192
  s_add_u32 s53, s44, 256
  buffer_load_dwordx4 v8, s[16:19], s53 offen lds
  v_mfma_f32_16x16x32_bf16 v[48:51], a[184:187], v[88:91], v[48:51]
  v_mfma_f32_16x16x32_bf16 v[52:55], a[184:187], v[92:95], v[52:55]
  v_mfma_f32_16x16x32_bf16 v[56:59], a[188:191], v[88:91], v[56:59]
  v_mfma_f32_16x16x32_bf16 v[60:63], a[188:191], v[92:95], v[60:63]
  s_add_u32 m0, s52, 12288
  s_add_u32 s53, s44, 384
  buffer_load_dwordx4 v8, s[16:19], s53 offen lds
  s_waitcnt lgkmcnt(4)
  v_mfma_f32_16x16x32_bf16 v[32:35], a[192:195], v[64:67], v[32:35]
  v_mfma_f32_16x16x32_bf16 v[36:39], a[192:195], v[68:71], v[36:39]
  ds_read_b128 v[88:91], v6 offset:28672
  ds_read_b128 v[92:95], v6 offset:30720
  v_mfma_f32_16x16x32_bf16 v[40:43], a[196:199], v[64:67], v[40:43]
  v_mfma_f32_16x16x32_bf16 v[44:47], a[196:199], v[68:71], v[44:47]
  s_add_u32 m0, s52, 16384
  s_add_u32 s53, s44, 512
  buffer_load_dwordx4 v8, s[16:19], s53 offen lds
  v_mfma_f32_16x16x32_bf16 v[48:51], a[200:203], v[64:67], v[48:51]
  v_mfma_f32_16x16x32_bf16 v[52:55], a[200:203], v[68:71], v[52:55]
  v_mfma_f32_16x16x32_bf16 v[56:59], a[204:207], v[64:67], v[56:59]
  v_mfma_f32_16x16x32_bf16 v[60:63], a[204:207], v[68:71], v[60:63]
  s_add_u32 m0, s52, 20480
  s_add_u32 s53, s44, 640
  buffer_load_dwordx4 v8, s[16:19], s53 offen lds
  s_waitcnt lgkmcnt(4)
  v_mfma_f32_16x16x32_bf16 v[32:35], a[208:211], v[72:75], v[32:35]
  v_mfma_f32_16x16x32_bf16 v[36:39], a[208:211], v[76:79], v[36:39]
  ds_read_b128 v[64:67], v4 offset:32768
  ds_read_b128 v[68:71], v4 offset:34816
  v_mfma_f32_16x16x32_bf16 v[40:43], a[212:215], v[72:75], v[40:43]
  v_mfma_f32_16x16x32_bf16 v[44:47], a[212:215], v[76:79], v[44:47]
  s_add_u32 m0, s52, 24576
  s_add_u32 s53, s44, 768
  buffer_load_dwordx4 v8, s[16:19], s53 offen lds
  v_mfma_f32_16x16x32_bf16 v[48:51], a[216:219], v[72:75], v[48:51]
  v_mfma_f32_16x16x32_bf16 v[52:55], a[216:219], v[76:79], v[52:55]
  v_mfma_f32_16x16x32_bf16 v[56:59], a[220:223], v[72:75], v[56:59]
  v_mfma_f32_16x16x32_bf16 v[60:63], a[220:223], v[76:79], v[60:63]
  s_add_u32 m0, s52, 28672
  s_add_u32 s53, s44, 896
  buffer_load_dwordx4 v8, s[16:19], s53 offen lds
  s_waitcnt lgkmcnt(4)
  v_mfma_f32_16x16x32_bf16 v[32:35], a[224:227], v[80:83], v[32:35]
  v_mfma_f32_16x16x32_bf16 v[36:39], a[224:227], v[84:87], v[36:39]
  ds_read_b128 v[72:75], v6 offset:32768
  ds_read_b128 v[76:79], v6 offset:34816
  v_mfma_f32_16x16x32_bf16 v[40:43], a[228:231], v[80:83], v[40:43]
  v_mfma_f32_16x16x32_bf16 v[44:47], a[228:231], v[84:87], v[44:47]
  s_add_u32 m0, s52, 32768
  s_add_u32 s53, s44, 1024
  buffer_load_dwordx4 v8, s[16:19], s53 offen lds
  v_mfma_f32_16x16x32_bf16 v[48:51], a[232:235], v[80:83], v[48:51]
  v_mfma_f32_16x16x32_bf16 v[52:55], a[232:235], v[84:87], v[52:55]
  v_mfma_f32_16x16x32_bf16 v[56:59], a[236:239], v[80:83], v[56:59]
  v_mfma_f32_16x16x32_bf16 v[60:63], a[236:239], v[84:87], v[60:63]
  s_add_u32 m0, s52, 36864
  s_add_u32 s53, s44, 1152
  buffer_load_dwordx4 v8, s[16:19], s53 offen lds
  s_waitcnt lgkmcnt(4)
  v_mfma_f32_16x16x32_bf16 v[32:35], a[240:243], v[88:91], v[32:35]
  v_mfma_f32_16x16x32_bf16 v[36:39], a[240:243], v[92:95], v[36:39]
  ds_read_b128 v[80:83], v4 offset:36864
  ds_read_b128 v[84:87], v4 offset:38912
  v_mfma_f32_16x16x32_bf16 v[40:43], a[244:247], v[88:91], v[40:43]
  v_mfma_f32_16x16x32_bf16 v[44:47], a[244:247], v[92:95], v[44:47]
  v_mfma_f32_16x16x32_bf16 v[48:51], a[248:251], v[88:91], v[48:51]
  v_mfma_f32_16x16x32_bf16 v[52:55], a[248:251], v[92:95], v[52:55]
  v_mfma_f32_16x16x32_bf16 v[56:59], a[252:255], v[88:91], v[56:59]
  v_mfma_f32_16x16x32_bf16 v[60:63], a[252:255], v[92:95], v[60:63]
  s_waitcnt lgkmcnt(4)
  v_mfma_f32_16x16x32_bf16 v[32:35], v[192:195], v[64:67], v[32:35]
  v_mfma_f32_16x16x32_bf16 v[36:39], v[192:195], v[68:71], v[36:39]
  ds_read_b128 v[88:91], v6 offset:36864
  ds_read_b128 v[92:95], v6 offset:38912
  v_mfma_f32_16x16x32_bf16 v[40:43], v[196:199], v[64:67], v[40:43]
  v_mfma_f32_16x16x32_bf16 v[44:47], v[196:199], v[68:71], v[44:47]
  v_mfma_f32_16x16x32_bf16 v[48:51], v[200:203], v[64:67], v[48:51]
  v_mfma_f32_16x16x32_bf16 v[52:55], v[200:203], v[68:71], v[52:55]
  v_mfma_f32_16x16x32_bf16 v[56:59], v[204:207], v[64:67], v[56:59]
  v_mfma_f32_16x16x32_bf16 v[60:63], v[204:207], v[68:71], v[60:63]
  s_waitcnt lgkmcnt(4)
  v_mfma_f32_16x16x32_bf16 v[32:35], v[208:211], v[72:75], v[32:35]
  v_mfma_f32_16x16x32_bf16 v[36:39], v[208:211], v[76:79], v[36:39]
  ds_read_b128 v[64:67], v10 offset:0
  ds_read_b128 v[68:71], v10 offset:2048
  v_mfma_f32_16x16x32_bf16 v[40:43], v[212:215], v[72:75], v[40:43]
  v_mfma_f32_16x16x32_bf16 v[44:47], v[212:215], v[76:79], v[44:47]
  v_mfma_f32_16x16x32_bf16 v[48:51], v[216:219], v[72:75], v[48:51]
  v_mfma_f32_16x16x32_bf16 v[52:55], v[216:219], v[76:79], v[52:55]
  v_mfma_f32_16x16x32_bf16 v[56:59], v[220:223], v[72:75], v[56:59]
  v_mfma_f32_16x16x32_bf16 v[60:63], v[220:223], v[76:79], v[60:63]
  s_waitcnt lgkmcnt(4)
  v_mfma_f32_16x16x32_bf16 v[32:35], v[224:227], v[80:83], v[32:35]
  v_mfma_f32_16x16x32_bf16 v[36:39], v[224:227], v[84:87], v[36:39]
  ds_read_b128 v[72:75], v11 offset:0
  ds_read_b128 v[76:79], v11 offset:2048
  v_mfma_f32_16x16x32_bf16 v[40:43], v[228:231], v[80:83], v[40:43]
  v_mfma_f32_16x16x32_bf16 v[44:47], v[228:231], v[84:87], v[44:47]
  v_mfma_f32_16x16x32_bf16 v[48:51], v[232:235], v[80:83], v[48:51]
  v_mfma_f32_16x16x32_bf16 v[52:55], v[232:235], v[84:87], v[52:55]
  v_mfma_f32_16x16x32_bf16 v[56:59], v[236:239], v[80:83], v[56:59]
  v_mfma_f32_16x16x32_bf16 v[60:63], v[236:239], v[84:87], v[60:63]
  s_waitcnt lgkmcnt(4)
  v_mfma_f32_16x16x32_bf16 v[32:35], v[240:243], v[88:91], v[32:35]
  v_mfma_f32_16x16x32_bf16 v[36:39], v[240:243], v[92:95], v[36:39]
  ds_read_b128 v[80:83], v10 offset:4096
  ds_read_b128 v[84:87], v10 offset:6144
  v_mfma_f32_16x16x32_bf16 v[40:43], v[244:247], v[88:91], v[40:43]
  v_mfma_f32_16x16x32_bf16 v[44:47], v[244:247], v[92:95], v[44:47]
  v_mfma_f32_16x16x32_bf16 v[48:51], v[248:251], v[88:91], v[48:51]
  v_mfma_f32_16x16x32_bf16 v[52:55], v[248:251], v[92:95], v[52:55]
  v_mfma_f32_16x16x32_bf16 v[56:59], v[252:255], v[88:91], v[56:59]
  v_mfma_f32_16x16x32_bf16 v[60:63], v[252:255], v[92:95], v[60:63]
  s_add_u32 s34, s34, s35
  s_add_u32 s54, s34, 4096
  s_mov_b32 s40, s46
  s_mov_b32 s46, s47
  s_mov_b32 s47, s48
  s_mov_b32 s48, s40
  v_mov_b32 v4, v10
  v_mov_b32 v6, v11
  v_add_u32 v10, s47, v9
  v_xor_b32 v11, 64, v10
  s_add_u32 s42, s42, 1
  s_cmp_lt_u32 s42, 64
  v_cvt_pk_bf16_f32 v96, v32, v33
  v_cvt_pk_bf16_f32 v97, v34, v35
  v_cvt_pk_bf16_f32 v104, v36, v37
  v_cvt_pk_bf16_f32 v105, v38, v39
  v_cvt_pk_bf16_f32 v98, v40, v41
  v_cvt_pk_bf16_f32 v99, v42, v43
  v_cvt_pk_bf16_f32 v106, v44, v45
  v_cvt_pk_bf16_f32 v107, v46, v47
  v_cvt_pk_bf16_f32 v100, v48, v49
  v_cvt_pk_bf16_f32 v101, v50, v51
  v_cvt_pk_bf16_f32 v108, v52, v53
  v_cvt_pk_bf16_f32 v109, v54, v55
  v_cvt_pk_bf16_f32 v102, v56, v57
  v_cvt_pk_bf16_f32 v103, v58, v59
  v_cvt_pk_bf16_f32 v110, v60, v61
  v_cvt_pk_bf16_f32 v111, v62, v63
  s_cbranch_scc1 L_g1_Kloop
  buffer_store_dwordx4 v[96:99], v3, s[4:7], s34 offen offset:0 sc1
  s_nop 0
  s_nop 0
  s_nop 0
  s_nop 0
  buffer_store_dwordx4 v[100:103], v3, s[4:7], s34 offen offset:1024 sc1
  s_nop 0
  s_nop 0
  s_nop 0
  s_nop 0
  buffer_store_dwordx4 v[104:107], v3, s[4:7], s54 offen offset:0 sc1
  s_nop 0
  s_nop 0
  s_nop 0
  s_nop 0
  buffer_store_dwordx4 v[108:111], v3, s[4:7], s54 offen offset:1024 sc1
  s_nop 0
  s_nop 0
  s_nop 0
  s_nop 0
  s_branch L_g1_fin
L_g1_V:
  s_sub_u32 s34, s34, s35
  s_branch L_g1_V0
L_g1_Vloop:
  s_waitcnt lgkmcnt(4)
  v_mfma_f32_16x16x32_bf16 v[32:35], v[64:67], a[0:3], 0
  buffer_store_dwordx4 v[96:99], v3, s[4:7], s34 offen offset:0 sc1
  v_mfma_f32_16x16x32_bf16 v[36:39], v[68:71], a[0:3], 0
  s_nop 0
  s_nop 0
  ds_read_b128 v[88:91], v6 offset:4096
  ds_read_b128 v[92:95], v6 offset:6144
  v_mfma_f32_16x16x32_bf16 v[40:43], v[64:67], a[4:7], 0
  s_nop 0
  s_nop 0
  v_mfma_f32_16x16x32_bf16 v[44:47], v[68:71], a[4:7], 0
  buffer_store_dwordx4 v[100:103], v3, s[4:7], s34 offen offset:1024 sc1
  v_mfma_f32_16x16x32_bf16 v[48:51], v[64:67], a[8:11], 0
  s_nop 0
  s_nop 0
  v_mfma_f32_16x16x32_bf16 v[52:55], v[68:71], a[8:11], 0
  s_nop 0
  s_nop 0
  v_mfma_f32_16x16x32_bf16 v[56:59], v[64:67], a[12:15], 0
  buffer_store_dwordx4 v[104:107], v3, s[4:7], s34 offen offset:2048 sc1
  v_mfma_f32_16x16x32_bf16 v[60:63], v[68:71], a[12:15], 0
  s_nop 0
  s_nop 0
  s_waitcnt lgkmcnt(4)
  v_mfma_f32_16x16x32_bf16 v[32:35], v[72:75], a[16:19], v[32:35]
  s_nop 0
  s_nop 0
  v_mfma_f32_16x16x32_bf16 v[36:39], v[76:79], a[16:19], v[36:39]
  buffer_store_dwordx4 v[108:111], v3, s[4:7], s34 offen offset:3072 sc1
  ds_read_b128 v[64:67], v4 offset:8192
  ds_read_b128 v[68:71], v4 offset:10240
  v_mfma_f32_16x16x32_bf16 v[40:43], v[72:75], a[20:23], v[40:43]
  s_nop 0
  s_nop 0
  v_mfma_f32_16x16x32_bf16 v[44:47], v[76:79], a[20:23], v[44:47]
  s_nop 0
  s_nop 0
  v_mfma_f32_16x16x32_bf16 v[48:51], v[72:75], a[24:27], v[48:51]
  v_mfma_f32_16x16x32_bf16 v[52:55], v[76:79], a[24:27], v[52:55]
  v_mfma_f32_16x16x32_bf16 v[56:59], v[72:75], a[28:31], v[56:59]
  v_mfma_f32_16x16x32_bf16 v[60:63], v[76:79], a[28:31], v[60:63]
  s_waitcnt lgkmcnt(4)
  v_mfma_f32_16x16x32_bf16 v[32:35], v[80:83], a[32:35], v[32:35]
  v_mfma_f32_16x16x32_bf16 v[36:39], v[84:87], a[32:35], v[36:39]
  ds_read_b128 v[72:75], v6 offset:8192
  ds_read_b128 v[76:79], v6 offset:10240
  v_mfma_f32_16x16x32_bf16 v[40:43], v[80:83], a[36:39], v[40:43]
  v_mfma_f32_16x16x32_bf16 v[44:47], v[84:87], a[36:39], v[44:47]
  v_mfma_f32_16x16x32_bf16 v[48:51], v[80:83], a[40:43], v[48:51]
  v_mfma_f32_16x16x32_bf16 v[52:55], v[84:87], a[40:43], v[52:55]
  v_mfma_f32_16x16x32_bf16 v[56:59], v[80:83], a[44:47], v[56:59]
  v_mfma_f32_16x16x32_bf16 v[60:63], v[84:87], a[44:47], v[60:63]
  s_waitcnt lgkmcnt(4)
  v_mfma_f32_16x16x32_bf16 v[32:35], v[88:91], a[48:51], v[32:35]
  v_mfma_f32_16x16x32_bf16 v[36:39], v[92:95], a[48:51], v[36:39]
  ds_read_b128 v[80:83], v4 offset:12288
  ds_read_b128 v[84:87], v4 offset:14336
  v_mfma_f32_16x16x32_bf16 v[40:43], v[88:91], a[52:55], v[40:43]
  v_mfma_f32_16x16x32_bf16 v[44:47], v[92:95], a[52:55], v[44:47]
  v_mfma_f32_16x16x32_bf16 v[48:51], v[88:91], a[56:59], v[48:51]
  v_mfma_f32_16x16x32_bf16 v[52:55], v[92:95], a[56:59], v[52:55]
  v_mfma_f32_16x16x32_bf16 v[56:59], v[88:91], a[60:63], v[56:59]
  v_mfma_f32_16x16x32_bf16 v[60:63], v[92:95], a[60:63], v[60:63]
  s_waitcnt lgkmcnt(4)
  v_mfma_f32_16x16x32_bf16 v[32:35], v[64:67], a[64:67], v[32:35]
  v_mfma_f32_16x16x32_bf16 v[36:39], v[68:71], a[64:67], v[36:39]
  ds_read_b128 v[88:91], v6 offset:12288
  ds_read_b128 v[92:95], v6 offset:14336
  v_mfma_f32_16x16x32_bf16 v[40:43], v[64:67], a[68:71], v[40:43]
  v_mfma_f32_16x16x32_bf16 v[44:47], v[68:71], a[68:71], v[44:47]
  v_mfma_f32_16x16x32_bf16 v[48:51], v[64:67], a[72:75], v[48:51]
  v_mfma_f32_16x16x32_bf16 v[52:55], v[68:71], a[72:75], v[52:55]
  v_mfma_f32_16x16x32_bf16 v[56:59], v[64:67], a[76:79], v[56:59]
  v_mfma_f32_16x16x32_bf16 v[60:63], v[68:71], a[76:79], v[60:63]
  s_waitcnt lgkmcnt(4)
  v_mfma_f32_16x16x32_bf16 v[32:35], v[72:75], a[80:83], v[32:35]
  v_mfma_f32_16x16x32_bf16 v[36:39], v[76:79], a[80:83], v[36:39]
  ds_read_b128 v[64:67], v4 offset:16384
  ds_read_b128 v[68:71], v4 offset:18432
  v_mfma_f32_16x16x32_bf16 v[40:43], v[72:75], a[84:87], v[40:43]
  v_mfma_f32_16x16x32_bf16 v[44:47], v[76:79], a[84:87], v[44:47]
  v_mfma_f32_16x16x32_bf16 v[48:51], v[72:75], a[88:91], v[48:51]
  v_mfma_f32_16x16x32_bf16 v[52:55], v[76:79], a[88:91], v[52:55]
  v_mfma_f32_16x16x32_bf16 v[56:59], v[72:75], a[92:95], v[56:59]
  v_mfma_f32_16x16x32_bf16 v[60:63], v[76:79], a[92:95], v[60:63]
  s_waitcnt lgkmcnt(4)
  v_mfma_f32_16x16x32_bf16 v[32:35], v[80:83], a[96:99], v[32:35]
  v_mfma_f32_16x16x32_bf16 v[36:39], v[84:87], a[96:99], v[36:39]
  ds_read_b128 v[72:75], v6 offset:16384
  ds_read_b128 v[76:79], v6 offset:18432
  v_mfma_f32_16x16x32_bf16 v[40:43], v[80:83], a[100:103], v[40:43]
  v_mfma_f32_16x16x32_bf16 v[44:47], v[84:87], a[100:103], v[44:47]
  v_mfma_f32_16x16x32_bf16 v[48:51], v[80:83], a[104:107], v[48:51]
  v_mfma_f32_16x16x32_bf16 v[52:55], v[84:87], a[104:107], v[52:55]
  v_mfma_f32_16x16x32_bf16 v[56:59], v[80:83], a[108:111], v[56:59]
  v_mfma_f32_16x16x32_bf16 v[60:63], v[84:87], a[108:111], v[60:63]
  s_waitcnt lgkmcnt(4)
  v_mfma_f32_16x16x32_bf16 v[32:35], v[88:91], a[112:115], v[32:35]
  v_mfma_f32_16x16x32_bf16 v[36:39], v[92:95], a[112:115], v[36:39]
  ds_read_b128 v[80:83], v4 offset:20480
  ds_read_b128 v[84:87], v4 offset:22528
  v_mfma_f32_16x16x32_bf16 v[40:43], v[88:91], a[116:119], v[40:43]
  v_mfma_f32_16x16x32_bf16 v[44:47], v[92:95], a[116:119], v[44:47]
  v_mfma_f32_16x16x32_bf16 v[48:51], v[88:91], a[120:123], v[48:51]
  v_mfma_f32_16x16x32_bf16 v[52:55], v[92:95], a[120:123], v[52:55]
  v_mfma_f32_16x16x32_bf16 v[56:59], v[88:91], a[124:127], v[56:59]
  v_mfma_f32_16x16x32_bf16 v[60:63], v[92:95], a[124:127], v[60:63]
  s_waitcnt lgkmcnt(4)
  v_mfma_f32_16x16x32_bf16 v[32:35], v[64:67], a[128:131], v[32:35]
  v_mfma_f32_16x16x32_bf16 v[36:39], v[68:71], a[128:131], v[36:39]
  ds_read_b128 v[88:91], v6 offset:20480
  ds_read_b128 v[92:95], v6 offset:22528
  v_mfma_f32_16x16x32_bf16 v[40:43], v[64:67], a[132:135], v[40:43]
  v_mfma_f32_16x16x32_bf16 v[44:47], v[68:71], a[132:135], v[44:47]
  v_mfma_f32_16x16x32_bf16 v[48:51], v[64:67], a[136:139], v[48:51]
  v_mfma_f32_16x16x32_bf16 v[52:55], v[68:71], a[136:139], v[52:55]
  v_mfma_f32_16x16x32_bf16 v[56:59], v[64:67], a[140:143], v[56:59]
  v_mfma_f32_16x16x32_bf16 v[60:63], v[68:71], a[140:143], v[60:63]
  s_branch L_g1_V1
L_g1_V0:
  s_waitcnt lgkmcnt(4)
  v_mfma_f32_16x16x32_bf16 v[32:35], v[64:67], a[0:3], 0
  v_mfma_f32_16x16x32_bf16 v[36:39], v[68:71], a[0:3], 0
  ds_read_b128 v[88:91], v6 offset:4096
  ds_read_b128 v[92:95], v6 offset:6144
  v_mfma_f32_16x16x32_bf16 v[40:43], v[64:67], a[4:7], 0
  v_mfma_f32_16x16x32_bf16 v[44:47], v[68:71], a[4:7], 0
  v_mfma_f32_16x16x32_bf16 v[48:51], v[64:67], a[8:11], 0
  v_mfma_f32_16x16x32_bf16 v[52:55], v[68:71], a[8:11], 0
  v_mfma_f32_16x16x32_bf16 v[56:59], v[64:67], a[12:15], 0
  v_mfma_f32_16x16x32_bf16 v[60:63], v[68:71], a[12:15], 0
  s_waitcnt lgkmcnt(4)
  v_mfma_f32_16x16x32_bf16 v[32:35], v[72:75], a[16:19], v[32:35]
  v_mfma_f32_16x16x32_bf16 v[36:39], v[76:79], a[16:19], v[36:39]
  ds_read_b128 v[64:67], v4 offset:8192
  ds_read_b128 v[68:71], v4 offset:10240
  v_mfma_f32_16x16x32_bf16 v[40:43], v[72:75], a[20:23], v[40:43]
  v_mfma_f32_16x16x32_bf16 v[44:47], v[76:79], a[20:23], v[44:47]
  v_mfma_f32_16x16x32_bf16 v[48:51], v[72:75], a[24:27], v[48:51]
  v_mfma_f32_16x16x32_bf16 v[52:55], v[76:79], a[24:27], v[52:55]
  v_mfma_f32_16x16x32_bf16 v[56:59], v[72:75], a[28:31], v[56:59]
  v_mfma_f32_16x16x32_bf16 v[60:63], v[76:79], a[28:31], v[60:63]
  s_waitcnt lgkmcnt(4)
  v_mfma_f32_16x16x32_bf16 v[32:35], v[80:83], a[32:35], v[32:35]
  v_mfma_f32_16x16x32_bf16 v[36:39], v[84:87], a[32:35], v[36:39]
  ds_read_b128 v[72:75], v6 offset:8192
  ds_read_b128 v[76:79], v6 offset:10240
  v_mfma_f32_16x16x32_bf16 v[40:43], v[80:83], a[36:39], v[40:43]
  v_mfma_f32_16x16x32_bf16 v[44:47], v[84:87], a[36:39], v[44:47]
  v_mfma_f32_16x16x32_bf16 v[48:51], v[80:83], a[40:43], v[48:51]
  v_mfma_f32_16x16x32_bf16 v[52:55], v[84:87], a[40:43], v[52:55]
  v_mfma_f32_16x16x32_bf16 v[56:59], v[80:83], a[44:47], v[56:59]
  v_mfma_f32_16x16x32_bf16 v[60:63], v[84:87], a[44:47], v[60:63]
  s_waitcnt lgkmcnt(4)
  v_mfma_f32_16x16x32_bf16 v[32:35], v[88:91], a[48:51], v[32:35]
  v_mfma_f32_16x16x32_bf16 v[36:39], v[92:95], a[48:51], v[36:39]
  ds_read_b128 v[80:83], v4 offset:12288
  ds_read_b128 v[84:87], v4 offset:14336
  v_mfma_f32_16x16x32_bf16 v[40:43], v[88:91], a[52:55], v[40:43]
  v_mfma_f32_16x16x32_bf16 v[44:47], v[92:95], a[52:55], v[44:47]
  v_mfma_f32_16x16x32_bf16 v[48:51], v[88:91], a[56:59], v[48:51]
  v_mfma_f32_16x16x32_bf16 v[52:55], v[92:95], a[56:59], v[52:55]
  v_mfma_f32_16x16x32_bf16 v[56:59], v[88:91], a[60:63], v[56:59]
  v_mfma_f32_16x16x32_bf16 v[60:63], v[92:95], a[60:63], v[60:63]
  s_waitcnt lgkmcnt(4)
  v_mfma_f32_16x16x32_bf16 v[32:35], v[64:67], a[64:67], v[32:35]
  v_mfma_f32_16x16x32_bf16 v[36:39], v[68:71], a[64:67], v[36:39]
  ds_read_b128 v[88:91], v6 offset:12288
  ds_read_b128 v[92:95], v6 offset:14336
  v_mfma_f32_16x16x32_bf16 v[40:43], v[64:67], a[68:71], v[40:43]
  v_mfma_f32_16x16x32_bf16 v[44:47], v[68:71], a[68:71], v[44:47]
  v_mfma_f32_16x16x32_bf16 v[48:51], v[64:67], a[72:75], v[48:51]
  v_mfma_f32_16x16x32_bf16 v[52:55], v[68:71], a[72:75], v[52:55]
  v_mfma_f32_16x16x32_bf16 v[56:59], v[64:67], a[76:79], v[56:59]
  v_mfma_f32_16x16x32_bf16 v[60:63], v[68:71], a[76:79], v[60:63]
  s_waitcnt lgkmcnt(4)
  v_mfma_f32_16x16x32_bf16 v[32:35], v[72:75], a[80:83], v[32:35]
  v_mfma_f32_16x16x32_bf16 v[36:39], v[76:79], a[80:83], v[36:39]
  ds_read_b128 v[64:67], v4 offset:16384
  ds_read_b128 v[68:71], v4 offset:18432
  v_mfma_f32_16x16x32_bf16 v[40:43], v[72:75], a[84:87], v[40:43]
  v_mfma_f32_16x16x32_bf16 v[44:47], v[76:79], a[84:87], v[44:47]
  v_mfma_f32_16x16x32_bf16 v[48:51], v[72:75], a[88:91], v[48:51]
  v_mfma_f32_16x16x32_bf16 v[52:55], v[76:79], a[88:91], v[52:55]
  v_mfma_f32_16x16x32_bf16 v[56:59], v[72:75], a[92:95], v[56:59]
  v_mfma_f32_16x16x32_bf16 v[60:63], v[76:79], a[92:95], v[60:63]
  s_waitcnt lgkmcnt(4)
  v_mfma_f32_16x16x32_bf16 v[32:35], v[80:83], a[96:99], v[32:35]
  v_mfma_f32_16x16x32_bf16 v[36:39], v[84:87], a[96:99], v[36:39]
  ds_read_b128 v[72:75], v6 offset:16384
  ds_read_b128 v[76:79], v6 offset:18432
  v_mfma_f32_16x16x32_bf16 v[40:43], v[80:83], a[100:103], v[40:43]
  v_mfma_f32_16x16x32_bf16 v[44:47], v[84:87], a[100:103], v[44:47]
  v_mfma_f32_16x16x32_bf16 v[48:51], v[80:83], a[104:107], v[48:51]
  v_mfma_f32_16x16x32_bf16 v[52:55], v[84:87], a[104:107], v[52:55]
  v_mfma_f32_16x16x32_bf16 v[56:59], v[80:83], a[108:111], v[56:59]
  v_mfma_f32_16x16x32_bf16 v[60:63], v[84:87], a[108:111], v[60:63]
  s_waitcnt lgkmcnt(4)
  v_mfma_f32_16x16x32_bf16 v[32:35], v[88:91], a[112:115], v[32:35]
  v_mfma_f32_16x16x32_bf16 v[36:39], v[92:95], a[112:115], v[36:39]
  ds_read_b128 v[80:83], v4 offset:20480
  ds_read_b128 v[84:87], v4 offset:22528
  v_mfma_f32_16x16x32_bf16 v[40:43], v[88:91], a[116:119], v[40:43]
  v_mfma_f32_16x16x32_bf16 v[44:47], v[92:95], a[116:119], v[44:47]
  v_mfma_f32_16x16x32_bf16 v[48:51], v[88:91], a[120:123], v[48:51]
  v_mfma_f32_16x16x32_bf16 v[52:55], v[92:95], a[120:123], v[52:55]
  v_mfma_f32_16x16x32_bf16 v[56:59], v[88:91], a[124:127], v[56:59]
  v_mfma_f32_16x16x32_bf16 v[60:63], v[92:95], a[124:127], v[60:63]
  s_waitcnt lgkmcnt(4)
  v_mfma_f32_16x16x32_bf16 v[32:35], v[64:67], a[128:131], v[32:35]
  v_mfma_f32_16x16x32_bf16 v[36:39], v[68:71], a[128:131], v[36:39]
  ds_read_b128 v[88:91], v6 offset:20480
  ds_read_b128 v[92:95], v6 offset:22528
  v_mfma_f32_16x16x32_bf16 v[40:43], v[64:67], a[132:135], v[40:43]
  v_mfma_f32_16x16x32_bf16 v[44:47], v[68:71], a[132:135], v[44:47]
  v_mfma_f32_16x16x32_bf16 v[48:51], v[64:67], a[136:139], v[48:51]
  v_mfma_f32_16x16x32_bf16 v[52:55], v[68:71], a[136:139], v[52:55]
  v_mfma_f32_16x16x32_bf16 v[56:59], v[64:67], a[140:143], v[56:59]
  v_mfma_f32_16x16x32_bf16 v[60:63], v[68:71], a[140:143], v[60:63]
L_g1_V1:
  s_waitcnt lgkmcnt(4)
  v_mfma_f32_16x16x32_bf16 v[32:35], v[72:75], a[144:147], v[32:35]
  v_mfma_f32_16x16x32_bf16 v[36:39], v[76:79], a[144:147], v[36:39]
  ds_read_b128 v[64:67], v4 offset:24576
  ds_read_b128 v[68:71], v4 offset:26624
  v_mfma_f32_16x16x32_bf16 v[40:43], v[72:75], a[148:151], v[40:43]
  v_mfma_f32_16x16x32_bf16 v[44:47], v[76:79], a[148:151], v[44:47]
  v_mfma_f32_16x16x32_bf16 v[48:51], v[72:75], a[152:155], v[48:51]
  v_mfma_f32_16x16x32_bf16 v[52:55], v[76:79], a[152:155], v[52:55]
  v_mfma_f32_16x16x32_bf16 v[56:59], v[72:75], a[156:159], v[56:59]
  v_mfma_f32_16x16x32_bf16 v[60:63], v[76:79], a[156:159], v[60:63]
  s_waitcnt vmcnt(0)
  s_barrier
  s_cmp_lg_u32 s29, 0
  s_cbranch_scc1 L_g1f_5
  v_cmp_eq_u32 vcc, 0, v7
  s_cbranch_vccz L_g1f_5p
  buffer_load_dword v7, off, s[20:23], 0 offset:128 sc1
  s_branch L_g1f_5
L_g1f_5p:
  v_mov_b32 v5, s42
  buffer_store_dword v5, off, s[4:7], s36 sc1
L_g1f_5:
  s_add_u32 s52, s48, s45
  s_min_u32 s44, s43, 2580480
  s_add_u32 s43, s43, 40960
  s_waitcnt lgkmcnt(4)
  v_mfma_f32_16x16x32_bf16 v[32:35], v[80:83], a[160:163], v[32:35]
  v_mfma_f32_16x16x32_bf16 v[36:39], v[84:87], a[160:163], v[36:39]
  ds_read_b128 v[72:75], v6 offset:24576
  ds_read_b128 v[76:79], v6 offset:26624
  v_mfma_f32_16x16x32_bf16 v[40:43], v[80:83], a[164:167], v[40:43]
  v_mfma_f32_16x16x32_bf16 v[44:47], v[84:87], a[164:167], v[44:47]
  s_add_u32 m0, s52, 0
  s_add_u32 s53, s44, 0
  buffer_load_dwordx4 v8, s[16:19], s53 offen lds
  v_mfma_f32_16x16x32_bf16 v[48:51], v[80:83], a[168:171], v[48:51]
  v_mfma_f32_16x16x32_bf16 v[52:55], v[84:87], a[168:171], v[52:55]
  v_mfma_f32_16x16x32_bf16 v[56:59], v[80:83], a[172:175], v[56:59]
  v_mfma_f32_16x16x32_bf16 v[60:63], v[84:87], a[172:175], v[60:63]
  s_add_u32 m0, s52, 4096
  s_add_u32 s53, s44, 128
  buffer_load_dwordx4 v8, s[16:19], s53 offen lds
  s_waitcnt lgkmcnt(4)
  v_mfma_f32_16x16x32_bf16 v[32:35], v[88:91], a[176:179], v[32:35]
  v_mfma_f32_16x16x32_bf16 v[36:39], v[92:95], a[176:179], v[36:39]
  ds_read_b128 v[80:83], v4 offset:28672
  ds_read_b128 v[84:87], v4 offset:30720
  v_mfma_f32_16x16x32_bf16 v[40:43], v[88:91], a[180:183], v[40:43]
  v_mfma_f32_16x16x32_bf16 v[44:47], v[92:95], a[180:183], v[44:47]
  s_add_u32 m0, s52, 8192
  s_add_u32 s53, s44, 256
  buffer_load_dwordx4 v8, s[16:19], s53 offen lds
  v_mfma_f32_16x16x32_bf16 v[48:51], v[88:91], a[184:187], v[48:51]
  v_mfma_f32_16x16x32_bf16 v[52:55], v[92:95], a[184:187], v[52:55]
  v_mfma_f32_16x16x32_bf16 v[56:59], v[88:91], a[188:191], v[56:59]
  v_mfma_f32_16x16x32_bf16 v[60:63], v[92:95], a[188:191], v[60:63]
  s_add_u32 m0, s52, 12288
  s_add_u32 s53, s44, 384
  buffer_load_dwordx4 v8, s[16:19], s53 offen lds
  s_waitcnt lgkmcnt(4)
  v_mfma_f32_16x16x32_bf16 v[32:35], v[64:67], a[192:195], v[32:35]
  v_mfma_f32_16x16x32_bf16 v[36:39], v[68:71], a[192:195], v[36:39]
  ds_read_b128 v[88:91], v6 offset:28672
  ds_read_b128 v[92:95], v6 offset:30720
  v_mfma_f32_16x16x32_bf16 v[40:43], v[64:67], a[196:199], v[40:43]
  v_mfma_f32_16x16x32_bf16 v[44:47], v[68:71], a[196:199], v[44:47]
  s_add_u32 m0, s52, 16384
  s_add_u32 s53, s44, 512
  buffer_load_dwordx4 v8, s[16:19], s53 offen lds
  v_mfma_f32_16x16x32_bf16 v[48:51], v[64:67], a[200:203], v[48:51]
  v_mfma_f32_16x16x32_bf16 v[52:55], v[68:71], a[200:203], v[52:55]
  v_mfma_f32_16x16x32_bf16 v[56:59], v[64:67], a[204:207], v[56:59]
  v_mfma_f32_16x16x32_bf16 v[60:63], v[68:71], a[204:207], v[60:63]
  s_add_u32 m0, s52, 20480
  s_add_u32 s53, s44, 640
  buffer_load_dwordx4 v8, s[16:19], s53 offen lds
  s_waitcnt lgkmcnt(4)
  v_mfma_f32_16x16x32_bf16 v[32:35], v[72:75], a[208:211], v[32:35]
  v_mfma_f32_16x16x32_bf16 v[36:39], v[76:79], a[208:211], v[36:39]
  ds_read_b128 v[64:67], v4 offset:32768
  ds_read_b128 v[68:71], v4 offset:34816
  v_mfma_f32_16x16x32_bf16 v[40:43], v[72:75], a[212:215], v[40:43]
  v_mfma_f32_16x16x32_bf16 v[44:47], v[76:79], a[212:215], v[44:47]
  s_add_u32 m0, s52, 24576
  s_add_u32 s53, s44, 768
  buffer_load_dwordx4 v8, s[16:19], s53 offen lds
  v_mfma_f32_16x16x32_bf16 v[48:51], v[72:75], a[216:219], v[48:51]
  v_mfma_f32_16x16x32_bf16 v[52:55], v[76:79], a[216:219], v[52:55]
  v_mfma_f32_16x16x32_bf16 v[56:59], v[72:75], a[220:223], v[56:59]
  v_mfma_f32_16x16x32_bf16 v[60:63], v[76:79], a[220:223], v[60:63]
  s_add_u32 m0, s52, 28672
  s_add_u32 s53, s44, 896
  buffer_load_dwordx4 v8, s[16:19], s53 offen lds
  s_waitcnt lgkmcnt(4)
  v_mfma_f32_16x16x32_bf16 v[32:35], v[80:83], a[224:227], v[32:35]
  v_mfma_f32_16x16x32_bf16 v[36:39], v[84:87], a[224:227], v[36:39]
  ds_read_b128 v[72:75], v6 offset:32768
  ds_read_b128 v[76:79], v6 offset:34816
  v_mfma_f32_16x16x32_bf16 v[40:43], v[80:83], a[228:231], v[40:43]
  v_mfma_f32_16x16x32_bf16 v[44:47], v[84:87], a[228:231], v[44:47]
  s_add_u32 m0, s52, 32768
  s_add_u32 s53, s44, 1024
  buffer_load_dwordx4 v8, s[16:19], s53 offen lds
  v_mfma_f32_16x16x32_bf16 v[48:51], v[80:83], a[232:235], v[48:51]
  v_mfma_f32_16x16x32_bf16 v[52:55], v[84:87], a[232:235], v[52:55]
  v_mfma_f32_16x16x32_bf16 v[56:59], v[80:83], a[236:239], v[56:59]
  v_mfma_f32_16x16x32_bf16 v[60:63], v[84:87], a[236:239], v[60:63]
  s_add_u32 m0, s52, 36864
  s_add_u32 s53, s44, 1152
  buffer_load_dwordx4 v8, s[16:19], s53 offen lds
  s_waitcnt lgkmcnt(4)
  v_mfma_f32_16x16x32_bf16 v[32:35], v[88:91], a[240:243], v[32:35]
  v_mfma_f32_16x16x32_bf16 v[36:39], v[92:95], a[240:243], v[36:39]
  ds_read_b128 v[80:83], v4 offset:36864
  ds_read_b128 v[84:87], v4 offset:38912
  v_mfma_f32_16x16x32_bf16 v[40:43], v[88:91], a[244:247], v[40:43]
  v_mfma_f32_16x16x32_bf16 v[44:47], v[92:95], a[244:247], v[44:47]
  v_mfma_f32_16x16x32_bf16 v[48:51], v[88:91], a[248:251], v[48:51]
  v_mfma_f32_16x16x32_bf16 v[52:55], v[92:95], a[248:251], v[52:55]
  v_mfma_f32_16x16x32_bf16 v[56:59], v[88:91], a[252:255], v[56:59]
  v_mfma_f32_16x16x32_bf16 v[60:63], v[92:95], a[252:255], v[60:63]
  s_waitcnt lgkmcnt(4)
  v_mfma_f32_16x16x32_bf16 v[32:35], v[64:67], v[192:195], v[32:35]
  v_mfma_f32_16x16x32_bf16 v[36:39], v[68:71], v[192:195], v[36:39]
  ds_read_b128 v[88:91], v6 offset:36864
  ds_read_b128 v[92:95], v6 offset:38912
  v_mfma_f32_16x16x32_bf16 v[40:43], v[64:67], v[196:199], v[40:43]
  v_mfma_f32_16x16x32_bf16 v[44:47], v[68:71], v[196:199], v[44:47]
  v_mfma_f32_16x16x32_bf16 v[48:51], v[64:67], v[200:203], v[48:51]
  v_mfma_f32_16x16x32_bf16 v[52:55], v[68:71], v[200:203], v[52:55]
  v_mfma_f32_16x16x32_bf16 v[56:59], v[64:67], v[204:207], v[56:59]
  v_mfma_f32_16x16x32_bf16 v[60:63], v[68:71], v[204:207], v[60:63]
  s_waitcnt lgkmcnt(4)
  v_mfma_f32_16x16x32_bf16 v[32:35], v[72:75], v[208:211], v[32:35]
  v_mfma_f32_16x16x32_bf16 v[36:39], v[76:79], v[208:211], v[36:39]
  ds_read_b128 v[64:67], v10 offset:0
  ds_read_b128 v[68:71], v10 offset:2048
  v_mfma_f32_16x16x32_bf16 v[40:43], v[72:75], v[212:215], v[40:43]
  v_mfma_f32_16x16x32_bf16 v[44:47], v[76:79], v[212:215], v[44:47]
  v_mfma_f32_16x16x32_bf16 v[48:51], v[72:75], v[216:219], v[48:51]
  v_mfma_f32_16x16x32_bf16 v[52:55], v[76:79], v[216:219], v[52:55]
  v_mfma_f32_16x16x32_bf16 v[56:59], v[72:75], v[220:223], v[56:59]
  v_mfma_f32_16x16x32_bf16 v[60:63], v[76:79], v[220:223], v[60:63]
  s_waitcnt lgkmcnt(4)
  v_mfma_f32_16x16x32_bf16 v[32:35], v[80:83], v[224:227], v[32:35]
  v_mfma_f32_16x16x32_bf16 v[36:39], v[84:87], v[224:227], v[36:39]
  ds_read_b128 v[72:75], v11 offset:0
  ds_read_b128 v[76:79], v11 offset:2048
  v_mfma_f32_16x16x32_bf16 v[40:43], v[80:83], v[228:231], v[40:43]
  v_mfma_f32_16x16x32_bf16 v[44:47], v[84:87], v[228:231], v[44:47]
  v_mfma_f32_16x16x32_bf16 v[48:51], v[80:83], v[232:235], v[48:51]
  v_mfma_f32_16x16x32_bf16 v[52:55], v[84:87], v[232:235], v[52:55]
  v_mfma_f32_16x16x32_bf16 v[56:59], v[80:83], v[236:239], v[56:59]
  v_mfma_f32_16x16x32_bf16 v[60:63], v[84:87], v[236:239], v[60:63]
  s_waitcnt lgkmcnt(4)
  v_mfma_f32_16x16x32_bf16 v[32:35], v[88:91], v[240:243], v[32:35]
  v_mfma_f32_16x16x32_bf16 v[36:39], v[92:95], v[240:243], v[36:39]
  ds_read_b128 v[80:83], v10 offset:4096
  ds_read_b128 v[84:87], v10 offset:6144
  v_mfma_f32_16x16x32_bf16 v[40:43], v[88:91], v[244:247], v[40:43]
  v_mfma_f32_16x16x32_bf16 v[44:47], v[92:95], v[244:247], v[44:47]
  v_mfma_f32_16x16x32_bf16 v[48:51], v[88:91], v[248:251], v[48:51]
  v_mfma_f32_16x16x32_bf16 v[52:55], v[92:95], v[248:251], v[52:55]
  v_mfma_f32_16x16x32_bf16 v[56:59], v[88:91], v[252:255], v[56:59]
  v_mfma_f32_16x16x32_bf16 v[60:63], v[92:95], v[252:255], v[60:63]
  s_add_u32 s34, s34, s35
  s_add_u32 s54, s34, 4096
  s_mov_b32 s40, s46
  s_mov_b32 s46, s47
  s_mov_b32 s47, s48
  s_mov_b32 s48, s40
  v_mov_b32 v4, v10
  v_mov_b32 v6, v11
  v_add_u32 v10, s47, v9
  v_xor_b32 v11, 64, v10
  s_add_u32 s42, s42, 1
  s_cmp_lt_u32 s42, 64
  v_cvt_pk_bf16_f32 v96, v32, v33
  v_cvt_pk_bf16_f32 v97, v34, v35
  v_cvt_pk_bf16_f32 v98, v36, v37
  v_cvt_pk_bf16_f32 v99, v38, v39
  v_cvt_pk_bf16_f32 v100, v40, v41
  v_cvt_pk_bf16_f32 v101, v42, v43
  v_cvt_pk_bf16_f32 v102, v44, v45
  v_cvt_pk_bf16_f32 v103, v46, v47
  v_cvt_pk_bf16_f32 v104, v48, v49
  v_cvt_pk_bf16_f32 v105, v50, v51
  v_cvt_pk_bf16_f32 v106, v52, v53
  v_cvt_pk_bf16_f32 v107, v54, v55
  v_cvt_pk_bf16_f32 v108, v56, v57
  v_cvt_pk_bf16_f32 v109, v58, v59
  v_cvt_pk_bf16_f32 v110, v60, v61
  v_cvt_pk_bf16_f32 v111, v62, v63
  s_cbranch_scc1 L_g1_Vloop
  buffer_store_dwordx4 v[96:99], v3, s[4:7], s34 offen offset:0 sc1
  s_nop 0
  s_nop 0
  s_nop 0
  s_nop 0
  buffer_store_dwordx4 v[100:103], v3, s[4:7], s34 offen offset:1024 sc1
  s_nop 0
  s_nop 0
  s_nop 0
  s_nop 0
  buffer_store_dwordx4 v[104:107], v3, s[4:7], s34 offen offset:2048 sc1
  s_nop 0
  s_nop 0
  s_nop 0
  s_nop 0
  buffer_store_dwordx4 v[108:111], v3, s[4:7], s34 offen offset:3072 sc1
  s_nop 0
  s_nop 0
  s_nop 0
  s_nop 0
  s_branch L_g1_fin
L_g1_F:
  s_mov_b32 s50, s49
  s_mov_b32 s51, s49
  s_sub_u32 s34, s34, s35
  s_branch L_g1_F0
L_g1_Floop:
  s_waitcnt lgkmcnt(4)
  v_mfma_f32_16x16x32_bf16 v[32:35], a[0:3], v[64:67], 0
  v_exp_f32 v144, v144
  v_mfma_f32_16x16x32_bf16 v[36:39], a[0:3], v[68:71], 0
  v_exp_f32 v145, v145
  ds_read_b128 v[88:91], v6 offset:4096
  ds_read_b128 v[92:95], v6 offset:6144
  v_mfma_f32_16x16x32_bf16 v[40:43], a[4:7], v[64:67], 0
  v_exp_f32 v146, v146
  v_mfma_f32_16x16x32_bf16 v[44:47], a[4:7], v[68:71], 0
  v_exp_f32 v147, v147
  v_mfma_f32_16x16x32_bf16 v[48:51], a[8:11], v[64:67], 0
  v_exp_f32 v148, v148
  v_mfma_f32_16x16x32_bf16 v[52:55], a[8:11], v[68:71], 0
  v_exp_f32 v149, v149
  v_mfma_f32_16x16x32_bf16 v[56:59], a[12:15], v[64:67], 0
  v_exp_f32 v150, v150
  v_mfma_f32_16x16x32_bf16 v[60:63], a[12:15], v[68:71], 0
  v_exp_f32 v151, v151
  s_waitcnt lgkmcnt(4)
  v_mfma_f32_16x16x32_bf16 v[32:35], a[16:19], v[72:75], v[32:35]
  v_exp_f32 v152, v152
  v_mfma_f32_16x16x32_bf16 v[36:39], a[16:19], v[76:79], v[36:39]
  v_exp_f32 v153, v153
  ds_read_b128 v[64:67], v4 offset:8192
  ds_read_b128 v[68:71], v4 offset:10240
  v_mfma_f32_16x16x32_bf16 v[40:43], a[20:23], v[72:75], v[40:43]
  v_exp_f32 v154, v154
  v_mfma_f32_16x16x32_bf16 v[44:47], a[20:23], v[76:79], v[44:47]
  v_exp_f32 v155, v155
  v_mfma_f32_16x16x32_bf16 v[48:51], a[24:27], v[72:75], v[48:51]
  v_exp_f32 v156, v156
  v_mfma_f32_16x16x32_bf16 v[52:55], a[24:27], v[76:79], v[52:55]
  v_exp_f32 v157, v157
  v_mfma_f32_16x16x32_bf16 v[56:59], a[28:31], v[72:75], v[56:59]
  v_exp_f32 v158, v158
  v_mfma_f32_16x16x32_bf16 v[60:63], a[28:31], v[76:79], v[60:63]
  v_exp_f32 v159, v159
  s_waitcnt lgkmcnt(4)
  v_mfma_f32_16x16x32_bf16 v[32:35], a[32:35], v[80:83], v[32:35]
  v_add_f32 v144, 1.0, v144
  v_add_f32 v145, 1.0, v145
  v_mfma_f32_16x16x32_bf16 v[36:39], a[32:35], v[84:87], v[36:39]
  v_add_f32 v146, 1.0, v146
  v_add_f32 v147, 1.0, v147
  ds_read_b128 v[72:75], v6 offset:8192
  ds_read_b128 v[76:79], v6 offset:10240
  v_mfma_f32_16x16x32_bf16 v[40:43], a[36:39], v[80:83], v[40:43]
  v_add_f32 v148, 1.0, v148
  v_add_f32 v149, 1.0, v149
  v_mfma_f32_16x16x32_bf16 v[44:47], a[36:39], v[84:87], v[44:47]
  v_add_f32 v150, 1.0, v150
  v_add_f32 v151, 1.0, v151
  v_mfma_f32_16x16x32_bf16 v[48:51], a[40:43], v[80:83], v[48:51]
  v_add_f32 v152, 1.0, v152
  v_add_f32 v153, 1.0, v153
  v_mfma_f32_16x16x32_bf16 v[52:55], a[40:43], v[84:87], v[52:55]
  v_add_f32 v154, 1.0, v154
  v_add_f32 v155, 1.0, v155
  v_mfma_f32_16x16x32_bf16 v[56:59], a[44:47], v[80:83], v[56:59]
  v_add_f32 v156, 1.0, v156
  v_add_f32 v157, 1.0, v157
  v_mfma_f32_16x16x32_bf16 v[60:63], a[44:47], v[84:87], v[60:63]
  v_add_f32 v158, 1.0, v158
  v_add_f32 v159, 1.0, v159
  s_waitcnt lgkmcnt(4)
  v_mfma_f32_16x16x32_bf16 v[32:35], a[48:51], v[88:91], v[32:35]
  v_rcp_f32 v144, v144
  v_mfma_f32_16x16x32_bf16 v[36:39], a[48:51], v[92:95], v[36:39]
  v_rcp_f32 v145, v145
  ds_read_b128 v[80:83], v4 offset:12288
  ds_read_b128 v[84:87], v4 offset:14336
  v_mfma_f32_16x16x32_bf16 v[40:43], a[52:55], v[88:91], v[40:43]
  v_rcp_f32 v146, v146
  v_mfma_f32_16x16x32_bf16 v[44:47], a[52:55], v[92:95], v[44:47]
  v_rcp_f32 v147, v147
  v_mfma_f32_16x16x32_bf16 v[48:51], a[56:59], v[88:91], v[48:51]
  v_rcp_f32 v148, v148
  v_mfma_f32_16x16x32_bf16 v[52:55], a[56:59], v[92:95], v[52:55]
  v_rcp_f32 v149, v149
  v_mfma_f32_16x16x32_bf16 v[56:59], a[60:63], v[88:91], v[56:59]
  v_rcp_f32 v150, v150
  v_mfma_f32_16x16x32_bf16 v[60:63], a[60:63], v[92:95], v[60:63]
  v_rcp_f32 v151, v151
  s_waitcnt lgkmcnt(4)
  v_mfma_f32_16x16x32_bf16 v[32:35], a[64:67], v[64:67], v[32:35]
  v_rcp_f32 v152, v152
  v_mfma_f32_16x16x32_bf16 v[36:39], a[64:67], v[68:71], v[36:39]
  v_rcp_f32 v153, v153
  ds_read_b128 v[88:91], v6 offset:12288
  ds_read_b128 v[92:95], v6 offset:14336
  v_mfma_f32_16x16x32_bf16 v[40:43], a[68:71], v[64:67], v[40:43]
  v_rcp_f32 v154, v154
  v_mfma_f32_16x16x32_bf16 v[44:47], a[68:71], v[68:71], v[44:47]
  v_rcp_f32 v155, v155
  v_mfma_f32_16x16x32_bf16 v[48:51], a[72:75], v[64:67], v[48:51]
  v_rcp_f32 v156, v156
  v_mfma_f32_16x16x32_bf16 v[52:55], a[72:75], v[68:71], v[52:55]
  v_rcp_f32 v157, v157
  v_mfma_f32_16x16x32_bf16 v[56:59], a[76:79], v[64:67], v[56:59]
  v_rcp_f32 v158, v158
  v_mfma_f32_16x16x32_bf16 v[60:63], a[76:79], v[68:71], v[60:63]
  v_rcp_f32 v159, v159
  s_waitcnt lgkmcnt(4)
  v_mfma_f32_16x16x32_bf16 v[32:35], a[80:83], v[72:75], v[32:35]
  v_mul_f32 v112, v112, v144
  v_mul_f32 v113, v113, v145
  v_mfma_f32_16x16x32_bf16 v[36:39], a[80:83], v[76:79], v[36:39]
  v_mul_f32 v114, v114, v146
  v_mul_f32 v115, v115, v147
  ds_read_b128 v[64:67], v4 offset:16384
  ds_read_b128 v[68:71], v4 offset:18432
  v_mfma_f32_16x16x32_bf16 v[40:43], a[84:87], v[72:75], v[40:43]
  v_mul_f32 v116, v116, v148
  v_mul_f32 v117, v117, v149
  v_mfma_f32_16x16x32_bf16 v[44:47], a[84:87], v[76:79], v[44:47]
  v_mul_f32 v118, v118, v150
  v_mul_f32 v119, v119, v151
  v_mfma_f32_16x16x32_bf16 v[48:51], a[88:91], v[72:75], v[48:51]
  v_mul_f32 v120, v120, v152
  v_mul_f32 v121, v121, v153
  v_mfma_f32_16x16x32_bf16 v[52:55], a[88:91], v[76:79], v[52:55]
  v_mul_f32 v122, v122, v154
  v_mul_f32 v123, v123, v155
  v_mfma_f32_16x16x32_bf16 v[56:59], a[92:95], v[72:75], v[56:59]
  v_mul_f32 v124, v124, v156
  v_mul_f32 v125, v125, v157
  v_mfma_f32_16x16x32_bf16 v[60:63], a[92:95], v[76:79], v[60:63]
  v_mul_f32 v126, v126, v158
  v_mul_f32 v127, v127, v159
  s_waitcnt lgkmcnt(4)
  v_mfma_f32_16x16x32_bf16 v[32:35], a[96:99], v[80:83], v[32:35]
  v_cvt_pk_bf16_f32 v96, v112, v113
  v_cvt_pk_bf16_f32 v97, v114, v115
  v_mfma_f32_16x16x32_bf16 v[36:39], a[96:99], v[84:87], v[36:39]
  v_cvt_pk_bf16_f32 v98, v120, v121
  v_cvt_pk_bf16_f32 v99, v122, v123
  ds_read_b128 v[72:75], v6 offset:16384
  ds_read_b128 v[76:79], v6 offset:18432
  v_mfma_f32_16x16x32_bf16 v[40:43], a[100:103], v[80:83], v[40:43]
  buffer_store_dwordx4 v[96:99], v3, s[4:7], s34 offen offset:0 sc1
  v_mfma_f32_16x16x32_bf16 v[44:47], a[100:103], v[84:87], v[44:47]
  v_cvt_pk_bf16_f32 v100, v116, v117
  v_cvt_pk_bf16_f32 v101, v118, v119
  v_mfma_f32_16x16x32_bf16 v[48:51], a[104:107], v[80:83], v[48:51]
  v_cvt_pk_bf16_f32 v102, v124, v125
  v_cvt_pk_bf16_f32 v103, v126, v127
  v_mfma_f32_16x16x32_bf16 v[52:55], a[104:107], v[84:87], v[52:55]
  buffer_store_dwordx4 v[100:103], v3, s[4:7], s34 offen offset:1024 sc1
  v_mfma_f32_16x16x32_bf16 v[56:59], a[108:111], v[80:83], v[56:59]
  v_mfma_f32_16x16x32_bf16 v[60:63], a[108:111], v[84:87], v[60:63]
  s_waitcnt lgkmcnt(4)
  v_mfma_f32_16x16x32_bf16 v[32:35], a[112:115], v[88:91], v[32:35]
  v_mfma_f32_16x16x32_bf16 v[36:39], a[112:115], v[92:95], v[36:39]
  ds_read_b128 v[80:83], v4 offset:20480
  ds_read_b128 v[84:87], v4 offset:22528
  v_mfma_f32_16x16x32_bf16 v[40:43], a[116:119], v[88:91], v[40:43]
  v_mfma_f32_16x16x32_bf16 v[44:47], a[116:119], v[92:95], v[44:47]
  v_mfma_f32_16x16x32_bf16 v[48:51], a[120:123], v[88:91], v[48:51]
  v_mfma_f32_16x16x32_bf16 v[52:55], a[120:123], v[92:95], v[52:55]
  v_mfma_f32_16x16x32_bf16 v[56:59], a[124:127], v[88:91], v[56:59]
  v_mfma_f32_16x16x32_bf16 v[60:63], a[124:127], v[92:95], v[60:63]
  s_waitcnt lgkmcnt(4)
  v_mfma_f32_16x16x32_bf16 v[32:35], a[128:131], v[64:67], v[32:35]
  v_mfma_f32_16x16x32_bf16 v[36:39], a[128:131], v[68:71], v[36:39]
  ds_read_b128 v[88:91], v6 offset:20480
  ds_read_b128 v[92:95], v6 offset:22528
  v_mfma_f32_16x16x32_bf16 v[40:43], a[132:135], v[64:67], v[40:43]
  v_mfma_f32_16x16x32_bf16 v[44:47], a[132:135], v[68:71], v[44:47]
  v_mfma_f32_16x16x32_bf16 v[48:51], a[136:139], v[64:67], v[48:51]
  v_mfma_f32_16x16x32_bf16 v[52:55], a[136:139], v[68:71], v[52:55]
  v_mfma_f32_16x16x32_bf16 v[56:59], a[140:143], v[64:67], v[56:59]
  v_mfma_f32_16x16x32_bf16 v[60:63], a[140:143], v[68:71], v[60:63]
  s_branch L_g1_F1
L_g1_F0:
  s_waitcnt lgkmcnt(4)
  v_mfma_f32_16x16x32_bf16 v[32:35], a[0:3], v[64:67], 0
  v_mfma_f32_16x16x32_bf16 v[36:39], a[0:3], v[68:71], 0
  ds_read_b128 v[88:91], v6 offset:4096
  ds_read_b128 v[92:95], v6 offset:6144
  v_mfma_f32_16x16x32_bf16 v[40:43], a[4:7], v[64:67], 0
  v_mfma_f32_16x16x32_bf16 v[44:47], a[4:7], v[68:71], 0
  v_mfma_f32_16x16x32_bf16 v[48:51], a[8:11], v[64:67], 0
  v_mfma_f32_16x16x32_bf16 v[52:55], a[8:11], v[68:71], 0
  v_mfma_f32_16x16x32_bf16 v[56:59], a[12:15], v[64:67], 0
  v_mfma_f32_16x16x32_bf16 v[60:63], a[12:15], v[68:71], 0
  s_waitcnt lgkmcnt(4)
  v_mfma_f32_16x16x32_bf16 v[32:35], a[16:19], v[72:75], v[32:35]
  v_mfma_f32_16x16x32_bf16 v[36:39], a[16:19], v[76:79], v[36:39]
  ds_read_b128 v[64:67], v4 offset:8192
  ds_read_b128 v[68:71], v4 offset:10240
  v_mfma_f32_16x16x32_bf16 v[40:43], a[20:23], v[72:75], v[40:43]
  v_mfma_f32_16x16x32_bf16 v[44:47], a[20:23], v[76:79], v[44:47]
  v_mfma_f32_16x16x32_bf16 v[48:51], a[24:27], v[72:75], v[48:51]
  v_mfma_f32_16x16x32_bf16 v[52:55], a[24:27], v[76:79], v[52:55]
  v_mfma_f32_16x16x32_bf16 v[56:59], a[28:31], v[72:75], v[56:59]
  v_mfma_f32_16x16x32_bf16 v[60:63], a[28:31], v[76:79], v[60:63]
  s_waitcnt lgkmcnt(4)
  v_mfma_f32_16x16x32_bf16 v[32:35], a[32:35], v[80:83], v[32:35]
  v_mfma_f32_16x16x32_bf16 v[36:39], a[32:35], v[84:87], v[36:39]
  ds_read_b128 v[72:75], v6 offset:8192
  ds_read_b128 v[76:79], v6 offset:10240
  v_mfma_f32_16x16x32_bf16 v[40:43], a[36:39], v[80:83], v[40:43]
  v_mfma_f32_16x16x32_bf16 v[44:47], a[36:39], v[84:87], v[44:47]
  v_mfma_f32_16x16x32_bf16 v[48:51], a[40:43], v[80:83], v[48:51]
  v_mfma_f32_16x16x32_bf16 v[52:55], a[40:43], v[84:87], v[52:55]
  v_mfma_f32_16x16x32_bf16 v[56:59], a[44:47], v[80:83], v[56:59]
  v_mfma_f32_16x16x32_bf16 v[60:63], a[44:47], v[84:87], v[60:63]
  s_waitcnt lgkmcnt(4)
  v_mfma_f32_16x16x32_bf16 v[32:35], a[48:51], v[88:91], v[32:35]
  v_mfma_f32_16x16x32_bf16 v[36:39], a[48:51], v[92:95], v[36:39]
  ds_read_b128 v[80:83], v4 offset:12288
  ds_read_b128 v[84:87], v4 offset:14336
  v_mfma_f32_16x16x32_bf16 v[40:43], a[52:55], v[88:91], v[40:43]
  v_mfma_f32_16x16x32_bf16 v[44:47], a[52:55], v[92:95], v[44:47]
  v_mfma_f32_16x16x32_bf16 v[48:51], a[56:59], v[88:91], v[48:51]
  v_mfma_f32_16x16x32_bf16 v[52:55], a[56:59], v[92:95], v[52:55]
  v_mfma_f32_16x16x32_bf16 v[56:59], a[60:63], v[88:91], v[56:59]
  v_mfma_f32_16x16x32_bf16 v[60:63], a[60:63], v[92:95], v[60:63]
  s_waitcnt lgkmcnt(4)
  v_mfma_f32_16x16x32_bf16 v[32:35], a[64:67], v[64:67], v[32:35]
  v_mfma_f32_16x16x32_bf16 v[36:39], a[64:67], v[68:71], v[36:39]
  ds_read_b128 v[88:91], v6 offset:12288
  ds_read_b128 v[92:95], v6 offset:14336
  v_mfma_f32_16x16x32_bf16 v[40:43], a[68:71], v[64:67], v[40:43]
  v_mfma_f32_16x16x32_bf16 v[44:47], a[68:71], v[68:71], v[44:47]
  v_mfma_f32_16x16x32_bf16 v[48:51], a[72:75], v[64:67], v[48:51]
  v_mfma_f32_16x16x32_bf16 v[52:55], a[72:75], v[68:71], v[52:55]
  v_mfma_f32_16x16x32_bf16 v[56:59], a[76:79], v[64:67], v[56:59]
  v_mfma_f32_16x16x32_bf16 v[60:63], a[76:79], v[68:71], v[60:63]
  s_waitcnt lgkmcnt(4)
  v_mfma_f32_16x16x32_bf16 v[32:35], a[80:83], v[72:75], v[32:35]
  v_mfma_f32_16x16x32_bf16 v[36:39], a[80:83], v[76:79], v[36:39]
  ds_read_b128 v[64:67], v4 offset:16384
  ds_read_b128 v[68:71], v4 offset:18432
  v_mfma_f32_16x16x32_bf16 v[40:43], a[84:87], v[72:75], v[40:43]
  v_mfma_f32_16x16x32_bf16 v[44:47], a[84:87], v[76:79], v[44:47]
  v_mfma_f32_16x16x32_bf16 v[48:51], a[88:91], v[72:75], v[48:51]
  v_mfma_f32_16x16x32_bf16 v[52:55], a[88:91], v[76:79], v[52:55]
  v_mfma_f32_16x16x32_bf16 v[56:59], a[92:95], v[72:75], v[56:59]
  v_mfma_f32_16x16x32_bf16 v[60:63], a[92:95], v[76:79], v[60:63]
  s_waitcnt lgkmcnt(4)
  v_mfma_f32_16x16x32_bf16 v[32:35], a[96:99], v[80:83], v[32:35]
  v_mfma_f32_16x16x32_bf16 v[36:39], a[96:99], v[84:87], v[36:39]
  ds_read_b128 v[72:75], v6 offset:16384
  ds_read_b128 v[76:79], v6 offset:18432
  v_mfma_f32_16x16x32_bf16 v[40:43], a[100:103], v[80:83], v[40:43]
  v_mfma_f32_16x16x32_bf16 v[44:47], a[100:103], v[84:87], v[44:47]
  v_mfma_f32_16x16x32_bf16 v[48:51], a[104:107], v[80:83], v[48:51]
  v_mfma_f32_16x16x32_bf16 v[52:55], a[104:107], v[84:87], v[52:55]
  v_mfma_f32_16x16x32_bf16 v[56:59], a[108:111], v[80:83], v[56:59]
  v_mfma_f32_16x16x32_bf16 v[60:63], a[108:111], v[84:87], v[60:63]
  s_waitcnt lgkmcnt(4)
  v_mfma_f32_16x16x32_bf16 v[32:35], a[112:115], v[88:91], v[32:35]
  v_mfma_f32_16x16x32_bf16 v[36:39], a[112:115], v[92:95], v[36:39]
  ds_read_b128 v[80:83], v4 offset:20480
  ds_read_b128 v[84:87], v4 offset:22528
  v_mfma_f32_16x16x32_bf16 v[40:43], a[116:119], v[88:91], v[40:43]
  v_mfma_f32_16x16x32_bf16 v[44:47], a[116:119], v[92:95], v[44:47]
  v_mfma_f32_16x16x32_bf16 v[48:51], a[120:123], v[88:91], v[48:51]
  v_mfma_f32_16x16x32_bf16 v[52:55], a[120:123], v[92:95], v[52:55]
  v_mfma_f32_16x16x32_bf16 v[56:59], a[124:127], v[88:91], v[56:59]
  v_mfma_f32_16x16x32_bf16 v[60:63], a[124:127], v[92:95], v[60:63]
  s_waitcnt lgkmcnt(4)
  v_mfma_f32_16x16x32_bf16 v[32:35], a[128:131], v[64:67], v[32:35]
  v_mfma_f32_16x16x32_bf16 v[36:39], a[128:131], v[68:71], v[36:39]
  ds_read_b128 v[88:91], v6 offset:20480
  ds_read_b128 v[92:95], v6 offset:22528
  v_mfma_f32_16x16x32_bf16 v[40:43], a[132:135], v[64:67], v[40:43]
  v_mfma_f32_16x16x32_bf16 v[44:47], a[132:135], v[68:71], v[44:47]
  v_mfma_f32_16x16x32_bf16 v[48:51], a[136:139], v[64:67], v[48:51]
  v_mfma_f32_16x16x32_bf16 v[52:55], a[136:139], v[68:71], v[52:55]
  v_mfma_f32_16x16x32_bf16 v[56:59], a[140:143], v[64:67], v[56:59]
  v_mfma_f32_16x16x32_bf16 v[60:63], a[140:143], v[68:71], v[60:63]
L_g1_F1:
  s_waitcnt lgkmcnt(4)
  v_mfma_f32_16x16x32_bf16 v[32:35], a[144:147], v[72:75], v[32:35]
  v_mfma_f32_16x16x32_bf16 v[36:39], a[144:147], v[76:79], v[36:39]
  ds_read_b128 v[64:67], v4 offset:24576
  ds_read_b128 v[68:71], v4 offset:26624
  v_mfma_f32_16x16x32_bf16 v[40:43], a[148:151], v[72:75], v[40:43]
  v_mfma_f32_16x16x32_bf16 v[44:47], a[148:151], v[76:79], v[44:47]
  v_mfma_f32_16x16x32_bf16 v[48:51], a[152:155], v[72:75], v[48:51]
  v_mfma_f32_16x16x32_bf16 v[52:55], a[152:155], v[76:79], v[52:55]
  v_mfma_f32_16x16x32_bf16 v[56:59], a[156:159], v[72:75], v[56:59]
  v_mfma_f32_16x16x32_bf16 v[60:63], a[156:159], v[76:79], v[60:63]
  s_waitcnt lgkmcnt(4)
  v_mfma_f32_16x16x32_bf16 v[32:35], a[160:163], v[80:83], v[32:35]
  v_mfma_f32_16x16x32_bf16 v[36:39], a[160:163], v[84:87], v[36:39]
  ds_read_b128 v[72:75], v6 offset:24576
  ds_read_b128 v[76:79], v6 offset:26624
  v_mfma_f32_16x16x32_bf16 v[40:43], a[164:167], v[80:83], v[40:43]
  v_mfma_f32_16x16x32_bf16 v[44:47], a[164:167], v[84:87], v[44:47]
  v_mfma_f32_16x16x32_bf16 v[48:51], a[168:171], v[80:83], v[48:51]
  v_mfma_f32_16x16x32_bf16 v[52:55], a[168:171], v[84:87], v[52:55]
  v_mfma_f32_16x16x32_bf16 v[56:59], a[172:175], v[80:83], v[56:59]
  v_mfma_f32_16x16x32_bf16 v[60:63], a[172:175], v[84:87], v[60:63]
  s_waitcnt lgkmcnt(4)
  v_mfma_f32_16x16x32_bf16 v[32:35], a[176:179], v[88:91], v[32:35]
  v_mfma_f32_16x16x32_bf16 v[36:39], a[176:179], v[92:95], v[36:39]
  ds_read_b128 v[80:83], v4 offset:28672
  ds_read_b128 v[84:87], v4 offset:30720
  v_mfma_f32_16x16x32_bf16 v[40:43], a[180:183], v[88:91], v[40:43]
  v_mfma_f32_16x16x32_bf16 v[44:47], a[180:183], v[92:95], v[44:47]
  v_mfma_f32_16x16x32_bf16 v[48:51], a[184:187], v[88:91], v[48:51]
  v_mfma_f32_16x16x32_bf16 v[52:55], a[184:187], v[92:95], v[52:55]
  v_mfma_f32_16x16x32_bf16 v[56:59], a[188:191], v[88:91], v[56:59]
  v_mfma_f32_16x16x32_bf16 v[60:63], a[188:191], v[92:95], v[60:63]
  s_waitcnt lgkmcnt(4)
  v_mfma_f32_16x16x32_bf16 v[32:35], a[192:195], v[64:67], v[32:35]
  v_mfma_f32_16x16x32_bf16 v[36:39], a[192:195], v[68:71], v[36:39]
  ds_read_b128 v[88:91], v6 offset:28672
  ds_read_b128 v[92:95], v6 offset:30720
  v_mfma_f32_16x16x32_bf16 v[40:43], a[196:199], v[64:67], v[40:43]
  v_mfma_f32_16x16x32_bf16 v[44:47], a[196:199], v[68:71], v[44:47]
  v_mfma_f32_16x16x32_bf16 v[48:51], a[200:203], v[64:67], v[48:51]
  v_mfma_f32_16x16x32_bf16 v[52:55], a[200:203], v[68:71], v[52:55]
  v_mfma_f32_16x16x32_bf16 v[56:59], a[204:207], v[64:67], v[56:59]
  v_mfma_f32_16x16x32_bf16 v[60:63], a[204:207], v[68:71], v[60:63]
  s_waitcnt lgkmcnt(4)
  v_mfma_f32_16x16x32_bf16 v[32:35], a[208:211], v[72:75], v[32:35]
  v_mfma_f32_16x16x32_bf16 v[36:39], a[208:211], v[76:79], v[36:39]
  ds_read_b128 v[64:67], v4 offset:32768
  ds_read_b128 v[68:71], v4 offset:34816
  v_mfma_f32_16x16x32_bf16 v[40:43], a[212:215], v[72:75], v[40:43]
  v_mfma_f32_16x16x32_bf16 v[44:47], a[212:215], v[76:79], v[44:47]
  v_mfma_f32_16x16x32_bf16 v[48:51], a[216:219], v[72:75], v[48:51]
  v_mfma_f32_16x16x32_bf16 v[52:55], a[216:219], v[76:79], v[52:55]
  v_mfma_f32_16x16x32_bf16 v[56:59], a[220:223], v[72:75], v[56:59]
  v_mfma_f32_16x16x32_bf16 v[60:63], a[220:223], v[76:79], v[60:63]
  s_waitcnt lgkmcnt(4)
  v_mfma_f32_16x16x32_bf16 v[32:35], a[224:227], v[80:83], v[32:35]
  v_mfma_f32_16x16x32_bf16 v[36:39], a[224:227], v[84:87], v[36:39]
  ds_read_b128 v[72:75], v6 offset:32768
  ds_read_b128 v[76:79], v6 offset:34816
  v_mfma_f32_16x16x32_bf16 v[40:43], a[228:231], v[80:83], v[40:43]
  v_mfma_f32_16x16x32_bf16 v[44:47], a[228:231], v[84:87], v[44:47]
  v_mfma_f32_16x16x32_bf16 v[48:51], a[232:235], v[80:83], v[48:51]
  v_mfma_f32_16x16x32_bf16 v[52:55], a[232:235], v[84:87], v[52:55]
  v_mfma_f32_16x16x32_bf16 v[56:59], a[236:239], v[80:83], v[56:59]
  v_mfma_f32_16x16x32_bf16 v[60:63], a[236:239], v[84:87], v[60:63]
  s_waitcnt vmcnt(0)
  s_barrier
  s_cmp_lg_u32 s29, 0
  s_cbranch_scc1 L_g1f_6
  v_cmp_eq_u32 vcc, 0, v7
  s_cbranch_vccz L_g1f_6p
  buffer_load_dword v7, off, s[20:23], 0 offset:128 sc1
  s_branch L_g1f_6
L_g1f_6p:
  v_mov_b32 v5, s42
  buffer_store_dword v5, off, s[4:7], s36 sc1
L_g1f_6:
  s_add_u32 s52, s48, s45
  s_min_u32 s44, s43, 2580480
  s_add_u32 s43, s43, 40960
  s_waitcnt lgkmcnt(4)
  v_mfma_f32_16x16x32_bf16 v[32:35], a[240:243], v[88:91], v[32:35]
  v_mfma_f32_16x16x32_bf16 v[36:39], a[240:243], v[92:95], v[36:39]
  ds_read_b128 v[80:83], v4 offset:36864
  ds_read_b128 v[84:87], v4 offset:38912
  v_mfma_f32_16x16x32_bf16 v[40:43], a[244:247], v[88:91], v[40:43]
  v_mfma_f32_16x16x32_bf16 v[44:47], a[244:247], v[92:95], v[44:47]
  s_add_u32 m0, s52, 0
  s_add_u32 s53, s44, 0
  buffer_load_dwordx4 v8, s[16:19], s53 offen lds
  v_mfma_f32_16x16x32_bf16 v[48:51], a[248:251], v[88:91], v[48:51]
  v_mfma_f32_16x16x32_bf16 v[52:55], a[248:251], v[92:95], v[52:55]
  v_mfma_f32_16x16x32_bf16 v[56:59], a[252:255], v[88:91], v[56:59]
  v_mfma_f32_16x16x32_bf16 v[60:63], a[252:255], v[92:95], v[60:63]
  s_add_u32 m0, s52, 4096
  s_add_u32 s53, s44, 128
  buffer_load_dwordx4 v8, s[16:19], s53 offen lds
  s_waitcnt lgkmcnt(4)
  v_mfma_f32_16x16x32_bf16 v[32:35], v[192:195], v[64:67], v[32:35]
  v_mfma_f32_16x16x32_bf16 v[36:39], v[192:195], v[68:71], v[36:39]
  ds_read_b128 v[88:91], v6 offset:36864
  ds_read_b128 v[92:95], v6 offset:38912
  v_mfma_f32_16x16x32_bf16 v[40:43], v[196:199], v[64:67], v[40:43]
  v_mfma_f32_16x16x32_bf16 v[44:47], v[196:199], v[68:71], v[44:47]
  s_add_u32 m0, s52, 8192
  s_add_u32 s53, s44, 256
  buffer_load_dwordx4 v8, s[16:19], s53 offen lds
  v_mfma_f32_16x16x32_bf16 v[48:51], v[200:203], v[64:67], v[48:51]
  v_mfma_f32_16x16x32_bf16 v[52:55], v[200:203], v[68:71], v[52:55]
  v_mfma_f32_16x16x32_bf16 v[56:59], v[204:207], v[64:67], v[56:59]
  v_mfma_f32_16x16x32_bf16 v[60:63], v[204:207], v[68:71], v[60:63]
  s_add_u32 m0, s52, 12288
  s_add_u32 s53, s44, 384
  buffer_load_dwordx4 v8, s[16:19], s53 offen lds
  s_waitcnt lgkmcnt(4)
  v_mfma_f32_16x16x32_bf16 v[32:35], v[208:211], v[72:75], v[32:35]
  v_mfma_f32_16x16x32_bf16 v[36:39], v[208:211], v[76:79], v[36:39]
  ds_read_b128 v[64:67], v10 offset:0
  ds_read_b128 v[68:71], v10 offset:2048
  v_mfma_f32_16x16x32_bf16 v[40:43], v[212:215], v[72:75], v[40:43]
  v_mfma_f32_16x16x32_bf16 v[44:47], v[212:215], v[76:79], v[44:47]
  s_add_u32 m0, s52, 16384
  s_add_u32 s53, s44, 512
  buffer_load_dwordx4 v8, s[16:19], s53 offen lds
  v_mfma_f32_16x16x32_bf16 v[48:51], v[216:219], v[72:75], v[48:51]
  v_mfma_f32_16x16x32_bf16 v[52:55], v[216:219], v[76:79], v[52:55]
  v_mfma_f32_16x16x32_bf16 v[56:59], v[220:223], v[72:75], v[56:59]
  v_mfma_f32_16x16x32_bf16 v[60:63], v[220:223], v[76:79], v[60:63]
  s_add_u32 m0, s52, 20480
  s_add_u32 s53, s44, 640
  buffer_load_dwordx4 v8, s[16:19], s53 offen lds
  s_waitcnt lgkmcnt(4)
  v_mfma_f32_16x16x32_bf16 v[32:35], v[224:227], v[80:83], v[32:35]
  v_mfma_f32_16x16x32_bf16 v[36:39], v[224:227], v[84:87], v[36:39]
  ds_read_b128 v[72:75], v11 offset:0
  ds_read_b128 v[76:79], v11 offset:2048
  v_mfma_f32_16x16x32_bf16 v[40:43], v[228:231], v[80:83], v[40:43]
  v_mfma_f32_16x16x32_bf16 v[44:47], v[228:231], v[84:87], v[44:47]
  s_add_u32 m0, s52, 24576
  s_add_u32 s53, s44, 768
  buffer_load_dwordx4 v8, s[16:19], s53 offen lds
  v_mfma_f32_16x16x32_bf16 v[48:51], v[232:235], v[80:83], v[48:51]
  v_mfma_f32_16x16x32_bf16 v[52:55], v[232:235], v[84:87], v[52:55]
  v_mfma_f32_16x16x32_bf16 v[56:59], v[236:239], v[80:83], v[56:59]
  v_mfma_f32_16x16x32_bf16 v[60:63], v[236:239], v[84:87], v[60:63]
  s_add_u32 m0, s52, 28672
  s_add_u32 s53, s44, 896
  buffer_load_dwordx4 v8, s[16:19], s53 offen lds
  s_waitcnt lgkmcnt(4)
  v_mfma_f32_16x16x32_bf16 v[32:35], v[240:243], v[88:91], v[32:35]
  v_mfma_f32_16x16x32_bf16 v[36:39], v[240:243], v[92:95], v[36:39]
  ds_read_b128 v[80:83], v10 offset:4096
  ds_read_b128 v[84:87], v10 offset:6144
  v_mfma_f32_16x16x32_bf16 v[40:43], v[244:247], v[88:91], v[40:43]
  v_mfma_f32_16x16x32_bf16 v[44:47], v[244:247], v[92:95], v[44:47]
  s_add_u32 m0, s52, 32768
  s_add_u32 s53, s44, 1024
  buffer_load_dwordx4 v8, s[16:19], s53 offen lds
  v_mfma_f32_16x16x32_bf16 v[48:51], v[248:251], v[88:91], v[48:51]
  v_mfma_f32_16x16x32_bf16 v[52:55], v[248:251], v[92:95], v[52:55]
  v_mfma_f32_16x16x32_bf16 v[56:59], v[252:255], v[88:91], v[56:59]
  v_mfma_f32_16x16x32_bf16 v[60:63], v[252:255], v[92:95], v[60:63]
  s_add_u32 m0, s52, 36864
  s_add_u32 s53, s44, 1152
  buffer_load_dwordx4 v8, s[16:19], s53 offen lds
  s_add_u32 s34, s34, s35
  s_add_u32 s54, s34, 4096
  s_mov_b32 s40, s46
  s_mov_b32 s46, s47
  s_mov_b32 s47, s48
  s_mov_b32 s48, s40
  v_mov_b32 v4, v10
  v_mov_b32 v6, v11
  v_add_u32 v10, s47, v9
  v_xor_b32 v11, 64, v10
  s_add_u32 s42, s42, 1
  s_cmp_lt_u32 s42, 64
  v_pk_mul_f32 v[144:145], v[32:33], s[50:51]
  v_pk_mul_f32 v[146:147], v[34:35], s[50:51]
  v_pk_mul_f32 v[148:149], v[36:37], s[50:51]
  v_pk_mul_f32 v[150:151], v[38:39], s[50:51]
  v_pk_mul_f32 v[152:153], v[40:41], s[50:51]
  v_pk_mul_f32 v[154:155], v[42:43], s[50:51]
  v_pk_mul_f32 v[156:157], v[44:45], s[50:51]
  v_pk_mul_f32 v[158:159], v[46:47], s[50:51]
  v_pk_mul_f32 v[112:113], v[32:33], v[48:49]
  v_pk_mul_f32 v[114:115], v[34:35], v[50:51]
  v_pk_mul_f32 v[116:117], v[36:37], v[52:53]
  v_pk_mul_f32 v[118:119], v[38:39], v[54:55]
  v_pk_mul_f32 v[120:121], v[40:41], v[56:57]
  v_pk_mul_f32 v[122:123], v[42:43], v[58:59]
  v_pk_mul_f32 v[124:125], v[44:45], v[60:61]
  v_pk_mul_f32 v[126:127], v[46:47], v[62:63]
  s_cbranch_scc1 L_g1_Floop
  v_exp_f32 v144, v144
  v_exp_f32 v145, v145
  v_exp_f32 v146, v146
  v_exp_f32 v147, v147
  v_exp_f32 v148, v148
  v_exp_f32 v149, v149
  v_exp_f32 v150, v150
  v_exp_f32 v151, v151
  v_exp_f32 v152, v152
  v_exp_f32 v153, v153
  v_exp_f32 v154, v154
  v_exp_f32 v155, v155
  v_exp_f32 v156, v156
  v_exp_f32 v157, v157
  v_exp_f32 v158, v158
  v_exp_f32 v159, v159
  v_add_f32 v144, 1.0, v144
  v_add_f32 v145, 1.0, v145
  v_add_f32 v146, 1.0, v146
  v_add_f32 v147, 1.0, v147
  v_add_f32 v148, 1.0, v148
  v_add_f32 v149, 1.0, v149
  v_add_f32 v150, 1.0, v150
  v_add_f32 v151, 1.0, v151
  v_add_f32 v152, 1.0, v152
  v_add_f32 v153, 1.0, v153
  v_add_f32 v154, 1.0, v154
  v_add_f32 v155, 1.0, v155
  v_add_f32 v156, 1.0, v156
  v_add_f32 v157, 1.0, v157
  v_add_f32 v158, 1.0, v158
  v_add_f32 v159, 1.0, v159
  v_rcp_f32 v144, v144
  v_rcp_f32 v145, v145
  v_rcp_f32 v146, v146
  v_rcp_f32 v147, v147
  v_rcp_f32 v148, v148
  v_rcp_f32 v149, v149
  v_rcp_f32 v150, v150
  v_rcp_f32 v151, v151
  v_rcp_f32 v152, v152
  v_rcp_f32 v153, v153
  v_rcp_f32 v154, v154
  v_rcp_f32 v155, v155
  v_rcp_f32 v156, v156
  v_rcp_f32 v157, v157
  v_rcp_f32 v158, v158
  v_rcp_f32 v159, v159
  v_mul_f32 v112, v112, v144
  v_mul_f32 v113, v113, v145
  v_mul_f32 v114, v114, v146
  v_mul_f32 v115, v115, v147
  v_mul_f32 v116, v116, v148
  v_mul_f32 v117, v117, v149
  v_mul_f32 v118, v118, v150
  v_mul_f32 v119, v119, v151
  v_mul_f32 v120, v120, v152
  v_mul_f32 v121, v121, v153
  v_mul_f32 v122, v122, v154
  v_mul_f32 v123, v123, v155
  v_mul_f32 v124, v124, v156
  v_mul_f32 v125, v125, v157
  v_mul_f32 v126, v126, v158
  v_mul_f32 v127, v127, v159
  v_cvt_pk_bf16_f32 v96, v112, v113
  v_cvt_pk_bf16_f32 v97, v114, v115
  v_cvt_pk_bf16_f32 v98, v120, v121
  v_cvt_pk_bf16_f32 v99, v122, v123
  buffer_store_dwordx4 v[96:99], v3, s[4:7], s34 offen offset:0 sc1
  v_cvt_pk_bf16_f32 v100, v116, v117
  v_cvt_pk_bf16_f32 v101, v118, v119
  v_cvt_pk_bf16_f32 v102, v124, v125
  v_cvt_pk_bf16_f32 v103, v126, v127
  buffer_store_dwordx4 v[100:103], v3, s[4:7], s34 offen offset:1024 sc1
  s_branch L_g1_fin
L_g1_I:
  s_waitcnt vmcnt(0)
  s_barrier
  s_add_u32 s52, s48, s45
  s_min_u32 s44, s43, 2580480
  s_add_u32 s43, s43, 40960
  s_add_u32 m0, s52, 0
  s_add_u32 s53, s44, 0
  buffer_load_dwordx4 v8, s[16:19], s53 offen lds
  s_add_u32 m0, s52, 4096
  s_add_u32 s53, s44, 128
  buffer_load_dwordx4 v8, s[16:19], s53 offen lds
  s_add_u32 m0, s52, 8192
  s_add_u32 s53, s44, 256
  buffer_load_dwordx4 v8, s[16:19], s53 offen lds
  s_add_u32 m0, s52, 12288
  s_add_u32 s53, s44, 384
  buffer_load_dwordx4 v8, s[16:19], s53 offen lds
  s_add_u32 m0, s52, 16384
  s_add_u32 s53, s44, 512
  buffer_load_dwordx4 v8, s[16:19], s53 offen lds
  s_add_u32 m0, s52, 20480
  s_add_u32 s53, s44, 640
  buffer_load_dwordx4 v8, s[16:19], s53 offen lds
  s_add_u32 m0, s52, 24576
  s_add_u32 s53, s44, 768
  buffer_load_dwordx4 v8, s[16:19], s53 offen lds
  s_add_u32 m0, s52, 28672
  s_add_u32 s53, s44, 896
  buffer_load_dwordx4 v8, s[16:19], s53 offen lds
  s_add_u32 m0, s52, 32768
  s_add_u32 s53, s44, 1024
  buffer_load_dwordx4 v8, s[16:19], s53 offen lds
  s_add_u32 m0, s52, 36864
  s_add_u32 s53, s44, 1152
  buffer_load_dwordx4 v8, s[16:19], s53 offen lds
  s_add_u32 s34, s34, s35
  s_add_u32 s54, s34, 4096
  s_mov_b32 s40, s46
  s_mov_b32 s46, s47
  s_mov_b32 s47, s48
  s_mov_b32 s48, s40
  v_mov_b32 v4, v10
  v_mov_b32 v6, v11
  v_add_u32 v10, s47, v9
  v_xor_b32 v11, 64, v10
  s_add_u32 s42, s42, 1
  s_cmp_lt_u32 s42, 64
  s_cbranch_scc1 L_g1_I
L_g1_fin:
  s_waitcnt vmcnt(0)
  s_barrier
  s_cmp_lg_u32 s29, 0
  s_cbranch_scc1 L_end
  s_load_dwordx2 s[20:21], s[0:1], 104
  s_mov_b32 s22, 256
  s_mov_b32 s23, 0x20000
  s_mov_b32 s38, 0
  s_waitcnt lgkmcnt(0)
L_g1e_wi:
  buffer_load_dword v1, off, s[20:23], 0 offset:128 sc1
  s_waitcnt vmcnt(0)
  v_cmp_eq_u32 vcc, 0, v1
  s_cbranch_vccz L_g1e_wd
  s_sleep 8
  s_add_u32 s38, s38, 1
  s_cmp_lt_u32 s38, 0x100000
  s_cbranch_scc1 L_g1e_wi
  s_branch L_end
L_g1e_wd:
  v_mov_b32 v5, s42
  buffer_store_dword v5, off, s[4:7], s36 sc1
  s_branch L_end
L_att:
  v_lshrrev_b32 v1, 6, v0
  s_nop 0
  v_readfirstlane_b32 s29, v1
  s_load_dwordx2 s[8:9], s[0:1], 0
  s_load_dwordx2 s[12:13], s[0:1], 88
  s_load_dwordx2 s[16:17], s[0:1], 104
  s_mov_b32 s10, 2621440
  s_mov_b32 s11, 0x20000
  s_mov_b32 s14, 1280
  s_mov_b32 s15, 0x20000
  s_mov_b32 s18, 256
  s_mov_b32 s19, 0x20000
  s_waitcnt lgkmcnt(0)
  s_mov_b32 s31, s30
  v_and_b32 v6, 31, v0
  v_lshlrev_b32 v6, 2, v6
  buffer_load_dword v20, v6, s[12:15], 0 offen offset:0
  buffer_load_dword v21, v6, s[12:15], 0 offen offset:128
  buffer_load_dword v22, v6, s[12:15], 0 offen offset:256
  buffer_load_dword v23, v6, s[12:15], 0 offen offset:384
  buffer_load_dword v24, v6, s[12:15], 0 offen offset:512
  buffer_load_dword v25, v6, s[12:15], 0 offen offset:640
  buffer_load_dword v26, v6, s[12:15], 0 offen offset:768
  buffer_load_dword v27, v6, s[12:15], 0 offen offset:896
  buffer_load_dword v28, v6, s[12:15], 0 offen offset:1024
  buffer_load_dword v29, v6, s[12:15], 0 offen offset:1152
L_h_g1:
  v_lshrrev_b32 v5, 5, v0
  s_lshl_b32 s21, s31, 3
  v_add_u32 v5, s21, v5
  v_mul_u32_u24 v7, 1280, v5
  v_add_u32 v7, v7, v6
  buffer_load_dword v10, v7, s[8:11], 0 offen offset:0
  buffer_load_dword v11, v7, s[8:11], 0 offen offset:128
  buffer_load_dword v12, v7, s[8:11], 0 offen offset:256
  buffer_load_dword v13, v7, s[8:11], 0 offen offset:384
  buffer_load_dword v14, v7, s[8:11], 0 offen offset:512
  buffer_load_dword v15, v7, s[8:11], 0 offen offset:640
  buffer_load_dword v16, v7, s[8:11], 0 offen offset:768
  buffer_load_dword v17, v7, s[8:11], 0 offen offset:896
  buffer_load_dword v18, v7, s[8:11], 0 offen offset:1024
  buffer_load_dword v19, v7, s[8:11], 0 offen offset:1152
  v_mov_b32 v8, 0
  s_waitcnt vmcnt(0)
  v_lshlrev_b32 v30, 16, v10
  v_lshlrev_b32 v31, 16, v20
  v_fmac_f32 v8, v30, v31
  v_and_b32 v30, 0xffff0000, v10
  v_and_b32 v31, 0xffff0000, v20
  v_fmac_f32 v8, v30, v31
  v_lshlrev_b32 v30, 16, v11
  v_lshlrev_b32 v31, 16, v21
  v_fmac_f32 v8, v30, v31
  v_and_b32 v30, 0xffff0000, v11
  v_and_b32 v31, 0xffff0000, v21
  v_fmac_f32 v8, v30, v31
  v_lshlrev_b32 v30, 16, v12
  v_lshlrev_b32 v31, 16, v22
  v_fmac_f32 v8, v30, v31
  v_and_b32 v30, 0xffff0000, v12
  v_and_b32 v31, 0xffff0000, v22
  v_fmac_f32 v8, v30, v31
  v_lshlrev_b32 v30, 16, v13
  v_lshlrev_b32 v31, 16, v23
  v_fmac_f32 v8, v30, v31
  v_and_b32 v30, 0xffff0000, v13
  v_and_b32 v31, 0xffff0000, v23
  v_fmac_f32 v8, v30, v31
  v_lshlrev_b32 v30, 16, v14
  v_lshlrev_b32 v31, 16, v24
  v_fmac_f32 v8, v30, v31
  v_and_b32 v30, 0xffff0000, v14
  v_and_b32 v31, 0xffff0000, v24
  v_fmac_f32 v8, v30, v31
  v_lshlrev_b32 v30, 16, v15
  v_lshlrev_b32 v31, 16, v25
  v_fmac_f32 v8, v30, v31
  v_and_b32 v30, 0xffff0000, v15
  v_and_b32 v31, 0xffff0000, v25
  v_fmac_f32 v8, v30, v31
  v_lshlrev_b32 v30, 16, v16
  v_lshlrev_b32 v31, 16, v26
  v_fmac_f32 v8, v30, v31
  v_and_b32 v30, 0xffff0000, v16
  v_and_b32 v31, 0xffff0000, v26
  v_fmac_f32 v8, v30, v31
  v_lshlrev_b32 v30, 16, v17
  v_lshlrev_b32 v31, 16, v27
  v_fmac_f32 v8, v30, v31
  v_and_b32 v30, 0xffff0000, v17
  v_and_b32 v31, 0xffff0000, v27
  v_fmac_f32 v8, v30, v31
  v_lshlrev_b32 v30, 16, v18
  v_lshlrev_b32 v31, 16, v28
  v_fmac_f32 v8, v30, v31
  v_and_b32 v30, 0xffff0000, v18
  v_and_b32 v31, 0xffff0000, v28
  v_fmac_f32 v8, v30, v31
  v_lshlrev_b32 v30, 16, v19
  v_lshlrev_b32 v31, 16, v29
  v_fmac_f32 v8, v30, v31
  v_and_b32 v30, 0xffff0000, v19
  v_and_b32 v31, 0xffff0000, v29
  v_fmac_f32 v8, v30, v31
  s_nop 1
  v_add_f32_dpp v8, v8, v8 row_ror:1 row_mask:0xf bank_mask:0xf
  s_nop 1
  v_add_f32_dpp v8, v8, v8 row_ror:2 row_mask:0xf bank_mask:0xf
  s_nop 1
  v_add_f32_dpp v8, v8, v8 row_ror:4 row_mask:0xf bank_mask:0xf
  s_nop 1
  v_add_f32_dpp v8, v8, v8 row_ror:8 row_mask:0xf bank_mask:0xf
  v_mov_b32 v9, v8
  s_nop 1
  v_permlane16_swap_b32 v8, v9
  v_add_f32 v8, v8, v9
  v_mul_f32 v8, 0xbfb8aa3b, v8
  v_exp_f32 v8, v8
  s_nop 0
  v_add_f32 v8, 1.0, v8
  v_rcp_f32 v8, v8
  v_lshlrev_b32 v5, 2, v5
  s_mov_b32 s21, 100728832
  s_mov_b32 exec_lo, 1
  s_mov_b32 exec_hi, 1
  buffer_atomic_swap v8, v5, s[4:7], s21 offen
  s_mov_b64 exec, -1
  s_add_u32 s31, s31, 16
  s_cmp_lt_u32 s31, 256
  s_cbranch_scc1 L_h_g1
  s_waitcnt vmcnt(0)
  s_barrier
  s_cmp_lg_u32 s29, 0
  s_cbranch_scc1 L_h_gd
  v_mov_b32 v5, 1
  s_mov_b64 exec, 1
  buffer_atomic_add v5, off, s[16:19], 0 offset:4 sc0
  s_waitcnt vmcnt(0)
  v_readfirstlane_b32 s21, v5
  s_cmp_lg_u32 s21, 15
  s_cbranch_scc1 L_h_gd
  buffer_atomic_swap v5, off, s[16:19], 0 offset:132
  s_branch L_h_gd
L_h_gd:
  s_mov_b64 exec, -1
  v_and_b32 v2, 63, v0
  v_lshlrev_b32 v3, 4, v2
  s_lshl_b32 s31, s30, 2
  s_add_u32 s31, s31, s29
  s_lshr_b32 s32, s31, 5
  s_add_u32 s36, s31, 128
  s_lshl_b32 s36, s36, 7
  s_add_u32 s36, s36, 100663296
  s_and_b32 s31, s31, 31
  v_and_b32 v4, 15, v2
  v_lshrrev_b32 v5, 4, v2
  s_add_u32 s38, s31, 64
  s_lshr_b32 s39, s31, 1
  s_add_u32 s39, s39, 96
  v_and_b32 v8, 1, v2
  v_mov_b32 v6, s38
  v_mov_b32 v9, s39
  v_cmp_eq_u32 vcc, 1, v8
  s_nop 1
  v_cndmask_b32 v6, v6, v9, vcc
  v_lshlrev_b32 v6, 7, v6
  v_add_u32 v6, 100663296, v6
  s_lshl_b32 s38, s31, 1
  v_add_u32 v7, s38, v8
  v_lshlrev_b32 v7, 7, v7
  v_add_u32 v7, 100663296, v7
  v_and_b32 v8, 7, v2
  v_lshlrev_b32 v8, 4, v8
  v_lshl_add_u32 v8, v5, 8, v8
  v_and_b32 v9, 1, v5
  v_lshlrev_b32 v9, 3, v9
  v_lshl_add_u32 v9, v4, 4, v9
  v_mov_b32 v10, 0
  v_mov_b32 v11, 0xf149f2ca
  v_cmp_gt_u32 vcc, 2, v5
  s_nop 1
  v_cndmask_b32 v12, v10, v11, vcc
  v_mov_b32 v13, v12
  v_mov_b32 v14, v12
  v_mov_b32 v15, v12
  v_lshlrev_b32 v20, 2, v5
  v_add_u32 v21, 0, v20
  v_cmp_gt_u32 vcc, v21, v4
  s_nop 1
  v_cndmask_b32 v16, v10, v11, vcc
  v_add_u32 v21, 1, v20
  v_cmp_gt_u32 vcc, v21, v4
  s_nop 1
  v_cndmask_b32 v17, v10, v11, vcc
  v_add_u32 v21, 2, v20
  v_cmp_gt_u32 vcc, v21, v4
  s_nop 1
  v_cndmask_b32 v18, v10, v11, vcc
  v_add_u32 v21, 3, v20
  v_cmp_gt_u32 vcc, v21, v4
  s_nop 1
  v_cndmask_b32 v19, v10, v11, vcc
  s_load_dwordx2 s[20:21], s[0:1], 104
  s_mov_b32 s22, 256
  s_mov_b32 s23, 0x20000
  s_mov_b32 s38, 0
  s_waitcnt lgkmcnt(0)
L_att_wi:
  buffer_load_dword v1, off, s[20:23], 0 offset:128 sc1
  s_waitcnt vmcnt(0)
  v_cmp_eq_u32 vcc, 0, v1
  s_cbranch_vccz L_att_wd
  s_sleep 8
  s_add_u32 s38, s38, 1
  s_cmp_lt_u32 s38, 0x100000
  s_cbranch_scc1 L_att_wi
  s_branch L_end
L_att_wd:
  v_mov_b32 v20, 0x3f803f80
  v_mov_b32 v21, 0x3f803f80
  v_mov_b32 v22, 0x3f803f80
  v_mov_b32 v23, 0x3f803f80
  s_mov_b32 s43, 0x3e0293ee
  s_mov_b32 s42, s32
  s_mov_b32 s50, 0
L_att_loop:
  s_add_u32 s44, s42, 1
  s_lshl_b32 s38, s42, 5
  s_add_u32 s38, s38, s31
  s_lshl_b32 s33, s38, 13
  s_add_u32 s33, s33, 67108864
  s_lshl_b32 s34, s38, 14
  s_add_u32 s34, s34, 16777216
  s_lshl_b32 s35, s38, 12
  s_add_u32 s35, s35, 50331648
  s_lshl_b32 s37, s38, 13
  s_add_u32 s37, s37, 83886080
L_att1_p:
  buffer_load_dword v24, v6, s[4:7], 0 offen sc1
  s_waitcnt vmcnt(0)
  v_cmp_gt_u32 vcc, s44, v24
  s_cbranch_vccz L_att1_ok
  s_sleep 8
  s_add_u32 s50, s50, 1
  s_cmp_lt_u32 s50, 0x200000
  s_cbranch_scc1 L_att1_p
  s_branch L_end
L_att1_ok:
  buffer_load_dwordx4 v[32:35], v3, s[4:7], s33 offen offset:0 sc1
  buffer_load_dwordx4 v[36:39], v3, s[4:7], s33 offen offset:1024 sc1
  buffer_load_dwordx4 v[40:43], v3, s[4:7], s33 offen offset:2048 sc1
  buffer_load_dwordx4 v[44:47], v3, s[4:7], s33 offen offset:3072 sc1
  s_add_u32 s33, s33, 4096
  buffer_load_dwordx4 v[48:51], v3, s[4:7], s33 offen offset:0 sc1
  buffer_load_dwordx4 v[52:55], v3, s[4:7], s33 offen offset:1024 sc1
  buffer_load_dwordx4 v[56:59], v3, s[4:7], s33 offen offset:2048 sc1
  buffer_load_dwordx4 v[60:63], v3, s[4:7], s33 offen offset:3072 sc1
  s_add_u32 s38, s34, 4096
  buffer_load_dwordx4 v[64:67], v3, s[4:7], s38 offen offset:0 sc1
  buffer_load_dwordx4 v[68:71], v3, s[4:7], s38 offen offset:1024 sc1
  buffer_load_dwordx4 v[72:75], v3, s[4:7], s38 offen offset:2048 sc1
  buffer_load_dwordx4 v[76:79], v3, s[4:7], s38 offen offset:3072 sc1
  s_add_u32 s38, s38, 4096
  buffer_load_dwordx4 v[80:83], v3, s[4:7], s38 offen offset:0 sc1
  buffer_load_dwordx4 v[84:87], v3, s[4:7], s38 offen offset:1024 sc1
  buffer_load_dwordx4 v[88:91], v3, s[4:7], s38 offen offset:2048 sc1
  buffer_load_dwordx4 v[92:95], v3, s[4:7], s38 offen offset:3072 sc1
  buffer_load_dwordx4 v[96:99], v3, s[4:7], s34 offen offset:0 sc1
  buffer_load_dwordx4 v[100:103], v3, s[4:7], s34 offen offset:1024 sc1
  buffer_load_dwordx4 v[104:107], v3, s[4:7], s34 offen offset:2048 sc1
  buffer_load_dwordx4 v[108:111], v3, s[4:7], s34 offen offset:3072 sc1
  s_add_u32 s34, s34, 12288
  buffer_load_dwordx4 v[112:115], v3, s[4:7], s34 offen offset:0 sc1
  buffer_load_dwordx4 v[116:119], v3, s[4:7], s34 offen offset:1024 sc1
  buffer_load_dwordx4 v[120:123], v3, s[4:7], s34 offen offset:2048 sc1
  buffer_load_dwordx4 v[124:127], v3, s[4:7], s34 offen offset:3072 sc1
  s_waitcnt vmcnt(8)
  v_mfma_f32_16x16x32_bf16 v[164:167], v[64:67], v[32:35], v[16:19]
  v_mfma_f32_16x16x32_bf16 v[172:175], v[64:67], v[48:51], 0
  v_mfma_f32_16x16x32_bf16 v[176:179], v[80:83], v[48:51], v[16:19]
  v_mfma_f32_16x16x32_bf16 v[164:167], v[68:71], v[36:39], v[164:167]
  v_mfma_f32_16x16x32_bf16 v[172:175], v[68:71], v[52:55], v[172:175]
  v_mfma_f32_16x16x32_bf16 v[176:179], v[84:87], v[52:55], v[176:179]
  v_mfma_f32_16x16x32_bf16 v[164:167], v[72:75], v[40:43], v[164:167]
  v_mfma_f32_16x16x32_bf16 v[172:175], v[72:75], v[56:59], v[172:175]
  v_mfma_f32_16x16x32_bf16 v[176:179], v[88:91], v[56:59], v[176:179]
  v_mfma_f32_16x16x32_bf16 v[164:167], v[76:79], v[44:47], v[164:167]
  v_mfma_f32_16x16x32_bf16 v[172:175], v[76:79], v[60:63], v[172:175]
  v_mfma_f32_16x16x32_bf16 v[176:179], v[92:95], v[60:63], v[176:179]
L_att2_p:
  buffer_load_dword v24, v7, s[4:7], 0 offen sc1
  s_waitcnt vmcnt(0)
  v_cmp_gt_u32 vcc, s44, v24
  s_cbranch_vccz L_att2_ok
  s_sleep 2
  s_add_u32 s50, s50, 1
  s_cmp_lt_u32 s50, 0x200000
  s_cbranch_scc1 L_att2_p
  s_branch L_end
L_att2_ok:
  buffer_load_dwordx4 v[128:131], v8, s[4:7], s35 offen offset:0 sc1
  buffer_load_dwordx4 v[132:135], v8, s[4:7], s35 offen offset:128 sc1
  buffer_load_dwordx4 v[136:139], v8, s[4:7], s35 offen offset:1024 sc1
  buffer_load_dwordx4 v[140:143], v8, s[4:7], s35 offen offset:1152 sc1
  buffer_load_dwordx2 v[144:145], v9, s[4:7], s35 offen offset:2048 sc1
  buffer_load_dwordx2 v[146:147], v9, s[4:7], s35 offen offset:2304 sc1
  buffer_load_dwordx2 v[148:149], v9, s[4:7], s35 offen offset:2560 sc1
  buffer_load_dwordx2 v[150:151], v9, s[4:7], s35 offen offset:2816 sc1
  buffer_load_dwordx2 v[152:153], v9, s[4:7], s35 offen offset:3072 sc1
  buffer_load_dwordx2 v[154:155], v9, s[4:7], s35 offen offset:3328 sc1
  buffer_load_dwordx2 v[156:157], v9, s[4:7], s35 offen offset:3584 sc1
  buffer_load_dwordx2 v[158:159], v9, s[4:7], s35 offen offset:3840 sc1
  s_waitcnt vmcnt(11)
  v_mfma_f32_16x16x32_bf16 v[160:163], v[128:131], v[32:35], v[12:15]
  v_mfma_f32_16x16x32_bf16 v[168:171], v[128:131], v[48:51], v[12:15]
  s_waitcnt vmcnt(10)
  v_mfma_f32_16x16x32_bf16 v[160:163], v[132:135], v[36:39], v[160:163]
  v_mfma_f32_16x16x32_bf16 v[168:171], v[132:135], v[52:55], v[168:171]
  s_waitcnt vmcnt(9)
  v_mfma_f32_16x16x32_bf16 v[160:163], v[136:139], v[40:43], v[160:163]
  v_mfma_f32_16x16x32_bf16 v[168:171], v[136:139], v[56:59], v[168:171]
  s_waitcnt vmcnt(8)
  v_mfma_f32_16x16x32_bf16 v[160:163], v[140:143], v[44:47], v[160:163]
  v_mfma_f32_16x16x32_bf16 v[168:171], v[140:143], v[60:63], v[168:171]
  s_nop 6
  v_max3_f32 v24, v160, v161, v162
  v_max3_f32 v24, v24, v163, v164
  v_max3_f32 v24, v24, v165, v166
  v_max_f32 v24, v24, v167
  v_max3_f32 v26, v168, v169, v170
  v_max3_f32 v26, v26, v171, v172
  v_max3_f32 v26, v26, v173, v174
  v_max3_f32 v26, v26, v175, v176
  v_max3_f32 v26, v26, v177, v178
  v_max_f32 v26, v26, v179
  v_mov_b32 v25, v24
  v_mov_b32 v27, v26
  s_nop 0
  v_permlane32_swap_b32 v24, v25
  v_permlane32_swap_b32 v26, v27
  v_max_f32 v24, v24, v25
  v_max_f32 v26, v26, v27
  v_mov_b32 v25, v24
  v_mov_b32 v27, v26
  s_nop 0
  v_permlane16_swap_b32 v24, v25
  v_permlane16_swap_b32 v26, v27
  v_max_f32 v24, v24, v25
  v_max_f32 v26, v26, v27
  v_mul_f32 v24, s43, v24
  v_mul_f32 v26, s43, v26
  v_fma_f32 v160, v160, s43, -v24
  v_fma_f32 v161, v161, s43, -v24
  v_fma_f32 v162, v162, s43, -v24
  v_fma_f32 v163, v163, s43, -v24
  v_fma_f32 v164, v164, s43, -v24
  v_fma_f32 v165, v165, s43, -v24
  v_fma_f32 v166, v166, s43, -v24
  v_fma_f32 v167, v167, s43, -v24
  v_fma_f32 v168, v168, s43, -v26
  v_fma_f32 v169, v169, s43, -v26
  v_fma_f32 v170, v170, s43, -v26
  v_fma_f32 v171, v171, s43, -v26
  v_fma_f32 v172, v172, s43, -v26
  v_fma_f32 v173, v173, s43, -v26
  v_fma_f32 v174, v174, s43, -v26
  v_fma_f32 v175, v175, s43, -v26
  v_fma_f32 v176, v176, s43, -v26
  v_fma_f32 v177, v177, s43, -v26
  v_fma_f32 v178, v178, s43, -v26
  v_fma_f32 v179, v179, s43, -v26
  v_exp_f32 v160, v160
  v_exp_f32 v161, v161
  v_exp_f32 v162, v162
  v_exp_f32 v163, v163
  v_exp_f32 v164, v164
  v_exp_f32 v165, v165
  v_exp_f32 v166, v166
  v_exp_f32 v167, v167
  v_exp_f32 v168, v168
  v_exp_f32 v169, v169
  v_exp_f32 v170, v170
  v_exp_f32 v171, v171
  v_exp_f32 v172, v172
  v_exp_f32 v173, v173
  v_exp_f32 v174, v174
  v_exp_f32 v175, v175
  v_exp_f32 v176, v176
  v_exp_f32 v177, v177
  v_exp_f32 v178, v178
  v_exp_f32 v179, v179
  v_cvt_pk_bf16_f32 v64, v160, v161
  v_cvt_pk_bf16_f32 v65, v162, v163
  v_cvt_pk_bf16_f32 v66, v164, v165
  v_cvt_pk_bf16_f32 v67, v166, v167
  v_cvt_pk_bf16_f32 v68, v168, v169
  v_cvt_pk_bf16_f32 v69, v170, v171
  v_cvt_pk_bf16_f32 v70, v172, v173
  v_cvt_pk_bf16_f32 v71, v174, v175
  v_cvt_pk_bf16_f32 v72, v176, v177
  v_cvt_pk_bf16_f32 v73, v178, v179
  s_waitcnt vmcnt(0)
  v_mfma_f32_16x16x32_bf16 v[160:163], v[20:23], v[64:67], 0
  v_mfma_f32_16x16x32_bf16 v[164:167], v[20:23], v[70:73], 0
  v_mfma_f32_16x16x16_bf16 v[192:195], v[96:97], v[66:67], 0
  v_mfma_f32_16x16x32_bf16 v[224:227], v[96:99], v[70:73], 0
  v_mfma_f32_16x16x16_bf16 v[196:199], v[100:101], v[66:67], 0
  v_mfma_f32_16x16x32_bf16 v[228:231], v[100:103], v[70:73], 0
  v_mfma_f32_16x16x16_bf16 v[200:203], v[104:105], v[66:67], 0
  v_mfma_f32_16x16x32_bf16 v[232:235], v[104:107], v[70:73], 0
  v_mfma_f32_16x16x16_bf16 v[164:167], v[20:21], v[68:69], v[164:167]
  v_mfma_f32_16x16x16_bf16 v[204:207], v[108:109], v[66:67], 0
  v_mfma_f32_16x16x32_bf16 v[236:239], v[108:111], v[70:73], 0
  v_mfma_f32_16x16x16_bf16 v[208:211], v[112:113], v[66:67], 0
  v_mfma_f32_16x16x32_bf16 v[240:243], v[112:115], v[70:73], 0
  v_mfma_f32_16x16x16_bf16 v[212:215], v[116:117], v[66:67], 0
  v_mfma_f32_16x16x32_bf16 v[244:247], v[116:119], v[70:73], 0
  v_mfma_f32_16x16x16_bf16 v[216:219], v[120:121], v[66:67], 0
  v_mfma_f32_16x16x32_bf16 v[248:251], v[120:123], v[70:73], 0
  v_mfma_f32_16x16x16_bf16 v[220:223], v[124:125], v[66:67], 0
  v_mfma_f32_16x16x32_bf16 v[252:255], v[124:127], v[70:73], 0
  v_rcp_f32 v24, v160
  v_rcp_f32 v26, v164
  v_mfma_f32_16x16x16_bf16 v[192:195], v[144:145], v[64:65], v[192:195]
  v_mfma_f32_16x16x16_bf16 v[224:227], v[144:145], v[68:69], v[224:227]
  v_mfma_f32_16x16x16_bf16 v[196:199], v[146:147], v[64:65], v[196:199]
  v_mfma_f32_16x16x16_bf16 v[228:231], v[146:147], v[68:69], v[228:231]
  v_mfma_f32_16x16x16_bf16 v[200:203], v[148:149], v[64:65], v[200:203]
  v_mfma_f32_16x16x16_bf16 v[232:235], v[148:149], v[68:69], v[232:235]
  v_mfma_f32_16x16x16_bf16 v[204:207], v[150:151], v[64:65], v[204:207]
  v_mfma_f32_16x16x16_bf16 v[236:239], v[150:151], v[68:69], v[236:239]
  v_mfma_f32_16x16x16_bf16 v[208:211], v[152:153], v[64:65], v[208:211]
  v_mfma_f32_16x16x16_bf16 v[240:243], v[152:153], v[68:69], v[240:243]
  v_mfma_f32_16x16x16_bf16 v[212:215], v[154:155], v[64:65], v[212:215]
  v_mfma_f32_16x16x16_bf16 v[244:247], v[154:155], v[68:69], v[244:247]
  v_mfma_f32_16x16x16_bf16 v[216:219], v[156:157], v[64:65], v[216:219]
  v_mfma_f32_16x16x16_bf16 v[248:251], v[156:157], v[68:69], v[248:251]
  v_mfma_f32_16x16x16_bf16 v[220:223], v[158:159], v[64:65], v[220:223]
  v_mfma_f32_16x16x16_bf16 v[252:255], v[158:159], v[68:69], v[252:255]
  s_add_u32 s38, s37, 4096
  v_mul_f32 v192, v24, v192
  v_mul_f32 v193, v24, v193
  v_mul_f32 v194, v24, v194
  v_mul_f32 v195, v24, v195
  v_cvt_pk_bf16_f32 v32, v192, v193
  v_cvt_pk_bf16_f32 v33, v194, v195
  v_mul_f32 v196, v24, v196
  v_mul_f32 v197, v24, v197
  v_mul_f32 v198, v24, v198
  v_mul_f32 v199, v24, v199
  v_cvt_pk_bf16_f32 v34, v196, v197
  v_cvt_pk_bf16_f32 v35, v198, v199
  buffer_store_dwordx4 v[32:35], v3, s[4:7], s37 offen offset:0 sc1
  v_mul_f32 v224, v26, v224
  v_mul_f32 v225, v26, v225
  v_mul_f32 v226, v26, v226
  v_mul_f32 v227, v26, v227
  v_cvt_pk_bf16_f32 v36, v224, v225
  v_cvt_pk_bf16_f32 v37, v226, v227
  v_mul_f32 v228, v26, v228
  v_mul_f32 v229, v26, v229
  v_mul_f32 v230, v26, v230
  v_mul_f32 v231, v26, v231
  v_cvt_pk_bf16_f32 v38, v228, v229
  v_cvt_pk_bf16_f32 v39, v230, v231
  buffer_store_dwordx4 v[36:39], v3, s[4:7], s37 offen offset:1024 sc1
  v_mul_f32 v200, v24, v200
  v_mul_f32 v201, v24, v201
  v_mul_f32 v202, v24, v202
  v_mul_f32 v203, v24, v203
  v_cvt_pk_bf16_f32 v40, v200, v201
  v_cvt_pk_bf16_f32 v41, v202, v203
  v_mul_f32 v204, v24, v204
  v_mul_f32 v205, v24, v205
  v_mul_f32 v206, v24, v206
  v_mul_f32 v207, v24, v207
  v_cvt_pk_bf16_f32 v42, v204, v205
  v_cvt_pk_bf16_f32 v43, v206, v207
  buffer_store_dwordx4 v[40:43], v3, s[4:7], s37 offen offset:2048 sc1
  v_mul_f32 v232, v26, v232
  v_mul_f32 v233, v26, v233
  v_mul_f32 v234, v26, v234
  v_mul_f32 v235, v26, v235
  v_cvt_pk_bf16_f32 v44, v232, v233
  v_cvt_pk_bf16_f32 v45, v234, v235
  v_mul_f32 v236, v26, v236
  v_mul_f32 v237, v26, v237
  v_mul_f32 v238, v26, v238
  v_mul_f32 v239, v26, v239
  v_cvt_pk_bf16_f32 v46, v236, v237
  v_cvt_pk_bf16_f32 v47, v238, v239
  buffer_store_dwordx4 v[44:47], v3, s[4:7], s37 offen offset:3072 sc1
  v_mul_f32 v208, v24, v208
  v_mul_f32 v209, v24, v209
  v_mul_f32 v210, v24, v210
  v_mul_f32 v211, v24, v211
  v_cvt_pk_bf16_f32 v48, v208, v209
  v_cvt_pk_bf16_f32 v49, v210, v211
  v_mul_f32 v212, v24, v212
  v_mul_f32 v213, v24, v213
  v_mul_f32 v214, v24, v214
  v_mul_f32 v215, v24, v215
  v_cvt_pk_bf16_f32 v50, v212, v213
  v_cvt_pk_bf16_f32 v51, v214, v215
  buffer_store_dwordx4 v[48:51], v3, s[4:7], s38 offen offset:0 sc1
  v_mul_f32 v240, v26, v240
  v_mul_f32 v241, v26, v241
  v_mul_f32 v242, v26, v242
  v_mul_f32 v243, v26, v243
  v_cvt_pk_bf16_f32 v52, v240, v241
  v_cvt_pk_bf16_f32 v53, v242, v243
  v_mul_f32 v244, v26, v244
  v_mul_f32 v245, v26, v245
  v_mul_f32 v246, v26, v246
  v_mul_f32 v247, v26, v247
  v_cvt_pk_bf16_f32 v54, v244, v245
  v_cvt_pk_bf16_f32 v55, v246, v247
  buffer_store_dwordx4 v[52:55], v3, s[4:7], s38 offen offset:1024 sc1
  v_mul_f32 v216, v24, v216
  v_mul_f32 v217, v24, v217
  v_mul_f32 v218, v24, v218
  v_mul_f32 v219, v24, v219
  v_cvt_pk_bf16_f32 v56, v216, v217
  v_cvt_pk_bf16_f32 v57, v218, v219
  v_mul_f32 v220, v24, v220
  v_mul_f32 v221, v24, v221
  v_mul_f32 v222, v24, v222
  v_mul_f32 v223, v24, v223
  v_cvt_pk_bf16_f32 v58, v220, v221
  v_cvt_pk_bf16_f32 v59, v222, v223
  buffer_store_dwordx4 v[56:59], v3, s[4:7], s38 offen offset:2048 sc1
  v_mul_f32 v248, v26, v248
  v_mul_f32 v249, v26, v249
  v_mul_f32 v250, v26, v250
  v_mul_f32 v251, v26, v251
  v_cvt_pk_bf16_f32 v60, v248, v249
  v_cvt_pk_bf16_f32 v61, v250, v251
  v_mul_f32 v252, v26, v252
  v_mul_f32 v253, v26, v253
  v_mul_f32 v254, v26, v254
  v_mul_f32 v255, v26, v255
  v_cvt_pk_bf16_f32 v62, v252, v253
  v_cvt_pk_bf16_f32 v63, v254, v255
  buffer_store_dwordx4 v[60:63], v3, s[4:7], s38 offen offset:3072 sc1
  v_mov_b32 v24, s44
  s_waitcnt vmcnt(0)
  buffer_store_dword v24, off, s[4:7], s36 sc1
  s_add_u32 s42, s42, 2
  s_cmp_lt_u32 s42, 64
  s_cbranch_scc1 L_att_loop
  s_branch L_end
L_g3a:
  v_lshrrev_b32 v1, 6, v0
  s_nop 0
  v_readfirstlane_b32 s29, v1
  s_mul_i32 s48, s28, 20
  s_add_u32 s48, s48, s30
  s_load_dwordx2 s[24:25], s[0:1], 104
  s_mov_b32 s26, 256
  s_mov_b32 s27, 0x20000
  v_lshlrev_b32 v2, 4, v0
  s_mov_b32 s22, 4290772927
  v_mov_b32 v32, s22
  v_mov_b32 v33, s22
  v_mov_b32 v34, s22
  v_mov_b32 v35, s22
  s_mov_b32 s49, s48
L_h_f1:
  s_lshl_b32 s21, s49, 12
  s_add_u32 s21, s21, 8388608
  s_cmp_ge_u32 s49, 352
  s_cselect_b32 s23, 655360, 0
  s_add_u32 s21, s21, s23
  buffer_store_dwordx4 v[32:35], v2, s[4:7], s21 offen sc1
  s_add_u32 s49, s49, 40
  s_cmp_lt_u32 s49, 672
  s_cbranch_scc1 L_h_f1
  s_cmp_ge_u32 s48, 32
  s_cbranch_scc1 L_h_f2
  s_lshr_b32 s21, s48, 4
  s_lshl_b32 s21, s21, 22
  s_and_b32 s23, s48, 15
  s_lshl_b32 s23, s23, 12
  s_add_u32 s21, s21, s23
  s_add_u32 s21, s21, 65536
  buffer_store_dwordx4 v[32:35], v2, s[4:7], s21 offen sc1
L_h_f2:
  v_mov_b32 v36, 0
  v_mov_b32 v37, 0
  v_mov_b32 v38, 0
  v_mov_b32 v39, 0
  s_sub_u32 s21, s48, 8
  s_cmp_ge_u32 s21, 8
  s_cbranch_scc1 L_h_nf
  s_lshl_b32 s21, s21, 12
  s_add_u32 s21, s21, 100663296
  buffer_store_dwordx4 v[36:39], v2, s[4:7], s21 offen sc1
L_h_nf:
L_h_nc:
  s_waitcnt vmcnt(0) lgkmcnt(0)
  s_barrier
  s_cmp_lg_u32 s29, 0
  s_cbranch_scc1 L_h_fd
  v_mov_b32 v5, 1
  s_mov_b64 exec, 1
  buffer_atomic_add v5, off, s[24:27], 0 sc0
  s_waitcnt vmcnt(0)
  v_readfirstlane_b32 s21, v5
  s_cmp_lg_u32 s21, 47
  s_cbranch_scc1 L_h_nd1
  buffer_atomic_swap v5, off, s[24:27], 0 offset:128
L_h_nd1:
  s_mov_b64 exec, -1
  s_branch L_h_fd
L_h_fd:
  s_load_dwordx4 s[60:63], s[0:1], 16
  s_load_dwordx4 s[64:67], s[0:1], 32
  s_lshr_b32 s33, s2, 3
  s_sub_u32 s33, s33, 8
  s_lshl_b32 s33, s33, 8
  v_add_u32 v40, s33, v0
  v_lshrrev_b32 v41, 4, v40
  v_add_u32 v41, 256, v41
  v_lshlrev_b32 v41, 13, v41
  v_bfe_u32 v42, v0, 1, 3
  v_lshl_add_u32 v41, v42, 10, v41
  v_and_b32 v42, 1, v0
  v_lshl_add_u32 v41, v42, 7, v41
  s_and_b32 s34, s2, 3
  s_lshl_b32 s33, s34, 8
  v_add_u32 v41, s33, v41
  s_waitcnt lgkmcnt(0)
  global_load_dword v255, v41, s[62:63]
  global_load_dword v255, v41, s[64:65]
  v_and_b32 v2, 63, v0
  v_lshlrev_b32 v3, 4, v2
  s_load_dwordx2 s[8:9], s[0:1], 40
  s_load_dwordx2 s[16:17], s[0:1], 96
  s_mov_b32 s10, 5242880
  s_mov_b32 s11, 0x20000
  s_mov_b32 s18, 2621440
  s_mov_b32 s19, 0x20000
  v_lshrrev_b32 v4, 2, v2
  v_mul_u32_u24 v4, 1280, v4
  v_and_b32 v5, 3, v2
  v_lshl_add_u32 v4, v5, 4, v4
  s_lshl_b32 s38, s30, 6
  v_add_u32 v4, s38, v4
  v_mov_b32 v8, v4
  s_cmp_ge_u32 s30, 10
  s_cselect_b32 s38, 10, 0
  s_sub_u32 s38, s30, s38
  s_mul_i32 s38, s38, 13
  s_lshr_b32 s38, s38, 2
  s_andn2_b32 s38, s38, 1
  s_lshl_b32 s31, s29, 5
  s_add_u32 s31, s31, s38
  s_lshl_b32 s32, s31, 5
  s_mul_i32 s45, s29, 40960
  v_lshrrev_b32 v6, 2, v2
  v_lshlrev_b32 v6, 6, v6
  v_lshl_add_u32 v6, v5, 4, v6
  v_add_u32 v10, s45, v6
  v_lshrrev_b32 v7, 4, v2
  s_waitcnt lgkmcnt(0)
  s_load_dwordx2 s[20:21], s[0:1], 104
  s_mov_b32 s22, 256
  s_mov_b32 s23, 0x20000
  s_mov_b32 s38, 0
  s_waitcnt lgkmcnt(0)
L_g3a_wi:
  buffer_load_dword v1, off, s[20:23], 0 offset:128 sc1
  s_waitcnt vmcnt(0)
  v_cmp_eq_u32 vcc, 0, v1
  s_cbranch_vccz L_g3a_wd
  s_sleep 8
  s_add_u32 s38, s38, 1
  s_cmp_lt_u32 s38, 0x100000
  s_cbranch_scc1 L_g3a_wi
  s_branch L_end
L_g3a_wd:
  s_and_b32 s22, s2, 31
  s_add_u32 s22, s22, 64
  s_lshl_b32 s22, s22, 7
  s_add_u32 s22, s22, 100663296
  s_mov_b32 s38, 0
L_g3a_ki:
  buffer_load_dword v1, off, s[4:7], s22 sc1
  s_waitcnt vmcnt(0)
  v_cmp_gt_u32 vcc, 4, v1
  s_cbranch_vccz L_g3a_kd
  s_sleep 16
  s_add_u32 s38, s38, 1
  s_cmp_lt_u32 s38, 0x100000
  s_cbranch_scc1 L_g3a_ki
  s_branch L_end
L_g3a_kd:
  s_add_u32 m0, s45, 0
  s_mul_i32 s38, s32, 1280
  s_add_u32 s32, s32, 16
  s_and_b32 s32, s32, 4095
  buffer_load_dwordx4 v8, s[8:11], s38 offen lds
  s_add_u32 m0, s45, 1024
  s_mul_i32 s38, s32, 1280
  s_add_u32 s32, s32, 16
  s_and_b32 s32, s32, 4095
  buffer_load_dwordx4 v8, s[8:11], s38 offen lds
  s_add_u32 m0, s45, 2048
  s_mul_i32 s38, s32, 1280
  s_add_u32 s32, s32, 16
  s_and_b32 s32, s32, 4095
  buffer_load_dwordx4 v8, s[8:11], s38 offen lds
  s_add_u32 m0, s45, 3072
  s_mul_i32 s38, s32, 1280
  s_add_u32 s32, s32, 16
  s_and_b32 s32, s32, 4095
  buffer_load_dwordx4 v8, s[8:11], s38 offen lds
  s_add_u32 m0, s45, 4096
  s_mul_i32 s38, s32, 1280
  s_add_u32 s32, s32, 16
  s_and_b32 s32, s32, 4095
  buffer_load_dwordx4 v8, s[8:11], s38 offen lds
  s_add_u32 m0, s45, 5120
  s_mul_i32 s38, s32, 1280
  s_add_u32 s32, s32, 16
  s_and_b32 s32, s32, 4095
  buffer_load_dwordx4 v8, s[8:11], s38 offen lds
  s_add_u32 m0, s45, 6144
  s_mul_i32 s38, s32, 1280
  s_add_u32 s32, s32, 16
  s_and_b32 s32, s32, 4095
  buffer_load_dwordx4 v8, s[8:11], s38 offen lds
  s_add_u32 m0, s45, 7168
  s_mul_i32 s38, s32, 1280
  s_add_u32 s32, s32, 16
  s_and_b32 s32, s32, 4095
  buffer_load_dwordx4 v8, s[8:11], s38 offen lds
  s_add_u32 m0, s45, 8192
  s_mul_i32 s38, s32, 1280
  s_add_u32 s32, s32, 16
  s_and_b32 s32, s32, 4095
  buffer_load_dwordx4 v8, s[8:11], s38 offen lds
  s_add_u32 m0, s45, 9216
  s_mul_i32 s38, s32, 1280
  s_add_u32 s32, s32, 16
  s_and_b32 s32, s32, 4095
  buffer_load_dwordx4 v8, s[8:11], s38 offen lds
  s_add_u32 m0, s45, 10240
  s_mul_i32 s38, s32, 1280
  s_add_u32 s32, s32, 16
  s_and_b32 s32, s32, 4095
  buffer_load_dwordx4 v8, s[8:11], s38 offen lds
  s_add_u32 m0, s45, 11264
  s_mul_i32 s38, s32, 1280
  s_add_u32 s32, s32, 16
  s_and_b32 s32, s32, 4095
  buffer_load_dwordx4 v8, s[8:11], s38 offen lds
  s_add_u32 m0, s45, 12288
  s_mul_i32 s38, s32, 1280
  s_add_u32 s32, s32, 16
  s_and_b32 s32, s32, 4095
  buffer_load_dwordx4 v8, s[8:11], s38 offen lds
  s_add_u32 m0, s45, 13312
  s_mul_i32 s38, s32, 1280
  s_add_u32 s32, s32, 16
  s_and_b32 s32, s32, 4095
  buffer_load_dwordx4 v8, s[8:11], s38 offen lds
  s_add_u32 m0, s45, 14336
  s_mul_i32 s38, s32, 1280
  s_add_u32 s32, s32, 16
  s_and_b32 s32, s32, 4095
  buffer_load_dwordx4 v8, s[8:11], s38 offen lds
  s_add_u32 m0, s45, 15360
  s_mul_i32 s38, s32, 1280
  s_add_u32 s32, s32, 16
  s_and_b32 s32, s32, 4095
  buffer_load_dwordx4 v8, s[8:11], s38 offen lds
  s_add_u32 m0, s45, 16384
  s_mul_i32 s38, s32, 1280
  s_add_u32 s32, s32, 16
  s_and_b32 s32, s32, 4095
  buffer_load_dwordx4 v8, s[8:11], s38 offen lds
  s_add_u32 m0, s45, 17408
  s_mul_i32 s38, s32, 1280
  s_add_u32 s32, s32, 16
  s_and_b32 s32, s32, 4095
  buffer_load_dwordx4 v8, s[8:11], s38 offen lds
  s_add_u32 m0, s45, 18432
  s_mul_i32 s38, s32, 1280
  s_add_u32 s32, s32, 16
  s_and_b32 s32, s32, 4095
  buffer_load_dwordx4 v8, s[8:11], s38 offen lds
  s_add_u32 m0, s45, 19456
  s_mul_i32 s38, s32, 1280
  s_add_u32 s32, s32, 16
  s_and_b32 s32, s32, 4095
  buffer_load_dwordx4 v8, s[8:11], s38 offen lds
  s_add_u32 m0, s45, 20480
  s_mul_i32 s38, s32, 1280
  s_add_u32 s32, s32, 16
  s_and_b32 s32, s32, 4095
  buffer_load_dwordx4 v8, s[8:11], s38 offen lds
  s_add_u32 m0, s45, 21504
  s_mul_i32 s38, s32, 1280
  s_add_u32 s32, s32, 16
  s_and_b32 s32, s32, 4095
  buffer_load_dwordx4 v8, s[8:11], s38 offen lds
  s_add_u32 m0, s45, 22528
  s_mul_i32 s38, s32, 1280
  s_add_u32 s32, s32, 16
  s_and_b32 s32, s32, 4095
  buffer_load_dwordx4 v8, s[8:11], s38 offen lds
  s_add_u32 m0, s45, 23552
  s_mul_i32 s38, s32, 1280
  s_add_u32 s32, s32, 16
  s_and_b32 s32, s32, 4095
  buffer_load_dwordx4 v8, s[8:11], s38 offen lds
  s_add_u32 m0, s45, 24576
  s_mul_i32 s38, s32, 1280
  s_add_u32 s32, s32, 16
  s_and_b32 s32, s32, 4095
  buffer_load_dwordx4 v8, s[8:11], s38 offen lds
  s_add_u32 m0, s45, 25600
  s_mul_i32 s38, s32, 1280
  s_add_u32 s32, s32, 16
  s_and_b32 s32, s32, 4095
  buffer_load_dwordx4 v8, s[8:11], s38 offen lds
  s_add_u32 m0, s45, 26624
  s_mul_i32 s38, s32, 1280
  s_add_u32 s32, s32, 16
  s_and_b32 s32, s32, 4095
  buffer_load_dwordx4 v8, s[8:11], s38 offen lds
  s_add_u32 m0, s45, 27648
  s_mul_i32 s38, s32, 1280
  s_add_u32 s32, s32, 16
  s_and_b32 s32, s32, 4095
  buffer_load_dwordx4 v8, s[8:11], s38 offen lds
  s_add_u32 m0, s45, 28672
  s_mul_i32 s38, s32, 1280
  s_add_u32 s32, s32, 16
  s_and_b32 s32, s32, 4095
  buffer_load_dwordx4 v8, s[8:11], s38 offen lds
  s_add_u32 m0, s45, 29696
  s_mul_i32 s38, s32, 1280
  s_add_u32 s32, s32, 16
  s_and_b32 s32, s32, 4095
  buffer_load_dwordx4 v8, s[8:11], s38 offen lds
  s_add_u32 m0, s45, 30720
  s_mul_i32 s38, s32, 1280
  s_add_u32 s32, s32, 16
  s_and_b32 s32, s32, 4095
  buffer_load_dwordx4 v8, s[8:11], s38 offen lds
  s_add_u32 m0, s45, 31744
  s_mul_i32 s38, s32, 1280
  s_add_u32 s32, s32, 16
  s_and_b32 s32, s32, 4095
  buffer_load_dwordx4 v8, s[8:11], s38 offen lds
  s_waitcnt vmcnt(16)
  ds_read_b64_tr_b16 a[0:1], v10 offset:0
  ds_read_b64_tr_b16 a[2:3], v10 offset:1024
  ds_read_b64_tr_b16 a[4:5], v10 offset:8
  ds_read_b64_tr_b16 a[6:7], v10 offset:1032
  ds_read_b64_tr_b16 a[8:9], v10 offset:2048
  ds_read_b64_tr_b16 a[10:11], v10 offset:3072
  ds_read_b64_tr_b16 a[12:13], v10 offset:2056
  ds_read_b64_tr_b16 a[14:15], v10 offset:3080
  s_waitcnt lgkmcnt(0)
  ds_read_b64_tr_b16 a[16:17], v10 offset:4096
  ds_read_b64_tr_b16 a[18:19], v10 offset:5120
  ds_read_b64_tr_b16 a[20:21], v10 offset:4104
  ds_read_b64_tr_b16 a[22:23], v10 offset:5128
  ds_read_b64_tr_b16 a[24:25], v10 offset:6144
  ds_read_b64_tr_b16 a[26:27], v10 offset:7168
  ds_read_b64_tr_b16 a[28:29], v10 offset:6152
  ds_read_b64_tr_b16 a[30:31], v10 offset:7176
  s_waitcnt lgkmcnt(0)
  ds_read_b64_tr_b16 a[32:33], v10 offset:8192
  ds_read_b64_tr_b16 a[34:35], v10 offset:9216
  ds_read_b64_tr_b16 a[36:37], v10 offset:8200
  ds_read_b64_tr_b16 a[38:39], v10 offset:9224
  ds_read_b64_tr_b16 a[40:41], v10 offset:10240
  ds_read_b64_tr_b16 a[42:43], v10 offset:11264
  ds_read_b64_tr_b16 a[44:45], v10 offset:10248
  ds_read_b64_tr_b16 a[46:47], v10 offset:11272
  s_waitcnt lgkmcnt(0)
  ds_read_b64_tr_b16 a[48:49], v10 offset:12288
  ds_read_b64_tr_b16 a[50:51], v10 offset:13312
  ds_read_b64_tr_b16 a[52:53], v10 offset:12296
  ds_read_b64_tr_b16 a[54:55], v10 offset:13320
  ds_read_b64_tr_b16 a[56:57], v10 offset:14336
  ds_read_b64_tr_b16 a[58:59], v10 offset:15360
  ds_read_b64_tr_b16 a[60:61], v10 offset:14344
  ds_read_b64_tr_b16 a[62:63], v10 offset:15368
  s_waitcnt lgkmcnt(0)
  s_add_u32 m0, s45, 0
  s_mul_i32 s38, s32, 1280
  s_add_u32 s32, s32, 16
  s_and_b32 s32, s32, 4095
  buffer_load_dwordx4 v8, s[8:11], s38 offen lds
  s_add_u32 m0, s45, 1024
  s_mul_i32 s38, s32, 1280
  s_add_u32 s32, s32, 16
  s_and_b32 s32, s32, 4095
  buffer_load_dwordx4 v8, s[8:11], s38 offen lds
  s_add_u32 m0, s45, 2048
  s_mul_i32 s38, s32, 1280
  s_add_u32 s32, s32, 16
  s_and_b32 s32, s32, 4095
  buffer_load_dwordx4 v8, s[8:11], s38 offen lds
  s_add_u32 m0, s45, 3072
  s_mul_i32 s38, s32, 1280
  s_add_u32 s32, s32, 16
  s_and_b32 s32, s32, 4095
  buffer_load_dwordx4 v8, s[8:11], s38 offen lds
  s_add_u32 m0, s45, 4096
  s_mul_i32 s38, s32, 1280
  s_add_u32 s32, s32, 16
  s_and_b32 s32, s32, 4095
  buffer_load_dwordx4 v8, s[8:11], s38 offen lds
  s_add_u32 m0, s45, 5120
  s_mul_i32 s38, s32, 1280
  s_add_u32 s32, s32, 16
  s_and_b32 s32, s32, 4095
  buffer_load_dwordx4 v8, s[8:11], s38 offen lds
  s_add_u32 m0, s45, 6144
  s_mul_i32 s38, s32, 1280
  s_add_u32 s32, s32, 16
  s_and_b32 s32, s32, 4095
  buffer_load_dwordx4 v8, s[8:11], s38 offen lds
  s_add_u32 m0, s45, 7168
  s_mul_i32 s38, s32, 1280
  s_add_u32 s32, s32, 16
  s_and_b32 s32, s32, 4095
  buffer_load_dwordx4 v8, s[8:11], s38 offen lds
  s_add_u32 m0, s45, 8192
  s_mul_i32 s38, s32, 1280
  s_add_u32 s32, s32, 16
  s_and_b32 s32, s32, 4095
  buffer_load_dwordx4 v8, s[8:11], s38 offen lds
  s_add_u32 m0, s45, 9216
  s_mul_i32 s38, s32, 1280
  s_add_u32 s32, s32, 16
  s_and_b32 s32, s32, 4095
  buffer_load_dwordx4 v8, s[8:11], s38 offen lds
  s_add_u32 m0, s45, 10240
  s_mul_i32 s38, s32, 1280
  s_add_u32 s32, s32, 16
  s_and_b32 s32, s32, 4095
  buffer_load_dwordx4 v8, s[8:11], s38 offen lds
  s_add_u32 m0, s45, 11264
  s_mul_i32 s38, s32, 1280
  s_add_u32 s32, s32, 16
  s_and_b32 s32, s32, 4095
  buffer_load_dwordx4 v8, s[8:11], s38 offen lds
  s_add_u32 m0, s45, 12288
  s_mul_i32 s38, s32, 1280
  s_add_u32 s32, s32, 16
  s_and_b32 s32, s32, 4095
  buffer_load_dwordx4 v8, s[8:11], s38 offen lds
  s_add_u32 m0, s45, 13312
  s_mul_i32 s38, s32, 1280
  s_add_u32 s32, s32, 16
  s_and_b32 s32, s32, 4095
  buffer_load_dwordx4 v8, s[8:11], s38 offen lds
  s_add_u32 m0, s45, 14336
  s_mul_i32 s38, s32, 1280
  s_add_u32 s32, s32, 16
  s_and_b32 s32, s32, 4095
  buffer_load_dwordx4 v8, s[8:11], s38 offen lds
  s_add_u32 m0, s45, 15360
  s_mul_i32 s38, s32, 1280
  s_add_u32 s32, s32, 16
  s_and_b32 s32, s32, 4095
  buffer_load_dwordx4 v8, s[8:11], s38 offen lds
  s_waitcnt vmcnt(16)
  ds_read_b64_tr_b16 a[64:65], v10 offset:16384
  ds_read_b64_tr_b16 a[66:67], v10 offset:17408
  ds_read_b64_tr_b16 a[68:69], v10 offset:16392
  ds_read_b64_tr_b16 a[70:71], v10 offset:17416
  ds_read_b64_tr_b16 a[72:73], v10 offset:18432
  ds_read_b64_tr_b16 a[74:75], v10 offset:19456
  ds_read_b64_tr_b16 a[76:77], v10 offset:18440
  ds_read_b64_tr_b16 a[78:79], v10 offset:19464
  s_waitcnt lgkmcnt(0)
  ds_read_b64_tr_b16 a[80:81], v10 offset:20480
  ds_read_b64_tr_b16 a[82:83], v10 offset:21504
  ds_read_b64_tr_b16 a[84:85], v10 offset:20488
  ds_read_b64_tr_b16 a[86:87], v10 offset:21512
  ds_read_b64_tr_b16 a[88:89], v10 offset:22528
  ds_read_b64_tr_b16 a[90:91], v10 offset:23552
  ds_read_b64_tr_b16 a[92:93], v10 offset:22536
  ds_read_b64_tr_b16 a[94:95], v10 offset:23560
  s_waitcnt lgkmcnt(0)
  ds_read_b64_tr_b16 a[96:97], v10 offset:24576
  ds_read_b64_tr_b16 a[98:99], v10 offset:25600
  ds_read_b64_tr_b16 a[100:101], v10 offset:24584
  ds_read_b64_tr_b16 a[102:103], v10 offset:25608
  ds_read_b64_tr_b16 a[104:105], v10 offset:26624
  ds_read_b64_tr_b16 a[106:107], v10 offset:27648
  ds_read_b64_tr_b16 a[108:109], v10 offset:26632
  ds_read_b64_tr_b16 a[110:111], v10 offset:27656
  s_waitcnt lgkmcnt(0)
  ds_read_b64_tr_b16 a[112:113], v10 offset:28672
  ds_read_b64_tr_b16 a[114:115], v10 offset:29696
  ds_read_b64_tr_b16 a[116:117], v10 offset:28680
  ds_read_b64_tr_b16 a[118:119], v10 offset:29704
  ds_read_b64_tr_b16 a[120:121], v10 offset:30720
  ds_read_b64_tr_b16 a[122:123], v10 offset:31744
  ds_read_b64_tr_b16 a[124:125], v10 offset:30728
  ds_read_b64_tr_b16 a[126:127], v10 offset:31752
  s_waitcnt lgkmcnt(0)
  s_add_u32 m0, s45, 16384
  s_mul_i32 s38, s32, 1280
  s_add_u32 s32, s32, 16
  s_and_b32 s32, s32, 4095
  buffer_load_dwordx4 v8, s[8:11], s38 offen lds
  s_add_u32 m0, s45, 17408
  s_mul_i32 s38, s32, 1280
  s_add_u32 s32, s32, 16
  s_and_b32 s32, s32, 4095
  buffer_load_dwordx4 v8, s[8:11], s38 offen lds
  s_add_u32 m0, s45, 18432
  s_mul_i32 s38, s32, 1280
  s_add_u32 s32, s32, 16
  s_and_b32 s32, s32, 4095
  buffer_load_dwordx4 v8, s[8:11], s38 offen lds
  s_add_u32 m0, s45, 19456
  s_mul_i32 s38, s32, 1280
  s_add_u32 s32, s32, 16
  s_and_b32 s32, s32, 4095
  buffer_load_dwordx4 v8, s[8:11], s38 offen lds
  s_add_u32 m0, s45, 20480
  s_mul_i32 s38, s32, 1280
  s_add_u32 s32, s32, 16
  s_and_b32 s32, s32, 4095
  buffer_load_dwordx4 v8, s[8:11], s38 offen lds
  s_add_u32 m0, s45, 21504
  s_mul_i32 s38, s32, 1280
  s_add_u32 s32, s32, 16
  s_and_b32 s32, s32, 4095
  buffer_load_dwordx4 v8, s[8:11], s38 offen lds
  s_add_u32 m0, s45, 22528
  s_mul_i32 s38, s32, 1280
  s_add_u32 s32, s32, 16
  s_and_b32 s32, s32, 4095
  buffer_load_dwordx4 v8, s[8:11], s38 offen lds
  s_add_u32 m0, s45, 23552
  s_mul_i32 s38, s32, 1280
  s_add_u32 s32, s32, 16
  s_and_b32 s32, s32, 4095
  buffer_load_dwordx4 v8, s[8:11], s38 offen lds
  s_add_u32 m0, s45, 24576
  s_mul_i32 s38, s32, 1280
  s_add_u32 s32, s32, 16
  s_and_b32 s32, s32, 4095
  buffer_load_dwordx4 v8, s[8:11], s38 offen lds
  s_add_u32 m0, s45, 25600
  s_mul_i32 s38, s32, 1280
  s_add_u32 s32, s32, 16
  s_and_b32 s32, s32, 4095
  buffer_load_dwordx4 v8, s[8:11], s38 offen lds
  s_add_u32 m0, s45, 26624
  s_mul_i32 s38, s32, 1280
  s_add_u32 s32, s32, 16
  s_and_b32 s32, s32, 4095
  buffer_load_dwordx4 v8, s[8:11], s38 offen lds
  s_add_u32 m0, s45, 27648
  s_mul_i32 s38, s32, 1280
  s_add_u32 s32, s32, 16
  s_and_b32 s32, s32, 4095
  buffer_load_dwordx4 v8, s[8:11], s38 offen lds
  s_add_u32 m0, s45, 28672
  s_mul_i32 s38, s32, 1280
  s_add_u32 s32, s32, 16
  s_and_b32 s32, s32, 4095
  buffer_load_dwordx4 v8, s[8:11], s38 offen lds
  s_add_u32 m0, s45, 29696
  s_mul_i32 s38, s32, 1280
  s_add_u32 s32, s32, 16
  s_and_b32 s32, s32, 4095
  buffer_load_dwordx4 v8, s[8:11], s38 offen lds
  s_add_u32 m0, s45, 30720
  s_mul_i32 s38, s32, 1280
  s_add_u32 s32, s32, 16
  s_and_b32 s32, s32, 4095
  buffer_load_dwordx4 v8, s[8:11], s38 offen lds
  s_add_u32 m0, s45, 31744
  s_mul_i32 s38, s32, 1280
  s_add_u32 s32, s32, 16
  s_and_b32 s32, s32, 4095
  buffer_load_dwordx4 v8, s[8:11], s38 offen lds
  s_waitcnt vmcnt(16)
  ds_read_b64_tr_b16 a[128:129], v10 offset:0
  ds_read_b64_tr_b16 a[130:131], v10 offset:1024
  ds_read_b64_tr_b16 a[132:133], v10 offset:8
  ds_read_b64_tr_b16 a[134:135], v10 offset:1032
  ds_read_b64_tr_b16 a[136:137], v10 offset:2048
  ds_read_b64_tr_b16 a[138:139], v10 offset:3072
  ds_read_b64_tr_b16 a[140:141], v10 offset:2056
  ds_read_b64_tr_b16 a[142:143], v10 offset:3080
  s_waitcnt lgkmcnt(0)
  ds_read_b64_tr_b16 a[144:145], v10 offset:4096
  ds_read_b64_tr_b16 a[146:147], v10 offset:5120
  ds_read_b64_tr_b16 a[148:149], v10 offset:4104
  ds_read_b64_tr_b16 a[150:151], v10 offset:5128
  ds_read_b64_tr_b16 a[152:153], v10 offset:6144
  ds_read_b64_tr_b16 a[154:155], v10 offset:7168
  ds_read_b64_tr_b16 a[156:157], v10 offset:6152
  ds_read_b64_tr_b16 a[158:159], v10 offset:7176
  s_waitcnt lgkmcnt(0)
  ds_read_b64_tr_b16 a[160:161], v10 offset:8192
  ds_read_b64_tr_b16 a[162:163], v10 offset:9216
  ds_read_b64_tr_b16 a[164:165], v10 offset:8200
  ds_read_b64_tr_b16 a[166:167], v10 offset:9224
  ds_read_b64_tr_b16 a[168:169], v10 offset:10240
  ds_read_b64_tr_b16 a[170:171], v10 offset:11264
  ds_read_b64_tr_b16 a[172:173], v10 offset:10248
  ds_read_b64_tr_b16 a[174:175], v10 offset:11272
  s_waitcnt lgkmcnt(0)
  ds_read_b64_tr_b16 a[176:177], v10 offset:12288
  ds_read_b64_tr_b16 a[178:179], v10 offset:13312
  ds_read_b64_tr_b16 a[180:181], v10 offset:12296
  ds_read_b64_tr_b16 a[182:183], v10 offset:13320
  ds_read_b64_tr_b16 a[184:185], v10 offset:14336
  ds_read_b64_tr_b16 a[186:187], v10 offset:15360
  ds_read_b64_tr_b16 a[188:189], v10 offset:14344
  ds_read_b64_tr_b16 a[190:191], v10 offset:15368
  s_waitcnt lgkmcnt(0)
  s_waitcnt vmcnt(0)
  ds_read_b64_tr_b16 a[192:193], v10 offset:16384
  ds_read_b64_tr_b16 a[194:195], v10 offset:17408
  ds_read_b64_tr_b16 a[196:197], v10 offset:16392
  ds_read_b64_tr_b16 a[198:199], v10 offset:17416
  ds_read_b64_tr_b16 a[200:201], v10 offset:18432
  ds_read_b64_tr_b16 a[202:203], v10 offset:19456
  ds_read_b64_tr_b16 a[204:205], v10 offset:18440
  ds_read_b64_tr_b16 a[206:207], v10 offset:19464
  s_waitcnt lgkmcnt(0)
  ds_read_b64_tr_b16 a[208:209], v10 offset:20480
  ds_read_b64_tr_b16 a[210:211], v10 offset:21504
  ds_read_b64_tr_b16 a[212:213], v10 offset:20488
  ds_read_b64_tr_b16 a[214:215], v10 offset:21512
  ds_read_b64_tr_b16 a[216:217], v10 offset:22528
  ds_read_b64_tr_b16 a[218:219], v10 offset:23552
  ds_read_b64_tr_b16 a[220:221], v10 offset:22536
  ds_read_b64_tr_b16 a[222:223], v10 offset:23560
  s_waitcnt lgkmcnt(0)
  ds_read_b64_tr_b16 a[224:225], v10 offset:24576
  ds_read_b64_tr_b16 a[226:227], v10 offset:25600
  ds_read_b64_tr_b16 a[228:229], v10 offset:24584
  ds_read_b64_tr_b16 a[230:231], v10 offset:25608
  ds_read_b64_tr_b16 a[232:233], v10 offset:26624
  ds_read_b64_tr_b16 a[234:235], v10 offset:27648
  ds_read_b64_tr_b16 a[236:237], v10 offset:26632
  ds_read_b64_tr_b16 a[238:239], v10 offset:27656
  s_waitcnt lgkmcnt(0)
  ds_read_b64_tr_b16 a[240:241], v10 offset:28672
  ds_read_b64_tr_b16 a[242:243], v10 offset:29696
  ds_read_b64_tr_b16 a[244:245], v10 offset:28680
  ds_read_b64_tr_b16 a[246:247], v10 offset:29704
  ds_read_b64_tr_b16 a[248:249], v10 offset:30720
  ds_read_b64_tr_b16 a[250:251], v10 offset:31744
  ds_read_b64_tr_b16 a[252:253], v10 offset:30728
  ds_read_b64_tr_b16 a[254:255], v10 offset:31752
  s_waitcnt lgkmcnt(0)
  v_min_u32 v5, 8, v2
  s_lshr_b32 s38, s31, 2
  v_add_u32 v5, s38, v5
  v_and_b32 v5, 31, v5
  v_add_u32 v6, 128, v5
  s_lshr_b32 s39, s30, 1
  s_add_u32 s39, s39, 192
  v_mov_b32 v5, s39
  s_cmp_eq_u32 s29, s28
  s_cselect_b32 s38, 32, 64
  v_cmp_gt_u32 vcc, s38, v2
  s_nop 1
  v_cndmask_b32 v5, v5, v6, vcc
  v_lshlrev_b32 v5, 7, v5
  v_add_u32 v5, 100663296, v5
  v_mov_b32 v6, 0
  v_mov_b32 v4, 4096
  v_cndmask_b32 v4, v6, v4, vcc
  v_and_b32 v8, 15, v2
  s_and_b32 s38, s29, 1
  s_lshl_b32 s38, s38, 4
  v_add_u32 v8, s38, v8
  v_lshlrev_b32 v9, 2, v8
  s_lshl_b32 s38, s30, 2
  v_add_u32 v12, s38, v7
  s_lshr_b32 s38, s30, 1
  s_lshl_b32 s38, s38, 19
  s_and_b32 s39, s30, 1
  s_lshl_b32 s39, s39, 11
  s_add_u32 s38, s38, s39
  s_and_b32 s39, s29, 1
  s_lshl_b32 s39, s39, 12
  s_add_u32 s38, s38, s39
  v_and_b32 v15, 15, v2
  v_lshlrev_b32 v15, 4, v15
  v_lshl_add_u32 v15, v7, 9, v15
  v_add_u32 v15, s38, v15
  v_mul_u32_u24 v8, 1280, v8
  v_lshl_add_u32 v8, v12, 4, v8
  s_lshl_b32 s38, s29, 12
  v_add_u32 v10, s38, v3
  s_and_b32 s38, s29, 1
  s_lshl_b32 s38, s38, 11
  v_add_u32 v11, s38, v3
  s_mov_b32 s42, s28
  s_mov_b32 s50, 0
  s_mov_b32 s46, 0
  s_load_dwordx2 s[20:21], s[0:1], 104
  s_mov_b32 s22, 256
  s_mov_b32 s23, 0x20000
  s_mov_b32 s38, 0
  s_waitcnt lgkmcnt(0)
L_g3g_wi:
  buffer_load_dword v1, off, s[20:23], 0 offset:132 sc1
  s_waitcnt vmcnt(0)
  v_cmp_eq_u32 vcc, 0, v1
  s_cbranch_vccz L_g3g_wd
  s_sleep 8
  s_add_u32 s38, s38, 1
  s_cmp_lt_u32 s38, 0x100000
  s_cbranch_scc1 L_g3g_wi
  s_branch L_end
L_g3g_wd:
  s_barrier
  s_lshl_b32 s47, s28, 10
  s_add_u32 s47, s47, 83886080
  s_lshl_b32 s51, s28, 11
  s_mov_b32 s42, 0
L_g3a_cold:
  s_add_u32 s44, s42, 1
  s_and_b32 s38, s42, 1
  v_mad_u32_u24 v6, v4, s38, v5
L_g3b_p:
  buffer_load_dword v7, v6, s[4:7], 0 offen sc1
  s_waitcnt vmcnt(0)
  v_cmp_gt_u32 vcc, s44, v7
  s_cbranch_vccz L_g3b_ok
  s_sleep 8
  s_add_u32 s50, s50, 1
  s_cmp_lt_u32 s50, 0x200000
  s_cbranch_scc1 L_g3b_p
  s_branch L_end
L_g3b_ok:
  s_lshl_b32 s48, s42, 18
  s_add_u32 s48, s48, s47
  s_lshl_b32 s49, s31, 11
  s_add_u32 s34, s48, s49
  s_add_u32 s49, s49, 4096
  s_and_b32 s49, s49, 0x3ffff
  buffer_load_dwordx4 v[40:43], v3, s[4:7], s34 offen offset:0 sc1
  buffer_load_dwordx4 v[44:47], v3, s[4:7], s34 offen offset:2048 sc1
  s_add_u32 s34, s48, s49
  s_add_u32 s49, s49, 4096
  s_and_b32 s49, s49, 0x3ffff
  buffer_load_dwordx4 v[48:51], v3, s[4:7], s34 offen offset:0 sc1
  buffer_load_dwordx4 v[52:55], v3, s[4:7], s34 offen offset:2048 sc1
  s_add_u32 s34, s48, s49
  s_add_u32 s49, s49, 4096
  s_and_b32 s49, s49, 0x3ffff
  buffer_load_dwordx4 v[56:59], v3, s[4:7], s34 offen offset:0 sc1
  buffer_load_dwordx4 v[60:63], v3, s[4:7], s34 offen offset:2048 sc1
  s_add_u32 s34, s48, s49
  s_add_u32 s49, s49, 4096
  s_and_b32 s49, s49, 0x3ffff
  buffer_load_dwordx4 v[64:67], v3, s[4:7], s34 offen offset:0 sc1
  buffer_load_dwordx4 v[68:71], v3, s[4:7], s34 offen offset:2048 sc1
  s_add_u32 s34, s48, s49
  s_add_u32 s49, s49, 4096
  s_and_b32 s49, s49, 0x3ffff
  buffer_load_dwordx4 v[72:75], v3, s[4:7], s34 offen offset:0 sc1
  buffer_load_dwordx4 v[76:79], v3, s[4:7], s34 offen offset:2048 sc1
  s_add_u32 s34, s48, s49
  s_add_u32 s49, s49, 4096
  s_and_b32 s49, s49, 0x3ffff
  buffer_load_dwordx4 v[80:83], v3, s[4:7], s34 offen offset:0 sc1
  buffer_load_dwordx4 v[84:87], v3, s[4:7], s34 offen offset:2048 sc1
  s_add_u32 s34, s48, s49
  s_add_u32 s49, s49, 4096
  s_and_b32 s49, s49, 0x3ffff
  buffer_load_dwordx4 v[88:91], v3, s[4:7], s34 offen offset:0 sc1
  buffer_load_dwordx4 v[92:95], v3, s[4:7], s34 offen offset:2048 sc1
  s_add_u32 s34, s48, s49
  s_add_u32 s49, s49, 4096
  s_and_b32 s49, s49, 0x3ffff
  buffer_load_dwordx4 v[96:99], v3, s[4:7], s34 offen offset:0 sc1
  buffer_load_dwordx4 v[100:103], v3, s[4:7], s34 offen offset:2048 sc1
  s_add_u32 s34, s48, s49
  s_add_u32 s49, s49, 4096
  s_and_b32 s49, s49, 0x3ffff
  buffer_load_dwordx4 v[104:107], v3, s[4:7], s34 offen offset:0 sc1
  buffer_load_dwordx4 v[108:111], v3, s[4:7], s34 offen offset:2048 sc1
  s_add_u32 s34, s48, s49
  s_add_u32 s49, s49, 4096
  s_and_b32 s49, s49, 0x3ffff
  buffer_load_dwordx4 v[112:115], v3, s[4:7], s34 offen offset:0 sc1
  buffer_load_dwordx4 v[116:119], v3, s[4:7], s34 offen offset:2048 sc1
  s_add_u32 s34, s48, s49
  s_add_u32 s49, s49, 4096
  s_and_b32 s49, s49, 0x3ffff
  buffer_load_dwordx4 v[120:123], v3, s[4:7], s34 offen offset:0 sc1
  buffer_load_dwordx4 v[124:127], v3, s[4:7], s34 offen offset:2048 sc1
  s_add_u32 s34, s48, s49
  s_add_u32 s49, s49, 4096
  s_and_b32 s49, s49, 0x3ffff
  buffer_load_dwordx4 v[128:131], v3, s[4:7], s34 offen offset:0 sc1
  buffer_load_dwordx4 v[132:135], v3, s[4:7], s34 offen offset:2048 sc1
  s_add_u32 s34, s48, s49
  s_add_u32 s49, s49, 4096
  s_and_b32 s49, s49, 0x3ffff
  buffer_load_dwordx4 v[136:139], v3, s[4:7], s34 offen offset:0 sc1
  buffer_load_dwordx4 v[140:143], v3, s[4:7], s34 offen offset:2048 sc1
  s_add_u32 s34, s48, s49
  s_add_u32 s49, s49, 4096
  s_and_b32 s49, s49, 0x3ffff
  buffer_load_dwordx4 v[144:147], v3, s[4:7], s34 offen offset:0 sc1
  buffer_load_dwordx4 v[148:151], v3, s[4:7], s34 offen offset:2048 sc1
  s_add_u32 s34, s48, s49
  s_add_u32 s49, s49, 4096
  s_and_b32 s49, s49, 0x3ffff
  buffer_load_dwordx4 v[152:155], v3, s[4:7], s34 offen offset:0 sc1
  buffer_load_dwordx4 v[156:159], v3, s[4:7], s34 offen offset:2048 sc1
  s_add_u32 s34, s48, s49
  s_add_u32 s49, s49, 4096
  s_and_b32 s49, s49, 0x3ffff
  buffer_load_dwordx4 v[160:163], v3, s[4:7], s34 offen offset:0 sc1
  buffer_load_dwordx4 v[164:167], v3, s[4:7], s34 offen offset:2048 sc1
  v_mov_b32 v7, 0
L_g3a_loop:
  s_add_u32 s44, s42, 1
  s_add_u32 s43, s42, 2
  s_lshl_b32 s35, s42, 7
  s_add_u32 s35, s35, 100728832
  s_lshl_b32 s33, s42, 13
  s_add_u32 s33, s33, 117440512
  v_cmp_gt_u32 vcc, s43, v7
  s_and_b32 s38, s43, 1
  v_mad_u32_u24 v6, v4, s38, v5
  s_lshl_b32 s48, s44, 18
  s_add_u32 s48, s48, s47
  s_lshl_b32 s49, s31, 11
  buffer_load_dword v7, v6, s[4:7], 0 offen sc1
  s_cmp_lg_u32 s29, s28
  s_cbranch_scc1 L_g3a_nx
  buffer_load_dword v12, v9, s[4:7], s35 offen sc1
  buffer_load_dwordx4 v[32:35], v15, s[4:7], s33 offen sc1
  buffer_load_dwordx4 v[36:39], v15, s[4:7], s33 offen offset:256 sc1
L_g3a_nx:
  s_mov_b32 s52, 0
  s_cbranch_vccnz L_g3a_np
  s_mov_b32 s52, 1
  s_waitcnt vmcnt(32)
  v_mfma_f32_16x16x32_bf16 v[16:19], a[0:3], v[40:43], 0
  v_mfma_f32_16x16x32_bf16 v[20:23], a[4:7], v[40:43], 0
  s_add_u32 s34, s48, s49
  s_add_u32 s49, s49, 4096
  s_and_b32 s49, s49, 0x3ffff
  buffer_load_dwordx4 v[40:43], v3, s[4:7], s34 offen offset:0 sc1
  s_waitcnt vmcnt(32)
  v_mfma_f32_16x16x32_bf16 v[16:19], a[8:11], v[44:47], v[16:19]
  v_mfma_f32_16x16x32_bf16 v[20:23], a[12:15], v[44:47], v[20:23]
  buffer_load_dwordx4 v[44:47], v3, s[4:7], s34 offen offset:2048 sc1
  s_waitcnt vmcnt(32)
  v_mfma_f32_16x16x32_bf16 v[16:19], a[16:19], v[48:51], v[16:19]
  v_mfma_f32_16x16x32_bf16 v[20:23], a[20:23], v[48:51], v[20:23]
  s_add_u32 s34, s48, s49
  s_add_u32 s49, s49, 4096
  s_and_b32 s49, s49, 0x3ffff
  buffer_load_dwordx4 v[48:51], v3, s[4:7], s34 offen offset:0 sc1
  s_waitcnt vmcnt(32)
  v_mfma_f32_16x16x32_bf16 v[16:19], a[24:27], v[52:55], v[16:19]
  v_mfma_f32_16x16x32_bf16 v[20:23], a[28:31], v[52:55], v[20:23]
  buffer_load_dwordx4 v[52:55], v3, s[4:7], s34 offen offset:2048 sc1
  s_waitcnt vmcnt(32)
  v_mfma_f32_16x16x32_bf16 v[16:19], a[32:35], v[56:59], v[16:19]
  v_mfma_f32_16x16x32_bf16 v[20:23], a[36:39], v[56:59], v[20:23]
  s_add_u32 s34, s48, s49
  s_add_u32 s49, s49, 4096
  s_and_b32 s49, s49, 0x3ffff
  buffer_load_dwordx4 v[56:59], v3, s[4:7], s34 offen offset:0 sc1
  s_waitcnt vmcnt(32)
  v_mfma_f32_16x16x32_bf16 v[16:19], a[40:43], v[60:63], v[16:19]
  v_mfma_f32_16x16x32_bf16 v[20:23], a[44:47], v[60:63], v[20:23]
  buffer_load_dwordx4 v[60:63], v3, s[4:7], s34 offen offset:2048 sc1
  s_waitcnt vmcnt(32)
  v_mfma_f32_16x16x32_bf16 v[16:19], a[48:51], v[64:67], v[16:19]
  v_mfma_f32_16x16x32_bf16 v[20:23], a[52:55], v[64:67], v[20:23]
  s_add_u32 s34, s48, s49
  s_add_u32 s49, s49, 4096
  s_and_b32 s49, s49, 0x3ffff
  buffer_load_dwordx4 v[64:67], v3, s[4:7], s34 offen offset:0 sc1
  s_waitcnt vmcnt(32)
  v_mfma_f32_16x16x32_bf16 v[16:19], a[56:59], v[68:71], v[16:19]
  v_mfma_f32_16x16x32_bf16 v[20:23], a[60:63], v[68:71], v[20:23]
  buffer_load_dwordx4 v[68:71], v3, s[4:7], s34 offen offset:2048 sc1
  s_waitcnt vmcnt(32)
  v_mfma_f32_16x16x32_bf16 v[16:19], a[64:67], v[72:75], v[16:19]
  v_mfma_f32_16x16x32_bf16 v[20:23], a[68:71], v[72:75], v[20:23]
  s_add_u32 s34, s48, s49
  s_add_u32 s49, s49, 4096
  s_and_b32 s49, s49, 0x3ffff
  buffer_load_dwordx4 v[72:75], v3, s[4:7], s34 offen offset:0 sc1
  s_waitcnt vmcnt(32)
  v_mfma_f32_16x16x32_bf16 v[16:19], a[72:75], v[76:79], v[16:19]
  v_mfma_f32_16x16x32_bf16 v[20:23], a[76:79], v[76:79], v[20:23]
  buffer_load_dwordx4 v[76:79], v3, s[4:7], s34 offen offset:2048 sc1
  s_waitcnt vmcnt(32)
  v_mfma_f32_16x16x32_bf16 v[16:19], a[80:83], v[80:83], v[16:19]
  v_mfma_f32_16x16x32_bf16 v[20:23], a[84:87], v[80:83], v[20:23]
  s_add_u32 s34, s48, s49
  s_add_u32 s49, s49, 4096
  s_and_b32 s49, s49, 0x3ffff
  buffer_load_dwordx4 v[80:83], v3, s[4:7], s34 offen offset:0 sc1
  s_waitcnt vmcnt(32)
  v_mfma_f32_16x16x32_bf16 v[16:19], a[88:91], v[84:87], v[16:19]
  v_mfma_f32_16x16x32_bf16 v[20:23], a[92:95], v[84:87], v[20:23]
  buffer_load_dwordx4 v[84:87], v3, s[4:7], s34 offen offset:2048 sc1
  s_waitcnt vmcnt(32)
  v_mfma_f32_16x16x32_bf16 v[16:19], a[96:99], v[88:91], v[16:19]
  v_mfma_f32_16x16x32_bf16 v[20:23], a[100:103], v[88:91], v[20:23]
  s_add_u32 s34, s48, s49
  s_add_u32 s49, s49, 4096
  s_and_b32 s49, s49, 0x3ffff
  buffer_load_dwordx4 v[88:91], v3, s[4:7], s34 offen offset:0 sc1
  s_waitcnt vmcnt(32)
  v_mfma_f32_16x16x32_bf16 v[16:19], a[104:107], v[92:95], v[16:19]
  v_mfma_f32_16x16x32_bf16 v[20:23], a[108:111], v[92:95], v[20:23]
  buffer_load_dwordx4 v[92:95], v3, s[4:7], s34 offen offset:2048 sc1
  s_waitcnt vmcnt(32)
  v_mfma_f32_16x16x32_bf16 v[16:19], a[112:115], v[96:99], v[16:19]
  v_mfma_f32_16x16x32_bf16 v[20:23], a[116:119], v[96:99], v[20:23]
  s_add_u32 s34, s48, s49
  s_add_u32 s49, s49, 4096
  s_and_b32 s49, s49, 0x3ffff
  buffer_load_dwordx4 v[96:99], v3, s[4:7], s34 offen offset:0 sc1
  s_waitcnt vmcnt(32)
  v_mfma_f32_16x16x32_bf16 v[16:19], a[120:123], v[100:103], v[16:19]
  v_mfma_f32_16x16x32_bf16 v[20:23], a[124:127], v[100:103], v[20:23]
  buffer_load_dwordx4 v[100:103], v3, s[4:7], s34 offen offset:2048 sc1
  s_waitcnt vmcnt(32)
  v_mfma_f32_16x16x32_bf16 v[16:19], a[128:131], v[104:107], v[16:19]
  v_mfma_f32_16x16x32_bf16 v[20:23], a[132:135], v[104:107], v[20:23]
  s_add_u32 s34, s48, s49
  s_add_u32 s49, s49, 4096
  s_and_b32 s49, s49, 0x3ffff
  buffer_load_dwordx4 v[104:107], v3, s[4:7], s34 offen offset:0 sc1
  s_waitcnt vmcnt(32)
  v_mfma_f32_16x16x32_bf16 v[16:19], a[136:139], v[108:111], v[16:19]
  v_mfma_f32_16x16x32_bf16 v[20:23], a[140:143], v[108:111], v[20:23]
  buffer_load_dwordx4 v[108:111], v3, s[4:7], s34 offen offset:2048 sc1
  s_waitcnt vmcnt(32)
  v_mfma_f32_16x16x32_bf16 v[16:19], a[144:147], v[112:115], v[16:19]
  v_mfma_f32_16x16x32_bf16 v[20:23], a[148:151], v[112:115], v[20:23]
  s_add_u32 s34, s48, s49
  s_add_u32 s49, s49, 4096
  s_and_b32 s49, s49, 0x3ffff
  buffer_load_dwordx4 v[112:115], v3, s[4:7], s34 offen offset:0 sc1
  s_waitcnt vmcnt(32)
  v_mfma_f32_16x16x32_bf16 v[16:19], a[152:155], v[116:119], v[16:19]
  v_mfma_f32_16x16x32_bf16 v[20:23], a[156:159], v[116:119], v[20:23]
  buffer_load_dwordx4 v[116:119], v3, s[4:7], s34 offen offset:2048 sc1
  s_waitcnt vmcnt(32)
  v_mfma_f32_16x16x32_bf16 v[16:19], a[160:163], v[120:123], v[16:19]
  v_mfma_f32_16x16x32_bf16 v[20:23], a[164:167], v[120:123], v[20:23]
  s_add_u32 s34, s48, s49
  s_add_u32 s49, s49, 4096
  s_and_b32 s49, s49, 0x3ffff
  buffer_load_dwordx4 v[120:123], v3, s[4:7], s34 offen offset:0 sc1
  s_waitcnt vmcnt(32)
  v_mfma_f32_16x16x32_bf16 v[16:19], a[168:171], v[124:127], v[16:19]
  v_mfma_f32_16x16x32_bf16 v[20:23], a[172:175], v[124:127], v[20:23]
  buffer_load_dwordx4 v[124:127], v3, s[4:7], s34 offen offset:2048 sc1
  s_waitcnt vmcnt(32)
  v_mfma_f32_16x16x32_bf16 v[16:19], a[176:179], v[128:131], v[16:19]
  v_mfma_f32_16x16x32_bf16 v[20:23], a[180:183], v[128:131], v[20:23]
  s_add_u32 s34, s48, s49
  s_add_u32 s49, s49, 4096
  s_and_b32 s49, s49, 0x3ffff
  buffer_load_dwordx4 v[128:131], v3, s[4:7], s34 offen offset:0 sc1
  s_waitcnt vmcnt(32)
  v_mfma_f32_16x16x32_bf16 v[16:19], a[184:187], v[132:135], v[16:19]
  v_mfma_f32_16x16x32_bf16 v[20:23], a[188:191], v[132:135], v[20:23]
  buffer_load_dwordx4 v[132:135], v3, s[4:7], s34 offen offset:2048 sc1
  s_waitcnt vmcnt(32)
  v_mfma_f32_16x16x32_bf16 v[16:19], a[192:195], v[136:139], v[16:19]
  v_mfma_f32_16x16x32_bf16 v[20:23], a[196:199], v[136:139], v[20:23]
  s_add_u32 s34, s48, s49
  s_add_u32 s49, s49, 4096
  s_and_b32 s49, s49, 0x3ffff
  buffer_load_dwordx4 v[136:139], v3, s[4:7], s34 offen offset:0 sc1
  s_waitcnt vmcnt(32)
  v_mfma_f32_16x16x32_bf16 v[16:19], a[200:203], v[140:143], v[16:19]
  v_mfma_f32_16x16x32_bf16 v[20:23], a[204:207], v[140:143], v[20:23]
  buffer_load_dwordx4 v[140:143], v3, s[4:7], s34 offen offset:2048 sc1
  s_waitcnt vmcnt(32)
  v_mfma_f32_16x16x32_bf16 v[16:19], a[208:211], v[144:147], v[16:19]
  v_mfma_f32_16x16x32_bf16 v[20:23], a[212:215], v[144:147], v[20:23]
  s_add_u32 s34, s48, s49
  s_add_u32 s49, s49, 4096
  s_and_b32 s49, s49, 0x3ffff
  buffer_load_dwordx4 v[144:147], v3, s[4:7], s34 offen offset:0 sc1
  s_waitcnt vmcnt(32)
  v_mfma_f32_16x16x32_bf16 v[16:19], a[216:219], v[148:151], v[16:19]
  v_mfma_f32_16x16x32_bf16 v[20:23], a[220:223], v[148:151], v[20:23]
  buffer_load_dwordx4 v[148:151], v3, s[4:7], s34 offen offset:2048 sc1
  s_waitcnt vmcnt(32)
  v_mfma_f32_16x16x32_bf16 v[16:19], a[224:227], v[152:155], v[16:19]
  v_mfma_f32_16x16x32_bf16 v[20:23], a[228:231], v[152:155], v[20:23]
  s_add_u32 s34, s48, s49
  s_add_u32 s49, s49, 4096
  s_and_b32 s49, s49, 0x3ffff
  buffer_load_dwordx4 v[152:155], v3, s[4:7], s34 offen offset:0 sc1
  s_waitcnt vmcnt(32)
  v_mfma_f32_16x16x32_bf16 v[16:19], a[232:235], v[156:159], v[16:19]
  v_mfma_f32_16x16x32_bf16 v[20:23], a[236:239], v[156:159], v[20:23]
  buffer_load_dwordx4 v[156:159], v3, s[4:7], s34 offen offset:2048 sc1
  s_waitcnt vmcnt(32)
  v_mfma_f32_16x16x32_bf16 v[16:19], a[240:243], v[160:163], v[16:19]
  v_mfma_f32_16x16x32_bf16 v[20:23], a[244:247], v[160:163], v[20:23]
  s_add_u32 s34, s48, s49
  s_add_u32 s49, s49, 4096
  s_and_b32 s49, s49, 0x3ffff
  buffer_load_dwordx4 v[160:163], v3, s[4:7], s34 offen offset:0 sc1
  s_waitcnt vmcnt(32)
  v_mfma_f32_16x16x32_bf16 v[16:19], a[248:251], v[164:167], v[16:19]
  v_mfma_f32_16x16x32_bf16 v[20:23], a[252:255], v[164:167], v[20:23]
  buffer_load_dwordx4 v[164:167], v3, s[4:7], s34 offen offset:2048 sc1
  s_waitcnt vmcnt(32)
  s_branch L_g3a_fin
L_g3a_np:
  s_waitcnt vmcnt(32)
  v_mfma_f32_16x16x32_bf16 v[16:19], a[0:3], v[40:43], 0
  v_mfma_f32_16x16x32_bf16 v[20:23], a[4:7], v[40:43], 0
  s_waitcnt vmcnt(31)
  v_mfma_f32_16x16x32_bf16 v[16:19], a[8:11], v[44:47], v[16:19]
  v_mfma_f32_16x16x32_bf16 v[20:23], a[12:15], v[44:47], v[20:23]
  s_waitcnt vmcnt(30)
  v_mfma_f32_16x16x32_bf16 v[16:19], a[16:19], v[48:51], v[16:19]
  v_mfma_f32_16x16x32_bf16 v[20:23], a[20:23], v[48:51], v[20:23]
  s_waitcnt vmcnt(29)
  v_mfma_f32_16x16x32_bf16 v[16:19], a[24:27], v[52:55], v[16:19]
  v_mfma_f32_16x16x32_bf16 v[20:23], a[28:31], v[52:55], v[20:23]
  s_waitcnt vmcnt(28)
  v_mfma_f32_16x16x32_bf16 v[16:19], a[32:35], v[56:59], v[16:19]
  v_mfma_f32_16x16x32_bf16 v[20:23], a[36:39], v[56:59], v[20:23]
  s_waitcnt vmcnt(27)
  v_mfma_f32_16x16x32_bf16 v[16:19], a[40:43], v[60:63], v[16:19]
  v_mfma_f32_16x16x32_bf16 v[20:23], a[44:47], v[60:63], v[20:23]
  s_waitcnt vmcnt(26)
  v_mfma_f32_16x16x32_bf16 v[16:19], a[48:51], v[64:67], v[16:19]
  v_mfma_f32_16x16x32_bf16 v[20:23], a[52:55], v[64:67], v[20:23]
  s_waitcnt vmcnt(25)
  v_mfma_f32_16x16x32_bf16 v[16:19], a[56:59], v[68:71], v[16:19]
  v_mfma_f32_16x16x32_bf16 v[20:23], a[60:63], v[68:71], v[20:23]
  s_waitcnt vmcnt(24)
  v_mfma_f32_16x16x32_bf16 v[16:19], a[64:67], v[72:75], v[16:19]
  v_mfma_f32_16x16x32_bf16 v[20:23], a[68:71], v[72:75], v[20:23]
  s_waitcnt vmcnt(23)
  v_mfma_f32_16x16x32_bf16 v[16:19], a[72:75], v[76:79], v[16:19]
  v_mfma_f32_16x16x32_bf16 v[20:23], a[76:79], v[76:79], v[20:23]
  s_waitcnt vmcnt(22)
  v_mfma_f32_16x16x32_bf16 v[16:19], a[80:83], v[80:83], v[16:19]
  v_mfma_f32_16x16x32_bf16 v[20:23], a[84:87], v[80:83], v[20:23]
  s_waitcnt vmcnt(21)
  v_mfma_f32_16x16x32_bf16 v[16:19], a[88:91], v[84:87], v[16:19]
  v_mfma_f32_16x16x32_bf16 v[20:23], a[92:95], v[84:87], v[20:23]
  s_waitcnt vmcnt(20)
  v_mfma_f32_16x16x32_bf16 v[16:19], a[96:99], v[88:91], v[16:19]
  v_mfma_f32_16x16x32_bf16 v[20:23], a[100:103], v[88:91], v[20:23]
  s_waitcnt vmcnt(19)
  v_mfma_f32_16x16x32_bf16 v[16:19], a[104:107], v[92:95], v[16:19]
  v_mfma_f32_16x16x32_bf16 v[20:23], a[108:111], v[92:95], v[20:23]
  s_waitcnt vmcnt(18)
  v_mfma_f32_16x16x32_bf16 v[16:19], a[112:115], v[96:99], v[16:19]
  v_mfma_f32_16x16x32_bf16 v[20:23], a[116:119], v[96:99], v[20:23]
  s_waitcnt vmcnt(17)
  v_mfma_f32_16x16x32_bf16 v[16:19], a[120:123], v[100:103], v[16:19]
  v_mfma_f32_16x16x32_bf16 v[20:23], a[124:127], v[100:103], v[20:23]
  s_waitcnt vmcnt(16)
  v_mfma_f32_16x16x32_bf16 v[16:19], a[128:131], v[104:107], v[16:19]
  v_mfma_f32_16x16x32_bf16 v[20:23], a[132:135], v[104:107], v[20:23]
  s_waitcnt vmcnt(15)
  v_mfma_f32_16x16x32_bf16 v[16:19], a[136:139], v[108:111], v[16:19]
  v_mfma_f32_16x16x32_bf16 v[20:23], a[140:143], v[108:111], v[20:23]
  s_waitcnt vmcnt(14)
  v_mfma_f32_16x16x32_bf16 v[16:19], a[144:147], v[112:115], v[16:19]
  v_mfma_f32_16x16x32_bf16 v[20:23], a[148:151], v[112:115], v[20:23]
  s_waitcnt vmcnt(13)
  v_mfma_f32_16x16x32_bf16 v[16:19], a[152:155], v[116:119], v[16:19]
  v_mfma_f32_16x16x32_bf16 v[20:23], a[156:159], v[116:119], v[20:23]
  s_waitcnt vmcnt(12)
  v_mfma_f32_16x16x32_bf16 v[16:19], a[160:163], v[120:123], v[16:19]
  v_mfma_f32_16x16x32_bf16 v[20:23], a[164:167], v[120:123], v[20:23]
  s_waitcnt vmcnt(11)
  v_mfma_f32_16x16x32_bf16 v[16:19], a[168:171], v[124:127], v[16:19]
  v_mfma_f32_16x16x32_bf16 v[20:23], a[172:175], v[124:127], v[20:23]
  s_waitcnt vmcnt(10)
  v_mfma_f32_16x16x32_bf16 v[16:19], a[176:179], v[128:131], v[16:19]
  v_mfma_f32_16x16x32_bf16 v[20:23], a[180:183], v[128:131], v[20:23]
  s_waitcnt vmcnt(9)
  v_mfma_f32_16x16x32_bf16 v[16:19], a[184:187], v[132:135], v[16:19]
  v_mfma_f32_16x16x32_bf16 v[20:23], a[188:191], v[132:135], v[20:23]
  s_waitcnt vmcnt(8)
  v_mfma_f32_16x16x32_bf16 v[16:19], a[192:195], v[136:139], v[16:19]
  v_mfma_f32_16x16x32_bf16 v[20:23], a[196:199], v[136:139], v[20:23]
  s_waitcnt vmcnt(7)
  v_mfma_f32_16x16x32_bf16 v[16:19], a[200:203], v[140:143], v[16:19]
  v_mfma_f32_16x16x32_bf16 v[20:23], a[204:207], v[140:143], v[20:23]
  s_waitcnt vmcnt(6)
  v_mfma_f32_16x16x32_bf16 v[16:19], a[208:211], v[144:147], v[16:19]
  v_mfma_f32_16x16x32_bf16 v[20:23], a[212:215], v[144:147], v[20:23]
  s_waitcnt vmcnt(5)
  v_mfma_f32_16x16x32_bf16 v[16:19], a[216:219], v[148:151], v[16:19]
  v_mfma_f32_16x16x32_bf16 v[20:23], a[220:223], v[148:151], v[20:23]
  s_waitcnt vmcnt(4)
  v_mfma_f32_16x16x32_bf16 v[16:19], a[224:227], v[152:155], v[16:19]
  v_mfma_f32_16x16x32_bf16 v[20:23], a[228:231], v[152:155], v[20:23]
  s_waitcnt vmcnt(3)
  v_mfma_f32_16x16x32_bf16 v[16:19], a[232:235], v[156:159], v[16:19]
  v_mfma_f32_16x16x32_bf16 v[20:23], a[236:239], v[156:159], v[20:23]
  s_waitcnt vmcnt(2)
  v_mfma_f32_16x16x32_bf16 v[16:19], a[240:243], v[160:163], v[16:19]
  v_mfma_f32_16x16x32_bf16 v[20:23], a[244:247], v[160:163], v[20:23]
  s_waitcnt vmcnt(1)
  v_mfma_f32_16x16x32_bf16 v[16:19], a[248:251], v[164:167], v[16:19]
  v_mfma_f32_16x16x32_bf16 v[20:23], a[252:255], v[164:167], v[20:23]
  s_waitcnt vmcnt(0)
L_g3a_fin:
  s_add_u32 s38, s51, s46
  v_add_u32 v13, s38, v10
  v_add_u32 v14, s46, v11
  s_nop 2
  ds_write_b128 v13, v[16:19] offset:0
  ds_write_b128 v13, v[20:23] offset:1024
  s_waitcnt lgkmcnt(0)
  s_barrier
  s_cmp_lg_u32 s29, s28
  s_cbranch_scc1 L_g3a_next
  ds_read_b128 v[168:171], v14 offset:0
  ds_read_b128 v[172:175], v14 offset:1024
  ds_read_b128 v[176:179], v14 offset:4096
  ds_read_b128 v[180:183], v14 offset:5120
  ds_read_b128 v[184:187], v14 offset:8192
  ds_read_b128 v[188:191], v14 offset:9216
  ds_read_b128 v[192:195], v14 offset:12288
  ds_read_b128 v[196:199], v14 offset:13312
  s_waitcnt lgkmcnt(0)
  v_pk_add_f32 v[168:169], v[168:169], v[176:177]
  v_pk_add_f32 v[184:185], v[184:185], v[192:193]
  v_pk_add_f32 v[170:171], v[170:171], v[178:179]
  v_pk_add_f32 v[186:187], v[186:187], v[194:195]
  v_pk_add_f32 v[172:173], v[172:173], v[180:181]
  v_pk_add_f32 v[188:189], v[188:189], v[196:197]
  v_pk_add_f32 v[174:175], v[174:175], v[182:183]
  v_pk_add_f32 v[190:191], v[190:191], v[198:199]
  v_pk_add_f32 v[168:169], v[168:169], v[184:185]
  v_pk_add_f32 v[170:171], v[170:171], v[186:187]
  v_pk_add_f32 v[172:173], v[172:173], v[188:189]
  v_pk_add_f32 v[174:175], v[174:175], v[190:191]
  v_sub_f32 v168, v168, v32
  v_sub_f32 v169, v169, v33
  v_sub_f32 v170, v170, v34
  v_sub_f32 v171, v171, v35
  v_sub_f32 v172, v172, v36
  v_sub_f32 v173, v173, v37
  v_sub_f32 v174, v174, v38
  v_sub_f32 v175, v175, v39
  v_fma_f32 v168, v12, v168, v32
  v_fma_f32 v169, v12, v169, v33
  v_fma_f32 v170, v12, v170, v34
  v_fma_f32 v171, v12, v171, v35
  v_fma_f32 v172, v12, v172, v36
  v_fma_f32 v173, v12, v173, v37
  v_fma_f32 v174, v12, v174, v38
  v_fma_f32 v175, v12, v175, v39
  v_cvt_pk_bf16_f32 v200, v168, v169
  v_cvt_pk_bf16_f32 v201, v170, v171
  v_cvt_pk_bf16_f32 v202, v172, v173
  v_cvt_pk_bf16_f32 v203, v174, v175
  s_mul_i32 s38, s42, 40960
  buffer_store_dwordx4 v[200:203], v8, s[16:19], s38 offen
L_g3a_next:
  s_xor_b32 s46, s46, 16384
  s_add_u32 s42, s42, 1
  s_cmp_ge_u32 s42, 64
  s_cbranch_scc1 L_end
  s_cmp_eq_u32 s52, 1
  s_cbranch_scc1 L_g3a_loop
  s_branch L_g3a_cold2
L_g3a_cold2:
  s_add_u32 s44, s42, 1
  v_mov_b32 v1, v7
  s_and_b32 s38, s42, 1
  v_mad_u32_u24 v6, v4, s38, v5
L_g3e_p:
  buffer_load_dword v7, v6, s[4:7], 0 offen sc1
  s_waitcnt vmcnt(0)
  v_cmp_gt_u32 vcc, s44, v7
  s_cbranch_vccz L_g3e_ok
  s_sleep 2
  s_add_u32 s50, s50, 1
  s_cmp_lt_u32 s50, 0x200000
  s_cbranch_scc1 L_g3e_p
  s_branch L_end
L_g3e_ok:
  s_lshl_b32 s48, s42, 18
  s_add_u32 s48, s48, s47
  s_lshl_b32 s49, s31, 11
  s_add_u32 s34, s48, s49
  s_add_u32 s49, s49, 4096
  s_and_b32 s49, s49, 0x3ffff
  buffer_load_dwordx4 v[40:43], v3, s[4:7], s34 offen offset:0 sc1
  buffer_load_dwordx4 v[44:47], v3, s[4:7], s34 offen offset:2048 sc1
  s_add_u32 s34, s48, s49
  s_add_u32 s49, s49, 4096
  s_and_b32 s49, s49, 0x3ffff
  buffer_load_dwordx4 v[48:51], v3, s[4:7], s34 offen offset:0 sc1
  buffer_load_dwordx4 v[52:55], v3, s[4:7], s34 offen offset:2048 sc1
  s_add_u32 s34, s48, s49
  s_add_u32 s49, s49, 4096
  s_and_b32 s49, s49, 0x3ffff
  buffer_load_dwordx4 v[56:59], v3, s[4:7], s34 offen offset:0 sc1
  buffer_load_dwordx4 v[60:63], v3, s[4:7], s34 offen offset:2048 sc1
  s_add_u32 s34, s48, s49
  s_add_u32 s49, s49, 4096
  s_and_b32 s49, s49, 0x3ffff
  buffer_load_dwordx4 v[64:67], v3, s[4:7], s34 offen offset:0 sc1
  buffer_load_dwordx4 v[68:71], v3, s[4:7], s34 offen offset:2048 sc1
  s_add_u32 s34, s48, s49
  s_add_u32 s49, s49, 4096
  s_and_b32 s49, s49, 0x3ffff
  buffer_load_dwordx4 v[72:75], v3, s[4:7], s34 offen offset:0 sc1
  buffer_load_dwordx4 v[76:79], v3, s[4:7], s34 offen offset:2048 sc1
  s_add_u32 s34, s48, s49
  s_add_u32 s49, s49, 4096
  s_and_b32 s49, s49, 0x3ffff
  buffer_load_dwordx4 v[80:83], v3, s[4:7], s34 offen offset:0 sc1
  buffer_load_dwordx4 v[84:87], v3, s[4:7], s34 offen offset:2048 sc1
  s_add_u32 s34, s48, s49
  s_add_u32 s49, s49, 4096
  s_and_b32 s49, s49, 0x3ffff
  buffer_load_dwordx4 v[88:91], v3, s[4:7], s34 offen offset:0 sc1
  buffer_load_dwordx4 v[92:95], v3, s[4:7], s34 offen offset:2048 sc1
  s_add_u32 s34, s48, s49
  s_add_u32 s49, s49, 4096
  s_and_b32 s49, s49, 0x3ffff
  buffer_load_dwordx4 v[96:99], v3, s[4:7], s34 offen offset:0 sc1
  buffer_load_dwordx4 v[100:103], v3, s[4:7], s34 offen offset:2048 sc1
  s_add_u32 s34, s48, s49
  s_add_u32 s49, s49, 4096
  s_and_b32 s49, s49, 0x3ffff
  buffer_load_dwordx4 v[104:107], v3, s[4:7], s34 offen offset:0 sc1
  buffer_load_dwordx4 v[108:111], v3, s[4:7], s34 offen offset:2048 sc1
  s_add_u32 s34, s48, s49
  s_add_u32 s49, s49, 4096
  s_and_b32 s49, s49, 0x3ffff
  buffer_load_dwordx4 v[112:115], v3, s[4:7], s34 offen offset:0 sc1
  buffer_load_dwordx4 v[116:119], v3, s[4:7], s34 offen offset:2048 sc1
  s_add_u32 s34, s48, s49
  s_add_u32 s49, s49, 4096
  s_and_b32 s49, s49, 0x3ffff
  buffer_load_dwordx4 v[120:123], v3, s[4:7], s34 offen offset:0 sc1
  buffer_load_dwordx4 v[124:127], v3, s[4:7], s34 offen offset:2048 sc1
  s_add_u32 s34, s48, s49
  s_add_u32 s49, s49, 4096
  s_and_b32 s49, s49, 0x3ffff
  buffer_load_dwordx4 v[128:131], v3, s[4:7], s34 offen offset:0 sc1
  buffer_load_dwordx4 v[132:135], v3, s[4:7], s34 offen offset:2048 sc1
  s_add_u32 s34, s48, s49
  s_add_u32 s49, s49, 4096
  s_and_b32 s49, s49, 0x3ffff
  buffer_load_dwordx4 v[136:139], v3, s[4:7], s34 offen offset:0 sc1
  buffer_load_dwordx4 v[140:143], v3, s[4:7], s34 offen offset:2048 sc1
  s_add_u32 s34, s48, s49
  s_add_u32 s49, s49, 4096
  s_and_b32 s49, s49, 0x3ffff
  buffer_load_dwordx4 v[144:147], v3, s[4:7], s34 offen offset:0 sc1
  buffer_load_dwordx4 v[148:151], v3, s[4:7], s34 offen offset:2048 sc1
  s_add_u32 s34, s48, s49
  s_add_u32 s49, s49, 4096
  s_and_b32 s49, s49, 0x3ffff
  buffer_load_dwordx4 v[152:155], v3, s[4:7], s34 offen offset:0 sc1
  buffer_load_dwordx4 v[156:159], v3, s[4:7], s34 offen offset:2048 sc1
  s_add_u32 s34, s48, s49
  s_add_u32 s49, s49, 4096
  s_and_b32 s49, s49, 0x3ffff
  buffer_load_dwordx4 v[160:163], v3, s[4:7], s34 offen offset:0 sc1
  buffer_load_dwordx4 v[164:167], v3, s[4:7], s34 offen offset:2048 sc1
  v_mov_b32 v7, v1
  s_branch L_g3a_loop
L_g3b:
  v_lshrrev_b32 v1, 6, v0
  s_nop 0
  v_readfirstlane_b32 s29, v1
  v_and_b32 v2, 63, v0
  v_lshlrev_b32 v3, 4, v2
  s_load_dwordx2 s[12:13], s[0:1], 80
  s_mov_b32 s14, 2211840
  s_mov_b32 s15, 0x20000
  s_mul_i32 s31, s29, 14
  s_min_u32 s31, s31, 40
  s_mul_i32 s45, s29, 40960
  s_mul_i32 s33, s31, 40960
  s_lshl_b32 s38, s30, 7
  s_add_u32 s33, s33, s38
  v_lshrrev_b32 v4, 3, v2
  v_mul_u32_u24 v4, 1280, v4
  v_and_b32 v5, 7, v2
  v_lshl_add_u32 v4, v5, 4, v4
  v_add_u32 v8, s33, v4
  v_lshrrev_b32 v7, 4, v2
  v_bfe_u32 v5, v2, 2, 2
  v_lshl_add_u32 v5, v7, 3, v5
  v_lshlrev_b32 v5, 7, v5
  v_and_b32 v6, 3, v2
  v_lshl_add_u32 v5, v6, 3, v5
  v_add_u32 v13, s45, v5
  s_waitcnt lgkmcnt(0)
  s_load_dwordx2 s[20:21], s[0:1], 104
  s_mov_b32 s22, 256
  s_mov_b32 s23, 0x20000
  s_mov_b32 s38, 0
  s_waitcnt lgkmcnt(0)
L_g3c_wi:
  buffer_load_dword v1, off, s[20:23], 0 offset:128 sc1
  s_waitcnt vmcnt(0)
  v_cmp_eq_u32 vcc, 0, v1
  s_cbranch_vccz L_g3c_wd
  s_sleep 8
  s_add_u32 s38, s38, 1
  s_cmp_lt_u32 s38, 0x100000
  s_cbranch_scc1 L_g3c_wi
  s_branch L_end
L_g3c_wd:
  s_add_u32 m0, s45, 0
  s_nop 0
  buffer_load_dwordx4 v8, s[12:15], 0 offen lds
  v_add_u32 v8, 10240, v8
  s_add_u32 m0, s45, 1024
  s_nop 0
  buffer_load_dwordx4 v8, s[12:15], 0 offen lds
  v_add_u32 v8, 10240, v8
  s_add_u32 m0, s45, 2048
  s_nop 0
  buffer_load_dwordx4 v8, s[12:15], 0 offen lds
  v_add_u32 v8, 10240, v8
  s_add_u32 m0, s45, 3072
  s_nop 0
  buffer_load_dwordx4 v8, s[12:15], 0 offen lds
  v_add_u32 v8, 10240, v8
  s_add_u32 m0, s45, 4096
  s_nop 0
  buffer_load_dwordx4 v8, s[12:15], 0 offen lds
  v_add_u32 v8, 10240, v8
  s_add_u32 m0, s45, 5120
  s_nop 0
  buffer_load_dwordx4 v8, s[12:15], 0 offen lds
  v_add_u32 v8, 10240, v8
  s_add_u32 m0, s45, 6144
  s_nop 0
  buffer_load_dwordx4 v8, s[12:15], 0 offen lds
  v_add_u32 v8, 10240, v8
  s_add_u32 m0, s45, 7168
  s_nop 0
  buffer_load_dwordx4 v8, s[12:15], 0 offen lds
  v_add_u32 v8, 10240, v8
  s_add_u32 m0, s45, 8192
  s_nop 0
  buffer_load_dwordx4 v8, s[12:15], 0 offen lds
  v_add_u32 v8, 10240, v8
  s_add_u32 m0, s45, 9216
  s_nop 0
  buffer_load_dwordx4 v8, s[12:15], 0 offen lds
  v_add_u32 v8, 10240, v8
  s_add_u32 m0, s45, 10240
  s_nop 0
  buffer_load_dwordx4 v8, s[12:15], 0 offen lds
  v_add_u32 v8, 10240, v8
  s_add_u32 m0, s45, 11264
  s_nop 0
  buffer_load_dwordx4 v8, s[12:15], 0 offen lds
  v_add_u32 v8, 10240, v8
  s_add_u32 m0, s45, 12288
  s_nop 0
  buffer_load_dwordx4 v8, s[12:15], 0 offen lds
  v_add_u32 v8, 10240, v8
  s_add_u32 m0, s45, 13312
  s_nop 0
  buffer_load_dwordx4 v8, s[12:15], 0 offen lds
  v_add_u32 v8, 10240, v8
  s_add_u32 m0, s45, 14336
  s_nop 0
  buffer_load_dwordx4 v8, s[12:15], 0 offen lds
  v_add_u32 v8, 10240, v8
  s_add_u32 m0, s45, 15360
  s_nop 0
  buffer_load_dwordx4 v8, s[12:15], 0 offen lds
  v_add_u32 v8, 10240, v8
  s_add_u32 m0, s45, 16384
  s_nop 0
  buffer_load_dwordx4 v8, s[12:15], 0 offen lds
  v_add_u32 v8, 10240, v8
  s_add_u32 m0, s45, 17408
  s_nop 0
  buffer_load_dwordx4 v8, s[12:15], 0 offen lds
  v_add_u32 v8, 10240, v8
  s_add_u32 m0, s45, 18432
  s_nop 0
  buffer_load_dwordx4 v8, s[12:15], 0 offen lds
  v_add_u32 v8, 10240, v8
  s_add_u32 m0, s45, 19456
  s_nop 0
  buffer_load_dwordx4 v8, s[12:15], 0 offen lds
  v_add_u32 v8, 10240, v8
  s_add_u32 m0, s45, 20480
  s_nop 0
  buffer_load_dwordx4 v8, s[12:15], 0 offen lds
  v_add_u32 v8, 10240, v8
  s_add_u32 m0, s45, 21504
  s_nop 0
  buffer_load_dwordx4 v8, s[12:15], 0 offen lds
  v_add_u32 v8, 10240, v8
  s_add_u32 m0, s45, 22528
  s_nop 0
  buffer_load_dwordx4 v8, s[12:15], 0 offen lds
  v_add_u32 v8, 10240, v8
  s_add_u32 m0, s45, 23552
  s_nop 0
  buffer_load_dwordx4 v8, s[12:15], 0 offen lds
  v_add_u32 v8, 10240, v8
  s_add_u32 m0, s45, 24576
  s_nop 0
  buffer_load_dwordx4 v8, s[12:15], 0 offen lds
  v_add_u32 v8, 10240, v8
  s_add_u32 m0, s45, 25600
  s_nop 0
  buffer_load_dwordx4 v8, s[12:15], 0 offen lds
  v_add_u32 v8, 10240, v8
  s_add_u32 m0, s45, 26624
  s_nop 0
  buffer_load_dwordx4 v8, s[12:15], 0 offen lds
  v_add_u32 v8, 10240, v8
  s_add_u32 m0, s45, 27648
  s_nop 0
  buffer_load_dwordx4 v8, s[12:15], 0 offen lds
  v_add_u32 v8, 10240, v8
  s_waitcnt vmcnt(24)
  ds_read_b64_tr_b16 a[0:1], v13 offset:0
  ds_read_b64_tr_b16 a[2:3], v13 offset:512
  ds_read_b64_tr_b16 a[4:5], v13 offset:32
  ds_read_b64_tr_b16 a[6:7], v13 offset:544
  ds_read_b64_tr_b16 a[8:9], v13 offset:64
  ds_read_b64_tr_b16 a[10:11], v13 offset:576
  ds_read_b64_tr_b16 a[12:13], v13 offset:96
  ds_read_b64_tr_b16 a[14:15], v13 offset:608
  s_waitcnt lgkmcnt(0)
  s_waitcnt vmcnt(20)
  ds_read_b64_tr_b16 a[16:17], v13 offset:4096
  ds_read_b64_tr_b16 a[18:19], v13 offset:4608
  ds_read_b64_tr_b16 a[20:21], v13 offset:4128
  ds_read_b64_tr_b16 a[22:23], v13 offset:4640
  ds_read_b64_tr_b16 a[24:25], v13 offset:4160
  ds_read_b64_tr_b16 a[26:27], v13 offset:4672
  ds_read_b64_tr_b16 a[28:29], v13 offset:4192
  ds_read_b64_tr_b16 a[30:31], v13 offset:4704
  s_waitcnt lgkmcnt(0)
  s_waitcnt vmcnt(16)
  ds_read_b64_tr_b16 a[32:33], v13 offset:8192
  ds_read_b64_tr_b16 a[34:35], v13 offset:8704
  ds_read_b64_tr_b16 a[36:37], v13 offset:8224
  ds_read_b64_tr_b16 a[38:39], v13 offset:8736
  ds_read_b64_tr_b16 a[40:41], v13 offset:8256
  ds_read_b64_tr_b16 a[42:43], v13 offset:8768
  ds_read_b64_tr_b16 a[44:45], v13 offset:8288
  ds_read_b64_tr_b16 a[46:47], v13 offset:8800
  s_waitcnt lgkmcnt(0)
  s_waitcnt vmcnt(12)
  ds_read_b64_tr_b16 a[48:49], v13 offset:12288
  ds_read_b64_tr_b16 a[50:51], v13 offset:12800
  ds_read_b64_tr_b16 a[52:53], v13 offset:12320
  ds_read_b64_tr_b16 a[54:55], v13 offset:12832
  ds_read_b64_tr_b16 a[56:57], v13 offset:12352
  ds_read_b64_tr_b16 a[58:59], v13 offset:12864
  ds_read_b64_tr_b16 a[60:61], v13 offset:12384
  ds_read_b64_tr_b16 a[62:63], v13 offset:12896
  s_waitcnt lgkmcnt(0)
  s_waitcnt vmcnt(8)
  ds_read_b64_tr_b16 a[64:65], v13 offset:16384
  ds_read_b64_tr_b16 a[66:67], v13 offset:16896
  ds_read_b64_tr_b16 a[68:69], v13 offset:16416
  ds_read_b64_tr_b16 a[70:71], v13 offset:16928
  ds_read_b64_tr_b16 a[72:73], v13 offset:16448
  ds_read_b64_tr_b16 a[74:75], v13 offset:16960
  ds_read_b64_tr_b16 a[76:77], v13 offset:16480
  ds_read_b64_tr_b16 a[78:79], v13 offset:16992
  s_waitcnt lgkmcnt(0)
  s_waitcnt vmcnt(4)
  ds_read_b64_tr_b16 a[80:81], v13 offset:20480
  ds_read_b64_tr_b16 a[82:83], v13 offset:20992
  ds_read_b64_tr_b16 a[84:85], v13 offset:20512
  ds_read_b64_tr_b16 a[86:87], v13 offset:21024
  ds_read_b64_tr_b16 a[88:89], v13 offset:20544
  ds_read_b64_tr_b16 a[90:91], v13 offset:21056
  ds_read_b64_tr_b16 a[92:93], v13 offset:20576
  ds_read_b64_tr_b16 a[94:95], v13 offset:21088
  s_waitcnt lgkmcnt(0)
  s_waitcnt vmcnt(0)
  ds_read_b64_tr_b16 a[96:97], v13 offset:24576
  ds_read_b64_tr_b16 a[98:99], v13 offset:25088
  ds_read_b64_tr_b16 a[100:101], v13 offset:24608
  ds_read_b64_tr_b16 a[102:103], v13 offset:25120
  ds_read_b64_tr_b16 a[104:105], v13 offset:24640
  ds_read_b64_tr_b16 a[106:107], v13 offset:25152
  ds_read_b64_tr_b16 a[108:109], v13 offset:24672
  ds_read_b64_tr_b16 a[110:111], v13 offset:25184
  s_waitcnt lgkmcnt(0)
  s_add_u32 m0, s45, 0
  s_nop 0
  buffer_load_dwordx4 v8, s[12:15], 0 offen lds
  v_add_u32 v8, 10240, v8
  s_add_u32 m0, s45, 1024
  s_nop 0
  buffer_load_dwordx4 v8, s[12:15], 0 offen lds
  v_add_u32 v8, 10240, v8
  s_add_u32 m0, s45, 2048
  s_nop 0
  buffer_load_dwordx4 v8, s[12:15], 0 offen lds
  v_add_u32 v8, 10240, v8
  s_add_u32 m0, s45, 3072
  s_nop 0
  buffer_load_dwordx4 v8, s[12:15], 0 offen lds
  v_add_u32 v8, 10240, v8
  s_add_u32 m0, s45, 4096
  s_nop 0
  buffer_load_dwordx4 v8, s[12:15], 0 offen lds
  v_add_u32 v8, 10240, v8
  s_add_u32 m0, s45, 5120
  s_nop 0
  buffer_load_dwordx4 v8, s[12:15], 0 offen lds
  v_add_u32 v8, 10240, v8
  s_add_u32 m0, s45, 6144
  s_nop 0
  buffer_load_dwordx4 v8, s[12:15], 0 offen lds
  v_add_u32 v8, 10240, v8
  s_add_u32 m0, s45, 7168
  s_nop 0
  buffer_load_dwordx4 v8, s[12:15], 0 offen lds
  v_add_u32 v8, 10240, v8
  s_add_u32 m0, s45, 8192
  s_nop 0
  buffer_load_dwordx4 v8, s[12:15], 0 offen lds
  v_add_u32 v8, 10240, v8
  s_add_u32 m0, s45, 9216
  s_nop 0
  buffer_load_dwordx4 v8, s[12:15], 0 offen lds
  v_add_u32 v8, 10240, v8
  s_add_u32 m0, s45, 10240
  s_nop 0
  buffer_load_dwordx4 v8, s[12:15], 0 offen lds
  v_add_u32 v8, 10240, v8
  s_add_u32 m0, s45, 11264
  s_nop 0
  buffer_load_dwordx4 v8, s[12:15], 0 offen lds
  v_add_u32 v8, 10240, v8
  s_add_u32 m0, s45, 12288
  s_nop 0
  buffer_load_dwordx4 v8, s[12:15], 0 offen lds
  v_add_u32 v8, 10240, v8
  s_add_u32 m0, s45, 13312
  s_nop 0
  buffer_load_dwordx4 v8, s[12:15], 0 offen lds
  v_add_u32 v8, 10240, v8
  s_add_u32 m0, s45, 14336
  s_nop 0
  buffer_load_dwordx4 v8, s[12:15], 0 offen lds
  v_add_u32 v8, 10240, v8
  s_add_u32 m0, s45, 15360
  s_nop 0
  buffer_load_dwordx4 v8, s[12:15], 0 offen lds
  v_add_u32 v8, 10240, v8
  s_add_u32 m0, s45, 16384
  s_nop 0
  buffer_load_dwordx4 v8, s[12:15], 0 offen lds
  v_add_u32 v8, 10240, v8
  s_add_u32 m0, s45, 17408
  s_nop 0
  buffer_load_dwordx4 v8, s[12:15], 0 offen lds
  v_add_u32 v8, 10240, v8
  s_add_u32 m0, s45, 18432
  s_nop 0
  buffer_load_dwordx4 v8, s[12:15], 0 offen lds
  v_add_u32 v8, 10240, v8
  s_add_u32 m0, s45, 19456
  s_nop 0
  buffer_load_dwordx4 v8, s[12:15], 0 offen lds
  v_add_u32 v8, 10240, v8
  s_add_u32 m0, s45, 20480
  s_nop 0
  buffer_load_dwordx4 v8, s[12:15], 0 offen lds
  v_add_u32 v8, 10240, v8
  s_add_u32 m0, s45, 21504
  s_nop 0
  buffer_load_dwordx4 v8, s[12:15], 0 offen lds
  v_add_u32 v8, 10240, v8
  s_add_u32 m0, s45, 22528
  s_nop 0
  buffer_load_dwordx4 v8, s[12:15], 0 offen lds
  v_add_u32 v8, 10240, v8
  s_add_u32 m0, s45, 23552
  s_nop 0
  buffer_load_dwordx4 v8, s[12:15], 0 offen lds
  v_add_u32 v8, 10240, v8
  s_add_u32 m0, s45, 24576
  s_nop 0
  buffer_load_dwordx4 v8, s[12:15], 0 offen lds
  v_add_u32 v8, 10240, v8
  s_add_u32 m0, s45, 25600
  s_nop 0
  buffer_load_dwordx4 v8, s[12:15], 0 offen lds
  v_add_u32 v8, 10240, v8
  s_add_u32 m0, s45, 26624
  s_nop 0
  buffer_load_dwordx4 v8, s[12:15], 0 offen lds
  v_add_u32 v8, 10240, v8
  s_add_u32 m0, s45, 27648
  s_nop 0
  buffer_load_dwordx4 v8, s[12:15], 0 offen lds
  v_add_u32 v8, 10240, v8
  s_waitcnt vmcnt(24)
  ds_read_b64_tr_b16 a[112:113], v13 offset:0
  ds_read_b64_tr_b16 a[114:115], v13 offset:512
  ds_read_b64_tr_b16 a[116:117], v13 offset:32
  ds_read_b64_tr_b16 a[118:119], v13 offset:544
  ds_read_b64_tr_b16 a[120:121], v13 offset:64
  ds_read_b64_tr_b16 a[122:123], v13 offset:576
  ds_read_b64_tr_b16 a[124:125], v13 offset:96
  ds_read_b64_tr_b16 a[126:127], v13 offset:608
  s_waitcnt lgkmcnt(0)
  s_waitcnt vmcnt(20)
  ds_read_b64_tr_b16 a[128:129], v13 offset:4096
  ds_read_b64_tr_b16 a[130:131], v13 offset:4608
  ds_read_b64_tr_b16 a[132:133], v13 offset:4128
  ds_read_b64_tr_b16 a[134:135], v13 offset:4640
  ds_read_b64_tr_b16 a[136:137], v13 offset:4160
  ds_read_b64_tr_b16 a[138:139], v13 offset:4672
  ds_read_b64_tr_b16 a[140:141], v13 offset:4192
  ds_read_b64_tr_b16 a[142:143], v13 offset:4704
  s_waitcnt lgkmcnt(0)
  s_waitcnt vmcnt(16)
  ds_read_b64_tr_b16 a[144:145], v13 offset:8192
  ds_read_b64_tr_b16 a[146:147], v13 offset:8704
  ds_read_b64_tr_b16 a[148:149], v13 offset:8224
  ds_read_b64_tr_b16 a[150:151], v13 offset:8736
  ds_read_b64_tr_b16 a[152:153], v13 offset:8256
  ds_read_b64_tr_b16 a[154:155], v13 offset:8768
  ds_read_b64_tr_b16 a[156:157], v13 offset:8288
  ds_read_b64_tr_b16 a[158:159], v13 offset:8800
  s_waitcnt lgkmcnt(0)
  s_waitcnt vmcnt(12)
  ds_read_b64_tr_b16 a[160:161], v13 offset:12288
  ds_read_b64_tr_b16 a[162:163], v13 offset:12800
  ds_read_b64_tr_b16 a[164:165], v13 offset:12320
  ds_read_b64_tr_b16 a[166:167], v13 offset:12832
  ds_read_b64_tr_b16 a[168:169], v13 offset:12352
  ds_read_b64_tr_b16 a[170:171], v13 offset:12864
  ds_read_b64_tr_b16 a[172:173], v13 offset:12384
  ds_read_b64_tr_b16 a[174:175], v13 offset:12896
  s_waitcnt lgkmcnt(0)
  s_waitcnt vmcnt(8)
  ds_read_b64_tr_b16 a[176:177], v13 offset:16384
  ds_read_b64_tr_b16 a[178:179], v13 offset:16896
  ds_read_b64_tr_b16 a[180:181], v13 offset:16416
  ds_read_b64_tr_b16 a[182:183], v13 offset:16928
  ds_read_b64_tr_b16 a[184:185], v13 offset:16448
  ds_read_b64_tr_b16 a[186:187], v13 offset:16960
  ds_read_b64_tr_b16 a[188:189], v13 offset:16480
  ds_read_b64_tr_b16 a[190:191], v13 offset:16992
  s_waitcnt lgkmcnt(0)
  s_waitcnt vmcnt(4)
  ds_read_b64_tr_b16 a[192:193], v13 offset:20480
  ds_read_b64_tr_b16 a[194:195], v13 offset:20992
  ds_read_b64_tr_b16 a[196:197], v13 offset:20512
  ds_read_b64_tr_b16 a[198:199], v13 offset:21024
  ds_read_b64_tr_b16 a[200:201], v13 offset:20544
  ds_read_b64_tr_b16 a[202:203], v13 offset:21056
  ds_read_b64_tr_b16 a[204:205], v13 offset:20576
  ds_read_b64_tr_b16 a[206:207], v13 offset:21088
  s_waitcnt lgkmcnt(0)
  s_waitcnt vmcnt(0)
  ds_read_b64_tr_b16 a[208:209], v13 offset:24576
  ds_read_b64_tr_b16 a[210:211], v13 offset:25088
  ds_read_b64_tr_b16 a[212:213], v13 offset:24608
  ds_read_b64_tr_b16 a[214:215], v13 offset:25120
  ds_read_b64_tr_b16 a[216:217], v13 offset:24640
  ds_read_b64_tr_b16 a[218:219], v13 offset:25152
  ds_read_b64_tr_b16 a[220:221], v13 offset:24672
  ds_read_b64_tr_b16 a[222:223], v13 offset:25184
  s_waitcnt lgkmcnt(0)
  s_cmp_lg_u32 s29, 3
  s_cbranch_scc1 L_g3b_nz
  v_accvgpr_write_b32 a0, 0
  v_accvgpr_write_b32 a1, 0
  v_accvgpr_write_b32 a2, 0
  v_accvgpr_write_b32 a3, 0
  v_accvgpr_write_b32 a4, 0
  v_accvgpr_write_b32 a5, 0
  v_accvgpr_write_b32 a6, 0
  v_accvgpr_write_b32 a7, 0
  v_accvgpr_write_b32 a8, 0
  v_accvgpr_write_b32 a9, 0
  v_accvgpr_write_b32 a10, 0
  v_accvgpr_write_b32 a11, 0
  v_accvgpr_write_b32 a12, 0
  v_accvgpr_write_b32 a13, 0
  v_accvgpr_write_b32 a14, 0
  v_accvgpr_write_b32 a15, 0
  v_accvgpr_write_b32 a16, 0
  v_accvgpr_write_b32 a17, 0
  v_accvgpr_write_b32 a18, 0
  v_accvgpr_write_b32 a19, 0
  v_accvgpr_write_b32 a20, 0
  v_accvgpr_write_b32 a21, 0
  v_accvgpr_write_b32 a22, 0
  v_accvgpr_write_b32 a23, 0
  v_accvgpr_write_b32 a24, 0
  v_accvgpr_write_b32 a25, 0
  v_accvgpr_write_b32 a26, 0
  v_accvgpr_write_b32 a27, 0
  v_accvgpr_write_b32 a28, 0
  v_accvgpr_write_b32 a29, 0
  v_accvgpr_write_b32 a30, 0
  v_accvgpr_write_b32 a31, 0
L_g3b_nz:
  v_min_u32 v4, 13, v2
  v_add_u32 v4, 112, v4
  v_lshlrev_b32 v4, 7, v4
  v_add_u32 v4, 100663296, v4
  s_add_u32 s36, s30, 192
  s_lshl_b32 s36, s36, 7
  s_add_u32 s36, s36, 100663296
  s_lshl_b32 s38, s29, 13
  v_add_u32 v10, s38, v3
  s_lshl_b32 s38, s29, 11
  v_add_u32 v11, s38, v3
  s_lshl_b32 s47, s30, 19
  s_add_u32 s47, s47, 117440512
  s_mov_b32 s42, 0
  s_mov_b32 s50, 0
  s_mov_b32 s46, 0
  s_barrier
  s_lshl_b32 s48, s31, 11
  s_add_u32 s48, s48, 58720256
  s_mov_b32 s33, s48
  s_mov_b32 s44, 1
L_g3p_p:
  buffer_load_dword v14, v4, s[4:7], 0 offen sc1
  s_waitcnt vmcnt(0)
  v_cmp_gt_u32 vcc, s44, v14
  s_cbranch_vccz L_g3p_ok
  s_sleep 4
  s_add_u32 s50, s50, 1
  s_cmp_lt_u32 s50, 0x200000
  s_cbranch_scc1 L_g3p_p
  s_branch L_end
L_g3p_ok:
  buffer_load_dwordx4 v[48:51], v3, s[4:7], s33 offen offset:0 sc1
  buffer_load_dwordx4 v[52:55], v3, s[4:7], s33 offen offset:1024 sc1
  buffer_load_dwordx4 v[56:59], v3, s[4:7], s33 offen offset:2048 sc1
  buffer_load_dwordx4 v[60:63], v3, s[4:7], s33 offen offset:3072 sc1
  s_add_u32 s33, s33, 4096
  buffer_load_dwordx4 v[64:67], v3, s[4:7], s33 offen offset:0 sc1
  buffer_load_dwordx4 v[68:71], v3, s[4:7], s33 offen offset:1024 sc1
  buffer_load_dwordx4 v[72:75], v3, s[4:7], s33 offen offset:2048 sc1
  buffer_load_dwordx4 v[76:79], v3, s[4:7], s33 offen offset:3072 sc1
  s_add_u32 s33, s33, 4096
  buffer_load_dwordx4 v[80:83], v3, s[4:7], s33 offen offset:0 sc1
  buffer_load_dwordx4 v[84:87], v3, s[4:7], s33 offen offset:1024 sc1
  buffer_load_dwordx4 v[88:91], v3, s[4:7], s33 offen offset:2048 sc1
  buffer_load_dwordx4 v[92:95], v3, s[4:7], s33 offen offset:3072 sc1
  s_add_u32 s33, s33, 4096
  buffer_load_dwordx4 v[96:99], v3, s[4:7], s33 offen offset:0 sc1
  buffer_load_dwordx4 v[100:103], v3, s[4:7], s33 offen offset:1024 sc1
  buffer_load_dwordx4 v[104:107], v3, s[4:7], s33 offen offset:2048 sc1
  buffer_load_dwordx4 v[108:111], v3, s[4:7], s33 offen offset:3072 sc1
  s_add_u32 s33, s33, 4096
  buffer_load_dwordx4 v[112:115], v3, s[4:7], s33 offen offset:0 sc1
  buffer_load_dwordx4 v[116:119], v3, s[4:7], s33 offen offset:1024 sc1
  buffer_load_dwordx4 v[120:123], v3, s[4:7], s33 offen offset:2048 sc1
  buffer_load_dwordx4 v[124:127], v3, s[4:7], s33 offen offset:3072 sc1
  s_add_u32 s33, s33, 4096
  buffer_load_dwordx4 v[128:131], v3, s[4:7], s33 offen offset:0 sc1
  buffer_load_dwordx4 v[132:135], v3, s[4:7], s33 offen offset:1024 sc1
  buffer_load_dwordx4 v[136:139], v3, s[4:7], s33 offen offset:2048 sc1
  buffer_load_dwordx4 v[140:143], v3, s[4:7], s33 offen offset:3072 sc1
  s_add_u32 s33, s33, 4096
  buffer_load_dwordx4 v[144:147], v3, s[4:7], s33 offen offset:0 sc1
  buffer_load_dwordx4 v[148:151], v3, s[4:7], s33 offen offset:1024 sc1
  buffer_load_dwordx4 v[152:155], v3, s[4:7], s33 offen offset:2048 sc1
  buffer_load_dwordx4 v[156:159], v3, s[4:7], s33 offen offset:3072 sc1
  v_mov_b32 v15, 0
  v_mov_b32 v14, v11
  s_waitcnt vmcnt(0)
L_g3b_loop:
  s_add_u32 s44, s42, 2
  s_min_u32 s44, s44, 64
  s_sub_u32 s33, s44, 1
  s_mul_i32 s33, s33, 110592
  s_add_u32 s33, s33, s48
  v_cmp_gt_u32 vcc, s44, v15
  s_cbranch_vccz L_g3a_ok
L_g3a_p:
  buffer_load_dword v15, v4, s[4:7], 0 offen sc1
  s_waitcnt vmcnt(0)
  v_cmp_gt_u32 vcc, s44, v15
  s_cbranch_vccz L_g3a_ok
  s_sleep 4
  s_add_u32 s50, s50, 1
  s_cmp_lt_u32 s50, 0x200000
  s_cbranch_scc1 L_g3a_p
  s_branch L_end
L_g3a_ok:
  s_add_u32 s38, s44, 2
  v_cmp_gt_u32 vcc, s38, v15
  s_cbranch_vccz L_g3b_nl
  buffer_load_dword v15, v4, s[4:7], 0 offen sc1
L_g3b_nl:
  s_waitcnt vmcnt(28)
  v_mfma_f32_16x16x32_bf16 v[16:19], a[0:3], v[48:51], 0
  v_mfma_f32_16x16x32_bf16 v[20:23], a[4:7], v[48:51], 0
  v_mfma_f32_16x16x32_bf16 v[24:27], a[8:11], v[48:51], 0
  v_mfma_f32_16x16x32_bf16 v[28:31], a[12:15], v[48:51], 0
  v_mfma_f32_16x16x32_bf16 v[32:35], a[0:3], v[52:55], 0
  v_mfma_f32_16x16x32_bf16 v[36:39], a[4:7], v[52:55], 0
  v_mfma_f32_16x16x32_bf16 v[40:43], a[8:11], v[52:55], 0
  v_mfma_f32_16x16x32_bf16 v[44:47], a[12:15], v[52:55], 0
  buffer_load_dwordx4 v[48:51], v3, s[4:7], s33 offen offset:0 sc1
  buffer_load_dwordx4 v[52:55], v3, s[4:7], s33 offen offset:1024 sc1
  s_waitcnt vmcnt(28)
  v_mfma_f32_16x16x32_bf16 v[16:19], a[16:19], v[56:59], v[16:19]
  v_mfma_f32_16x16x32_bf16 v[20:23], a[20:23], v[56:59], v[20:23]
  v_mfma_f32_16x16x32_bf16 v[24:27], a[24:27], v[56:59], v[24:27]
  v_mfma_f32_16x16x32_bf16 v[28:31], a[28:31], v[56:59], v[28:31]
  v_mfma_f32_16x16x32_bf16 v[32:35], a[16:19], v[60:63], v[32:35]
  v_mfma_f32_16x16x32_bf16 v[36:39], a[20:23], v[60:63], v[36:39]
  v_mfma_f32_16x16x32_bf16 v[40:43], a[24:27], v[60:63], v[40:43]
  v_mfma_f32_16x16x32_bf16 v[44:47], a[28:31], v[60:63], v[44:47]
  buffer_load_dwordx4 v[56:59], v3, s[4:7], s33 offen offset:2048 sc1
  buffer_load_dwordx4 v[60:63], v3, s[4:7], s33 offen offset:3072 sc1
  s_waitcnt vmcnt(28)
  v_mfma_f32_16x16x32_bf16 v[16:19], a[32:35], v[64:67], v[16:19]
  v_mfma_f32_16x16x32_bf16 v[20:23], a[36:39], v[64:67], v[20:23]
  v_mfma_f32_16x16x32_bf16 v[24:27], a[40:43], v[64:67], v[24:27]
  v_mfma_f32_16x16x32_bf16 v[28:31], a[44:47], v[64:67], v[28:31]
  v_mfma_f32_16x16x32_bf16 v[32:35], a[32:35], v[68:71], v[32:35]
  v_mfma_f32_16x16x32_bf16 v[36:39], a[36:39], v[68:71], v[36:39]
  v_mfma_f32_16x16x32_bf16 v[40:43], a[40:43], v[68:71], v[40:43]
  v_mfma_f32_16x16x32_bf16 v[44:47], a[44:47], v[68:71], v[44:47]
  s_add_u32 s33, s33, 4096
  buffer_load_dwordx4 v[64:67], v3, s[4:7], s33 offen offset:0 sc1
  buffer_load_dwordx4 v[68:71], v3, s[4:7], s33 offen offset:1024 sc1
  s_waitcnt vmcnt(22) lgkmcnt(0)
  s_barrier
  s_cmp_lg_u32 s29, 3
  s_cbranch_scc1 L_g3b_nf
  s_max_i32 s38, s42, 1
  s_sub_u32 s38, s38, 1
  v_mov_b32 v5, s38
  buffer_store_dword v5, off, s[4:7], s36 sc1
L_g3b_nf:
  ds_read_b128 v[160:163], v14 offset:0
  ds_read_b128 v[164:167], v14 offset:8192
  ds_read_b128 v[168:171], v14 offset:16384
  ds_read_b128 v[172:175], v14 offset:24576
  ds_read_b128 v[176:179], v14 offset:1024
  ds_read_b128 v[180:183], v14 offset:9216
  ds_read_b128 v[184:187], v14 offset:17408
  ds_read_b128 v[188:191], v14 offset:25600
  s_waitcnt vmcnt(28)
  v_mfma_f32_16x16x32_bf16 v[16:19], a[48:51], v[72:75], v[16:19]
  v_mfma_f32_16x16x32_bf16 v[20:23], a[52:55], v[72:75], v[20:23]
  v_mfma_f32_16x16x32_bf16 v[24:27], a[56:59], v[72:75], v[24:27]
  v_mfma_f32_16x16x32_bf16 v[28:31], a[60:63], v[72:75], v[28:31]
  v_mfma_f32_16x16x32_bf16 v[32:35], a[48:51], v[76:79], v[32:35]
  v_mfma_f32_16x16x32_bf16 v[36:39], a[52:55], v[76:79], v[36:39]
  v_mfma_f32_16x16x32_bf16 v[40:43], a[56:59], v[76:79], v[40:43]
  v_mfma_f32_16x16x32_bf16 v[44:47], a[60:63], v[76:79], v[44:47]
  buffer_load_dwordx4 v[72:75], v3, s[4:7], s33 offen offset:2048 sc1
  buffer_load_dwordx4 v[76:79], v3, s[4:7], s33 offen offset:3072 sc1
  s_waitcnt vmcnt(28)
  v_mfma_f32_16x16x32_bf16 v[16:19], a[64:67], v[80:83], v[16:19]
  v_mfma_f32_16x16x32_bf16 v[20:23], a[68:71], v[80:83], v[20:23]
  v_mfma_f32_16x16x32_bf16 v[24:27], a[72:75], v[80:83], v[24:27]
  v_mfma_f32_16x16x32_bf16 v[28:31], a[76:79], v[80:83], v[28:31]
  v_mfma_f32_16x16x32_bf16 v[32:35], a[64:67], v[84:87], v[32:35]
  v_mfma_f32_16x16x32_bf16 v[36:39], a[68:71], v[84:87], v[36:39]
  v_mfma_f32_16x16x32_bf16 v[40:43], a[72:75], v[84:87], v[40:43]
  v_mfma_f32_16x16x32_bf16 v[44:47], a[76:79], v[84:87], v[44:47]
  s_add_u32 s33, s33, 4096
  buffer_load_dwordx4 v[80:83], v3, s[4:7], s33 offen offset:0 sc1
  buffer_load_dwordx4 v[84:87], v3, s[4:7], s33 offen offset:1024 sc1
  s_waitcnt lgkmcnt(0)
  v_add_f32 v160, v160, v164
  v_add_f32 v168, v168, v172
  v_add_f32 v161, v161, v165
  v_add_f32 v169, v169, v173
  v_add_f32 v162, v162, v166
  v_add_f32 v170, v170, v174
  v_add_f32 v163, v163, v167
  v_add_f32 v171, v171, v175
  v_add_f32 v160, v160, v168
  v_add_f32 v161, v161, v169
  v_add_f32 v162, v162, v170
  v_add_f32 v163, v163, v171
  buffer_store_dwordx4 v[160:163], v11, s[4:7], s47 offen offset:0 sc1
  v_add_f32 v176, v176, v180
  v_add_f32 v184, v184, v188
  v_add_f32 v177, v177, v181
  v_add_f32 v185, v185, v189
  v_add_f32 v178, v178, v182
  v_add_f32 v186, v186, v190
  v_add_f32 v179, v179, v183
  v_add_f32 v187, v187, v191
  v_add_f32 v176, v176, v184
  v_add_f32 v177, v177, v185
  v_add_f32 v178, v178, v186
  v_add_f32 v179, v179, v187
  buffer_store_dwordx4 v[176:179], v11, s[4:7], s47 offen offset:1024 sc1
  s_waitcnt vmcnt(28)
  v_mfma_f32_16x16x32_bf16 v[16:19], a[80:83], v[88:91], v[16:19]
  v_mfma_f32_16x16x32_bf16 v[20:23], a[84:87], v[88:91], v[20:23]
  v_mfma_f32_16x16x32_bf16 v[24:27], a[88:91], v[88:91], v[24:27]
  v_mfma_f32_16x16x32_bf16 v[28:31], a[92:95], v[88:91], v[28:31]
  v_mfma_f32_16x16x32_bf16 v[32:35], a[80:83], v[92:95], v[32:35]
  v_mfma_f32_16x16x32_bf16 v[36:39], a[84:87], v[92:95], v[36:39]
  v_mfma_f32_16x16x32_bf16 v[40:43], a[88:91], v[92:95], v[40:43]
  v_mfma_f32_16x16x32_bf16 v[44:47], a[92:95], v[92:95], v[44:47]
  buffer_load_dwordx4 v[88:91], v3, s[4:7], s33 offen offset:2048 sc1
  buffer_load_dwordx4 v[92:95], v3, s[4:7], s33 offen offset:3072 sc1
  s_waitcnt vmcnt(28)
  v_mfma_f32_16x16x32_bf16 v[16:19], a[96:99], v[96:99], v[16:19]
  v_mfma_f32_16x16x32_bf16 v[20:23], a[100:103], v[96:99], v[20:23]
  v_mfma_f32_16x16x32_bf16 v[24:27], a[104:107], v[96:99], v[24:27]
  v_mfma_f32_16x16x32_bf16 v[28:31], a[108:111], v[96:99], v[28:31]
  v_mfma_f32_16x16x32_bf16 v[32:35], a[96:99], v[100:103], v[32:35]
  v_mfma_f32_16x16x32_bf16 v[36:39], a[100:103], v[100:103], v[36:39]
  v_mfma_f32_16x16x32_bf16 v[40:43], a[104:107], v[100:103], v[40:43]
  v_mfma_f32_16x16x32_bf16 v[44:47], a[108:111], v[100:103], v[44:47]
  s_add_u32 s33, s33, 4096
  buffer_load_dwordx4 v[96:99], v3, s[4:7], s33 offen offset:0 sc1
  buffer_load_dwordx4 v[100:103], v3, s[4:7], s33 offen offset:1024 sc1
  s_waitcnt vmcnt(28)
  v_mfma_f32_16x16x32_bf16 v[16:19], a[112:115], v[104:107], v[16:19]
  v_mfma_f32_16x16x32_bf16 v[20:23], a[116:119], v[104:107], v[20:23]
  v_mfma_f32_16x16x32_bf16 v[24:27], a[120:123], v[104:107], v[24:27]
  v_mfma_f32_16x16x32_bf16 v[28:31], a[124:127], v[104:107], v[28:31]
  v_mfma_f32_16x16x32_bf16 v[32:35], a[112:115], v[108:111], v[32:35]
  v_mfma_f32_16x16x32_bf16 v[36:39], a[116:119], v[108:111], v[36:39]
  v_mfma_f32_16x16x32_bf16 v[40:43], a[120:123], v[108:111], v[40:43]
  v_mfma_f32_16x16x32_bf16 v[44:47], a[124:127], v[108:111], v[44:47]
  buffer_load_dwordx4 v[104:107], v3, s[4:7], s33 offen offset:2048 sc1
  buffer_load_dwordx4 v[108:111], v3, s[4:7], s33 offen offset:3072 sc1
  s_waitcnt vmcnt(28)
  v_mfma_f32_16x16x32_bf16 v[16:19], a[128:131], v[112:115], v[16:19]
  v_mfma_f32_16x16x32_bf16 v[20:23], a[132:135], v[112:115], v[20:23]
  v_mfma_f32_16x16x32_bf16 v[24:27], a[136:139], v[112:115], v[24:27]
  v_mfma_f32_16x16x32_bf16 v[28:31], a[140:143], v[112:115], v[28:31]
  v_mfma_f32_16x16x32_bf16 v[32:35], a[128:131], v[116:119], v[32:35]
  v_mfma_f32_16x16x32_bf16 v[36:39], a[132:135], v[116:119], v[36:39]
  v_mfma_f32_16x16x32_bf16 v[40:43], a[136:139], v[116:119], v[40:43]
  v_mfma_f32_16x16x32_bf16 v[44:47], a[140:143], v[116:119], v[44:47]
  s_add_u32 s33, s33, 4096
  buffer_load_dwordx4 v[112:115], v3, s[4:7], s33 offen offset:0 sc1
  buffer_load_dwordx4 v[116:119], v3, s[4:7], s33 offen offset:1024 sc1
  s_waitcnt vmcnt(28)
  v_mfma_f32_16x16x32_bf16 v[16:19], a[144:147], v[120:123], v[16:19]
  v_mfma_f32_16x16x32_bf16 v[20:23], a[148:151], v[120:123], v[20:23]
  v_mfma_f32_16x16x32_bf16 v[24:27], a[152:155], v[120:123], v[24:27]
  v_mfma_f32_16x16x32_bf16 v[28:31], a[156:159], v[120:123], v[28:31]
  v_mfma_f32_16x16x32_bf16 v[32:35], a[144:147], v[124:127], v[32:35]
  v_mfma_f32_16x16x32_bf16 v[36:39], a[148:151], v[124:127], v[36:39]
  v_mfma_f32_16x16x32_bf16 v[40:43], a[152:155], v[124:127], v[40:43]
  v_mfma_f32_16x16x32_bf16 v[44:47], a[156:159], v[124:127], v[44:47]
  buffer_load_dwordx4 v[120:123], v3, s[4:7], s33 offen offset:2048 sc1
  buffer_load_dwordx4 v[124:127], v3, s[4:7], s33 offen offset:3072 sc1
  s_waitcnt vmcnt(28)
  v_mfma_f32_16x16x32_bf16 v[16:19], a[160:163], v[128:131], v[16:19]
  v_mfma_f32_16x16x32_bf16 v[20:23], a[164:167], v[128:131], v[20:23]
  v_mfma_f32_16x16x32_bf16 v[24:27], a[168:171], v[128:131], v[24:27]
  v_mfma_f32_16x16x32_bf16 v[28:31], a[172:175], v[128:131], v[28:31]
  v_mfma_f32_16x16x32_bf16 v[32:35], a[160:163], v[132:135], v[32:35]
  v_mfma_f32_16x16x32_bf16 v[36:39], a[164:167], v[132:135], v[36:39]
  v_mfma_f32_16x16x32_bf16 v[40:43], a[168:171], v[132:135], v[40:43]
  v_mfma_f32_16x16x32_bf16 v[44:47], a[172:175], v[132:135], v[44:47]
  s_add_u32 s33, s33, 4096
  buffer_load_dwordx4 v[128:131], v3, s[4:7], s33 offen offset:0 sc1
  buffer_load_dwordx4 v[132:135], v3, s[4:7], s33 offen offset:1024 sc1
  s_waitcnt vmcnt(28)
  v_mfma_f32_16x16x32_bf16 v[16:19], a[176:179], v[136:139], v[16:19]
  v_mfma_f32_16x16x32_bf16 v[20:23], a[180:183], v[136:139], v[20:23]
  v_mfma_f32_16x16x32_bf16 v[24:27], a[184:187], v[136:139], v[24:27]
  v_mfma_f32_16x16x32_bf16 v[28:31], a[188:191], v[136:139], v[28:31]
  v_mfma_f32_16x16x32_bf16 v[32:35], a[176:179], v[140:143], v[32:35]
  v_mfma_f32_16x16x32_bf16 v[36:39], a[180:183], v[140:143], v[36:39]
  v_mfma_f32_16x16x32_bf16 v[40:43], a[184:187], v[140:143], v[40:43]
  v_mfma_f32_16x16x32_bf16 v[44:47], a[188:191], v[140:143], v[44:47]
  buffer_load_dwordx4 v[136:139], v3, s[4:7], s33 offen offset:2048 sc1
  buffer_load_dwordx4 v[140:143], v3, s[4:7], s33 offen offset:3072 sc1
  s_waitcnt vmcnt(28)
  v_mfma_f32_16x16x32_bf16 v[16:19], a[192:195], v[144:147], v[16:19]
  v_mfma_f32_16x16x32_bf16 v[20:23], a[196:199], v[144:147], v[20:23]
  v_mfma_f32_16x16x32_bf16 v[24:27], a[200:203], v[144:147], v[24:27]
  v_mfma_f32_16x16x32_bf16 v[28:31], a[204:207], v[144:147], v[28:31]
  v_mfma_f32_16x16x32_bf16 v[32:35], a[192:195], v[148:151], v[32:35]
  v_mfma_f32_16x16x32_bf16 v[36:39], a[196:199], v[148:151], v[36:39]
  v_mfma_f32_16x16x32_bf16 v[40:43], a[200:203], v[148:151], v[40:43]
  v_mfma_f32_16x16x32_bf16 v[44:47], a[204:207], v[148:151], v[44:47]
  s_add_u32 s33, s33, 4096
  buffer_load_dwordx4 v[144:147], v3, s[4:7], s33 offen offset:0 sc1
  buffer_load_dwordx4 v[148:151], v3, s[4:7], s33 offen offset:1024 sc1
  s_waitcnt vmcnt(28)
  v_mfma_f32_16x16x32_bf16 v[16:19], a[208:211], v[152:155], v[16:19]
  v_mfma_f32_16x16x32_bf16 v[20:23], a[212:215], v[152:155], v[20:23]
  v_mfma_f32_16x16x32_bf16 v[24:27], a[216:219], v[152:155], v[24:27]
  v_mfma_f32_16x16x32_bf16 v[28:31], a[220:223], v[152:155], v[28:31]
  v_mfma_f32_16x16x32_bf16 v[32:35], a[208:211], v[156:159], v[32:35]
  v_mfma_f32_16x16x32_bf16 v[36:39], a[212:215], v[156:159], v[36:39]
  v_mfma_f32_16x16x32_bf16 v[40:43], a[216:219], v[156:159], v[40:43]
  v_mfma_f32_16x16x32_bf16 v[44:47], a[220:223], v[156:159], v[44:47]
  buffer_load_dwordx4 v[152:155], v3, s[4:7], s33 offen offset:2048 sc1
  buffer_load_dwordx4 v[156:159], v3, s[4:7], s33 offen offset:3072 sc1
  v_add_u32 v13, s46, v10
  v_add_u32 v14, s46, v11
  ds_write_b128 v13, v[16:19] offset:0
  ds_write_b128 v13, v[20:23] offset:1024
  ds_write_b128 v13, v[24:27] offset:2048
  ds_write_b128 v13, v[28:31] offset:3072
  ds_write_b128 v13, v[32:35] offset:4096
  ds_write_b128 v13, v[36:39] offset:5120
  ds_write_b128 v13, v[40:43] offset:6144
  ds_write_b128 v13, v[44:47] offset:7168
  s_xor_b32 s46, s46, 32768
  s_cmp_eq_u32 s42, 0
  s_cselect_b32 s38, 0, 8192
  s_add_u32 s47, s47, s38
  s_add_u32 s42, s42, 1
  s_cmp_lt_u32 s42, 64
  s_cbranch_scc1 L_g3b_loop
  s_waitcnt lgkmcnt(0)
  s_barrier
  ds_read_b128 v[160:163], v14 offset:0
  ds_read_b128 v[164:167], v14 offset:8192
  ds_read_b128 v[168:171], v14 offset:16384
  ds_read_b128 v[172:175], v14 offset:24576
  ds_read_b128 v[176:179], v14 offset:1024
  ds_read_b128 v[180:183], v14 offset:9216
  ds_read_b128 v[184:187], v14 offset:17408
  ds_read_b128 v[188:191], v14 offset:25600
  s_waitcnt lgkmcnt(0)
  v_add_f32 v160, v160, v164
  v_add_f32 v168, v168, v172
  v_add_f32 v161, v161, v165
  v_add_f32 v169, v169, v173
  v_add_f32 v162, v162, v166
  v_add_f32 v170, v170, v174
  v_add_f32 v163, v163, v167
  v_add_f32 v171, v171, v175
  v_add_f32 v160, v160, v168
  v_add_f32 v161, v161, v169
  v_add_f32 v162, v162, v170
  v_add_f32 v163, v163, v171
  buffer_store_dwordx4 v[160:163], v11, s[4:7], s47 offen offset:0 sc1
  v_add_f32 v176, v176, v180
  v_add_f32 v184, v184, v188
  v_add_f32 v177, v177, v181
  v_add_f32 v185, v185, v189
  v_add_f32 v178, v178, v182
  v_add_f32 v186, v186, v190
  v_add_f32 v179, v179, v183
  v_add_f32 v187, v187, v191
  v_add_f32 v176, v176, v184
  v_add_f32 v177, v177, v185
  v_add_f32 v178, v178, v186
  v_add_f32 v179, v179, v187
  buffer_store_dwordx4 v[176:179], v11, s[4:7], s47 offen offset:1024 sc1
  s_waitcnt vmcnt(0)
  s_barrier
  s_cmp_lg_u32 s29, 3
  s_cbranch_scc1 L_end
  v_mov_b32 v5, s42
  buffer_store_dword v5, off, s[4:7], s36 sc1
  s_branch L_end
L_hlp:
  s_memrealtime s[70:71]
  s_memtime s[72:73]
  s_load_dwordx2 s[8:9], s[0:1], 0
  s_load_dwordx2 s[12:13], s[0:1], 88
  s_load_dwordx2 s[16:17], s[0:1], 104
  s_mov_b32 s10, 2621440
  s_mov_b32 s11, 0x20000
  s_mov_b32 s14, 1280
  s_mov_b32 s15, 0x20000
  s_mov_b32 s18, 256
  s_mov_b32 s19, 0x20000
  v_lshrrev_b32 v1, 6, v0
  s_nop 0
  v_readfirstlane_b32 s29, v1
  v_lshlrev_b32 v2, 4, v0
  s_mov_b32 s22, 4290772927
  v_mov_b32 v32, s22
  v_mov_b32 v33, s22
  v_mov_b32 v34, s22
  v_mov_b32 v35, s22
  s_waitcnt lgkmcnt(0)
L_h_lo:
  s_mov_b32 s48, s30
L_h_pf:
  s_load_dwordx4 s[60:63], s[0:1], 16
  s_load_dwordx4 s[64:67], s[0:1], 32
  s_lshr_b32 s33, s2, 3
  s_sub_u32 s33, s33, 16
  s_lshl_b32 s33, s33, 8
  v_add_u32 v40, s33, v0
  v_lshrrev_b32 v41, 4, v40
  v_add_u32 v41, 128, v41
  v_lshlrev_b32 v41, 13, v41
  v_bfe_u32 v42, v0, 1, 3
  v_lshl_add_u32 v41, v42, 10, v41
  v_and_b32 v42, 1, v0
  v_lshl_add_u32 v41, v42, 7, v41
  s_and_b32 s34, s2, 3
  s_lshl_b32 s33, s34, 8
  v_add_u32 v41, s33, v41
  s_waitcnt lgkmcnt(0)
  global_load_dword v255, v41, s[62:63]
  global_load_dword v255, v41, s[64:65]
  global_load_dword v255, v41, s[60:61]
  v_add_u32 v41, 2097152, v41
  s_waitcnt vmcnt(2)
  global_load_dword v255, v41, s[62:63]
  global_load_dword v255, v41, s[64:65]
  global_load_dword v255, v41, s[60:61]
  s_mul_i32 s33, s34, 163840
  s_mov_b32 s34, 52429
  s_waitcnt vmcnt(2)
  v_min_u32 v41, 10239, v40
  v_lshrrev_b32 v42, 8, v41
  v_mul_u32_u24 v42, s34, v42
  v_lshrrev_b32 v42, 18, v42
  v_mul_u32_u24 v42, 491520, v42
  v_lshl_add_u32 v41, v41, 7, v42
  v_add_u32 v41, s33, v41
  global_load_dword v255, v41, s[66:67]
  v_add_u32 v40, 4096, v40
  v_min_u32 v41, 10239, v40
  v_lshrrev_b32 v42, 8, v41
  v_mul_u32_u24 v42, s34, v42
  v_lshrrev_b32 v42, 18, v42
  v_mul_u32_u24 v42, 491520, v42
  v_lshl_add_u32 v41, v41, 7, v42
  v_add_u32 v41, s33, v41
  global_load_dword v255, v41, s[66:67]
  v_add_u32 v40, 4096, v40
  v_min_u32 v41, 10239, v40
  v_lshrrev_b32 v42, 8, v41
  v_mul_u32_u24 v42, s34, v42
  v_lshrrev_b32 v42, 18, v42
  v_mul_u32_u24 v42, 491520, v42
  v_lshl_add_u32 v41, v41, 7, v42
  v_add_u32 v41, s33, v41
  global_load_dword v255, v41, s[66:67]
  v_add_u32 v40, 4096, v40
  s_lshl_b32 s32, s29, 6
  s_add_u32 s32, s32, s30
  s_cmp_ge_u32 s32, 80
  s_cbranch_scc1 L_end
  s_load_dwordx2 s[20:21], s[0:1], 104
  s_mov_b32 s22, 256
  s_mov_b32 s23, 0x20000
  s_mov_b32 s38, 0
  s_waitcnt lgkmcnt(0)
L_red_wi:
  buffer_load_dword v6, off, s[20:23], 0 offset:128 sc1
  s_waitcnt vmcnt(0)
  v_cmp_eq_u32 vcc, 0, v6
  s_cbranch_vccz L_red_wd
  s_sleep 8
  s_add_u32 s38, s38, 1
  s_cmp_lt_u32 s38, 0x100000
  s_cbranch_scc1 L_red_wi
  s_branch L_end
L_red_wd:
  s_mov_b32 s38, 100761600
  buffer_load_dwordx4 v[44:47], off, s[4:7], s38 sc1
  buffer_load_dwordx4 v[48:51], off, s[4:7], s38 offset:16 sc1
  v_and_b32 v21, 63, v0
  v_lshlrev_b32 v2, 4, v21
  v_lshlrev_b32 v3, 4, v21
  v_lshrrev_b32 v23, 4, v21
  v_bfe_u32 v24, v21, 3, 1
  v_and_b32 v26, 1, v21
  v_lshlrev_b32 v26, 4, v26
  v_mov_b32 v27, 0x3f80
  v_lshlrev_b32 v27, v26, v27
  v_bfe_u32 v28, v21, 1, 2
  v_mov_b32 v26, 0
  v_cmp_eq_u32 vcc, 0, v28
  s_nop 1
  v_cndmask_b32 v16, v26, v27, vcc
  v_cmp_eq_u32 vcc, 1, v28
  s_nop 1
  v_cndmask_b32 v17, v26, v27, vcc
  v_cmp_eq_u32 vcc, 2, v28
  s_nop 1
  v_cndmask_b32 v18, v26, v27, vcc
  v_cmp_eq_u32 vcc, 3, v28
  s_nop 1
  v_cndmask_b32 v19, v26, v27, vcc
  s_waitcnt vmcnt(0)
  v_readfirstlane_b32 s80, v44
  v_readfirstlane_b32 s81, v45
  v_readfirstlane_b32 s82, v46
  v_readfirstlane_b32 s83, v47
  v_readfirstlane_b32 s84, v48
  v_readfirstlane_b32 s85, v49
  v_readfirstlane_b32 s86, v50
  v_readfirstlane_b32 s87, v51
  s_mov_b32 s38, 0
  s_mov_b32 s88, 0
  s_bfe_u32 s39, s80, 0x1000e
  s_add_u32 s88, s88, s39
  s_bfe_u32 s39, s81, 0x1000e
  s_add_u32 s88, s88, s39
  s_bfe_u32 s39, s82, 0x1000e
  s_add_u32 s88, s88, s39
  s_bfe_u32 s39, s83, 0x1000e
  s_add_u32 s88, s88, s39
  s_bfe_u32 s39, s84, 0x1000e
  s_add_u32 s88, s88, s39
  s_bfe_u32 s39, s85, 0x1000e
  s_add_u32 s88, s88, s39
  s_bfe_u32 s39, s86, 0x1000e
  s_add_u32 s88, s88, s39
  s_bfe_u32 s39, s87, 0x1000e
  s_add_u32 s88, s88, s39
  s_cmp_ge_u32 s88, 4
  s_cselect_b32 s88, 1, 0
  s_and_b32 s80, s80, 8192
  s_add_u32 s38, s38, s80
  s_and_b32 s81, s81, 8192
  s_xor_b32 s81, s81, 8192
  s_add_u32 s38, s38, s81
  s_and_b32 s82, s82, 8192
  s_add_u32 s38, s38, s82
  s_and_b32 s83, s83, 8192
  s_xor_b32 s83, s83, 8192
  s_add_u32 s38, s38, s83
  s_and_b32 s84, s84, 8192
  s_add_u32 s38, s38, s84
  s_and_b32 s85, s85, 8192
  s_xor_b32 s85, s85, 8192
  s_add_u32 s38, s38, s85
  s_and_b32 s86, s86, 8192
  s_add_u32 s38, s38, s86
  s_and_b32 s87, s87, 8192
  s_xor_b32 s87, s87, 8192
  s_add_u32 s38, s38, s87
  s_cmp_ge_u32 s38, 49152
  s_cselect_b32 s80, 8192, s80
  s_cmp_le_u32 s38, 16384
  s_cselect_b32 s80, 0, s80
  s_cmp_ge_u32 s38, 49152
  s_cselect_b32 s81, 8192, s81
  s_cmp_le_u32 s38, 16384
  s_cselect_b32 s81, 0, s81
  s_xor_b32 s81, s81, 8192
  s_cmp_ge_u32 s38, 49152
  s_cselect_b32 s82, 8192, s82
  s_cmp_le_u32 s38, 16384
  s_cselect_b32 s82, 0, s82
  s_cmp_ge_u32 s38, 49152
  s_cselect_b32 s83, 8192, s83
  s_cmp_le_u32 s38, 16384
  s_cselect_b32 s83, 0, s83
  s_xor_b32 s83, s83, 8192
  s_cmp_ge_u32 s38, 49152
  s_cselect_b32 s84, 8192, s84
  s_cmp_le_u32 s38, 16384
  s_cselect_b32 s84, 0, s84
  s_cmp_ge_u32 s38, 49152
  s_cselect_b32 s85, 8192, s85
  s_cmp_le_u32 s38, 16384
  s_cselect_b32 s85, 0, s85
  s_xor_b32 s85, s85, 8192
  s_cmp_ge_u32 s38, 49152
  s_cselect_b32 s86, 8192, s86
  s_cmp_le_u32 s38, 16384
  s_cselect_b32 s86, 0, s86
  s_cmp_ge_u32 s38, 49152
  s_cselect_b32 s87, 8192, s87
  s_cmp_le_u32 s38, 16384
  s_cselect_b32 s87, 0, s87
  s_xor_b32 s87, s87, 8192
  s_lshr_b32 s38, s32, 5
  s_xor_b32 s38, s38, s88
  s_and_b32 s38, s38, 1
  s_xor_b32 s32, s32, s38
  s_lshl_b32 s38, s32, 14
  v_add_u32 v10, s38, v2
  v_add_u32 v11, 4096, v10
  v_and_b32 v29, 1, v23
  v_and_b32 v27, 3, v21
  v_lshl_add_u32 v26, v29, 2, v27
  v_lshlrev_b32 v26, 4, v26
  v_bfe_u32 v28, v21, 2, 1
  v_lshl_add_u32 v26, v28, 3, v26
  v_lshrrev_b32 v28, 1, v23
  v_lshl_add_u32 v26, v28, 2, v26
  s_lshl_b32 s38, s32, 7
  s_cmp_ge_u32 s32, 64
  s_cselect_b32 s39, 24576, 0
  s_add_u32 s38, s38, s39
  s_add_u32 s38, s38, 0
  v_add_u32 v26, s38, v26
  v_lshl_add_u32 v26, v24, 14, v26
  v_add_u32 v12, s80, v26
  v_add_u32 v13, s82, v26
  v_add_u32 v13, 4194304, v13
  s_add_u32 s8, s84, 8388608
  s_add_u32 s9, s85, 10485760
  s_add_u32 s10, s8, 0x140000
  s_bfe_u32 s14, s41, 0x8000a
  s_bfe_u32 s15, s41, 0x80012
  s_and_b32 s18, s41, 1023
  s_cmp_ge_u32 s32, 32
  s_cselect_b32 s38, s14, 0
  s_add_u32 s18, s18, s38
  s_cmp_ge_u32 s32, 64
  s_cselect_b32 s38, s15, 0
  s_add_u32 s18, s18, s38
  s_add_u32 s19, s18, 24
  s_mov_b32 s46, 0
  s_mov_b32 s33, 0
  s_mov_b32 s34, 65536
  s_mov_b32 s50, 0
  s_mov_b32 s51, 0
  s_mov_b32 s47, 0
  s_mov_b32 s97, 4290772927
L_red_step:
  s_mov_b32 s45, 0
  s_mov_b32 s44, 0
  s_and_b32 s49, s33, 3
  s_lshl_b32 s49, s49, 15
  s_add_u32 s49, s49, s10
  s_and_b32 s48, s32, 63
  s_lshl_b32 s48, s48, 7
  s_add_u32 s48, s48, s49
  s_add_u32 s48, s48, 16384
  s_memrealtime s[76:77]
  s_memtime s[78:79]
  s_waitcnt lgkmcnt(0)
  s_sub_u32 s76, s76, s70
  s_sub_u32 s78, s78, s72
  v_cvt_f32_u32 v4, s76
  v_cvt_f32_u32 v5, s78
  v_rcp_f32 v4, v4
  s_nop 0
  v_mul_f32 v4, v4, v5
  v_max_f32 v4, 0x41800000, v4
  v_min_f32 v4, 0x41d00000, v4
  v_rcp_f32 v5, v4
  v_mul_f32 v4, 0x42924925, v4
  v_cvt_u32_f32 v4, v4
  s_nop 0
  v_readfirstlane_b32 s74, v4
L_red_cn:
  buffer_load_dword v4, off, s[4:7], s48 sc1
  s_waitcnt vmcnt(0)
  v_cmp_gt_i32 vcc, 0, v4
  s_cbranch_vccz L_red_cok
  s_sleep 1
  s_add_u32 s47, s47, 1
  s_cmp_lt_u32 s47, 0x400000
  s_cbranch_scc1 L_red_cn
  s_branch L_end
L_red_cok:
  s_sleep 2
  buffer_load_dword v4, v3, s[4:7], s49 offen sc1
  buffer_store_dwordx4 v[32:35], v10, s[4:7], s9 offen offset:0 sc1
  s_sleep 1
  buffer_store_dwordx4 v[32:35], v10, s[4:7], s9 offen offset:1024 sc1
  s_sleep 1
  buffer_store_dwordx4 v[32:35], v10, s[4:7], s9 offen offset:2048 sc1
  s_sleep 1
  buffer_store_dwordx4 v[32:35], v10, s[4:7], s9 offen offset:3072 sc1
  s_sleep 1
  buffer_store_dwordx4 v[32:35], v11, s[4:7], s9 offen offset:0 sc1
  s_sleep 1
  buffer_store_dwordx4 v[32:35], v11, s[4:7], s9 offen offset:1024 sc1
  s_sleep 1
  buffer_store_dwordx4 v[32:35], v11, s[4:7], s9 offen offset:2048 sc1
  s_sleep 1
  buffer_store_dwordx4 v[32:35], v11, s[4:7], s9 offen offset:3072 sc1
  s_sleep 1
  s_add_u32 s35, s34, 65536
  s_and_b32 s35, s35, 524287
  buffer_store_dword v32, v12, s[4:7], s35 offen sc1
  buffer_store_dword v32, v13, s[4:7], s35 offen sc1
  s_waitcnt vmcnt(10)
  s_branch L_red_tc
L_red_tl:
  buffer_load_dword v4, v3, s[4:7], s49 offen sc1
  s_waitcnt vmcnt(0)
L_red_tc:
  s_memrealtime s[52:53]
  v_cmp_gt_i32 vcc, 0, v4
  s_cbranch_vccz L_red_tok
  s_sleep 4
  s_add_u32 s50, s50, 1
  s_add_u32 s45, s45, 1
  s_cmp_lt_u32 s45, 64
  s_cbranch_scc1 L_red_tl
  s_branch L_red_ld
L_red_tok:
  s_waitcnt lgkmcnt(0)
  v_subrev_u32 v4, s52, v4
  v_lshlrev_b32 v4, 1, v4
  s_nop 1
  v_max_i32_dpp v4, v4, v4 row_ror:1 row_mask:0xf bank_mask:0xf
  s_nop 1
  v_max_i32_dpp v4, v4, v4 row_ror:2 row_mask:0xf bank_mask:0xf
  s_nop 1
  v_max_i32_dpp v4, v4, v4 row_ror:4 row_mask:0xf bank_mask:0xf
  s_nop 1
  v_max_i32_dpp v4, v4, v4 row_ror:8 row_mask:0xf bank_mask:0xf
  s_nop 0
  v_readlane_b32 s38, v4, 0
  v_readlane_b32 s39, v4, 16
  v_readlane_b32 s36, v4, 32
  v_readlane_b32 s37, v4, 48
  s_max_i32 s38, s38, s39
  s_max_i32 s36, s36, s37
  s_max_i32 s38, s38, s36
  s_max_i32 s38, s38, -4000
  s_min_i32 s38, s38, 4000
  s_add_i32 s38, s38, s18
  s_cmp_lt_u32 s33, 6
  s_cselect_b32 s39, 6, 0
  s_add_i32 s38, s38, s39
  s_mul_i32 s38, s38, s74
  s_ashr_i32 s38, s38, 12
  s_max_i32 s38, s38, 0
.p2align 3
L_red_d1:
  s_sub_u32 s38, s38, 1
  s_cbranch_scc0 L_red_d1
L_red_ld:
  buffer_load_dwordx4 v[64:67], v10, s[4:7], s8 offen offset:0 sc1
  buffer_load_dwordx4 v[68:71], v10, s[4:7], s8 offen offset:1024 sc1
  buffer_load_dwordx4 v[72:75], v10, s[4:7], s8 offen offset:2048 sc1
  buffer_load_dwordx4 v[76:79], v10, s[4:7], s8 offen offset:3072 sc1
  buffer_load_dwordx4 v[80:83], v11, s[4:7], s8 offen offset:0 sc1
  buffer_load_dwordx4 v[84:87], v11, s[4:7], s8 offen offset:1024 sc1
  buffer_load_dwordx4 v[88:91], v11, s[4:7], s8 offen offset:2048 sc1
  buffer_load_dwordx4 v[92:95], v11, s[4:7], s8 offen offset:3072 sc1
  s_waitcnt vmcnt(7)
  v_mfma_f32_16x16x32_bf16 v[96:99], v[64:67], v[16:19], 0
  v_max3_u32 v5, v64, v65, v66
  s_waitcnt vmcnt(6)
  v_mfma_f32_16x16x32_bf16 v[96:99], v[68:71], v[16:19], v[96:99]
  v_max3_u32 v5, v5, v67, v68
  v_max3_u32 v5, v5, v69, v70
  s_waitcnt vmcnt(5)
  v_mfma_f32_16x16x32_bf16 v[96:99], v[72:75], v[16:19], v[96:99]
  v_max3_u32 v5, v5, v71, v72
  v_max3_u32 v5, v5, v73, v74
  s_waitcnt vmcnt(4)
  v_mfma_f32_16x16x32_bf16 v[96:99], v[76:79], v[16:19], v[96:99]
  v_max3_u32 v5, v5, v75, v76
  v_max3_u32 v5, v5, v77, v78
  s_waitcnt vmcnt(3)
  v_mfma_f32_16x16x32_bf16 v[96:99], v[80:83], v[16:19], v[96:99]
  v_max3_u32 v5, v5, v79, v80
  v_max3_u32 v5, v5, v81, v82
  s_waitcnt vmcnt(2)
  v_mfma_f32_16x16x32_bf16 v[96:99], v[84:87], v[16:19], v[96:99]
  v_max3_u32 v5, v5, v83, v84
  v_max3_u32 v5, v5, v85, v86
  s_waitcnt vmcnt(1)
  v_mfma_f32_16x16x32_bf16 v[96:99], v[88:91], v[16:19], v[96:99]
  v_max3_u32 v5, v5, v87, v88
  v_max3_u32 v5, v5, v89, v90
  s_waitcnt vmcnt(0)
  v_mfma_f32_16x16x32_bf16 v[96:99], v[92:95], v[16:19], v[96:99]
  v_max3_u32 v5, v5, v91, v92
  v_max3_u32 v5, v5, v93, v94
  v_max_u32 v5, v5, v95
  v_cmp_eq_u32 vcc, s97, v5
  s_cbranch_vccnz L_red_fail
  s_nop 2
  v_permlane32_swap_b32 v96, v98
  v_permlane32_swap_b32 v97, v99
  v_add_f32 v96, v96, v98
  v_add_f32 v97, v97, v99
  v_cvt_pk_bf16_f32 v96, v96, v97
  buffer_store_dword v96, v12, s[4:7], s34 offen sc1
  buffer_store_dword v96, v13, s[4:7], s34 offen sc1
  s_sleep 12
  s_mov_b32 s38, s8
  s_mov_b32 s8, s9
  s_mov_b32 s9, s38
  s_add_u32 s18, s18, s46
  s_min_u32 s18, s18, s19
  s_mov_b32 s46, 0
  s_mov_b32 s34, s35
  s_add_u32 s33, s33, 1
  s_cmp_lt_u32 s33, 63
  s_cbranch_scc1 L_red_step
  s_branch L_end
L_red_fail:
  s_cmp_lt_u32 s33, 3
  s_cselect_b32 s46, 0, 2
  s_add_u32 s51, s51, 1
  s_cmp_ge_u32 s51, 0x200000
  s_cbranch_scc1 L_end
  s_add_u32 s44, s44, 1
  s_cmp_lt_u32 s44, 2
  s_cbranch_scc1 L_red_ld
  s_branch L_red_tl
L_end:
  s_endpgm
.section .rodata,"a"
.p2align 6
.amdhsa_kernel gated_mix__memory_aug_recurrent_mem_tr__glu_gated_swiglu__prompt_kernel
  .amdhsa_next_free_vgpr 512
  .amdhsa_next_free_sgpr 102
  .amdhsa_accum_offset 256
  .amdhsa_group_segment_fixed_size 0
  .amdhsa_kernarg_size 120
  .amdhsa_user_sgpr_count 2
  .amdhsa_user_sgpr_kernarg_segment_ptr 1
  .amdhsa_system_sgpr_workgroup_id_x 1
.end_amdhsa_kernel
```
